```python
import torch

def _softmax(x, axis=-1):
    return torch.softmax(x, dim=axis)
def _gelu(x):
    return torch.nn.functional.gelu(x, approximate="tanh")
def _silu(x):
    return torch.nn.functional.silu(x)
def _sigmoid(x):
    return torch.sigmoid(x)
def _layernorm(x, axis=-1, eps=1e-5):
    m = x.mean(dim=axis, keepdim=True)
    v = x.var(dim=axis, keepdim=True, unbiased=False)
    return (x - m) / torch.sqrt(v + eps)
def _scatter_add(tgt, idx, src, axis=0):
    return tgt.clone().index_add_(axis, idx, src)
def _segment_sum(src, seg, n):
    out = torch.zeros((n,) + src.shape[1:], dtype=src.dtype)
    return out.index_add_(0, seg, src)
def _pad(x, pw):
    flat = tuple(v for pair in reversed(pw) for v in pair)
    return torch.nn.functional.pad(x, flat)

kernel_name = 'concat_heads__mha_block_cached__gqa_block_cached__near_ridge'

def setup_inputs():

    _w = (lambda a: (lambda t: t.to(torch.bfloat16) if t.is_floating_point() else t)(torch.as_tensor(a)))
    def _A_setup():
        B, Sq, D = 8, 224, 448
        H, Sk, Dh = 16, 512, 256
        return {
            "x": _w((lambda *s: torch.randn(*s, dtype=torch.bfloat16) * 0.8)(B, Sq, D)),
            "k_cache": _w((lambda *s: torch.randn(*s, dtype=torch.bfloat16) * 0.8)(B, H, Sk, Dh)),
            "v_cache": _w((lambda *s: torch.randn(*s, dtype=torch.bfloat16) * 0.05)(B, H, Sk, Dh)),
            "wq": _w((lambda *s: torch.randn(*s, dtype=torch.bfloat16) * 0.8)(D, H * Dh) * (D ** -0.5)),
            "wo": _w((lambda *s: torch.randn(*s, dtype=torch.bfloat16) * 0.05)(H * Dh, D) * ((H * Dh) ** -0.5)),
        }
    _A_in = _A_setup()

    def _B_setup():
        B, Sq, D = 8, 224, 448
        Hq, Hkv, Sk, Dh = 16, 16, 512, 256
        assert Hq % Hkv == 0, (Hq, Hkv)
        return {
            "x": _w((lambda *s: torch.randn(*s, dtype=torch.bfloat16) * 0.8)(B, Sq, D)),
            "k_cache": _w((lambda *s: torch.randn(*s, dtype=torch.bfloat16) * 0.8)(B, Hkv, Sk, Dh)),
            "v_cache": _w((lambda *s: torch.randn(*s, dtype=torch.bfloat16) * 0.05)(B, Hkv, Sk, Dh)),
            "wq": _w((lambda *s: torch.randn(*s, dtype=torch.bfloat16) * 0.8)(D, Hq * Dh) * (D ** -0.5)),
            "wo": _w((lambda *s: torch.randn(*s, dtype=torch.bfloat16) * 0.05)(Hq * Dh, D) * ((Hq * Dh) ** -0.5)),
        }
    _B_in = _B_setup()

    return {
        "A_x": _A_in["x"],
        "A_k_cache": _A_in["k_cache"],
        "A_v_cache": _A_in["v_cache"],
        "A_wq": _A_in["wq"],
        "A_wo": _A_in["wo"],
        "B_x": _B_in["x"],
        "B_k_cache": _B_in["k_cache"],
        "B_v_cache": _B_in["v_cache"],
        "B_wq": _B_in["wq"],
        "B_wo": _B_in["wo"],
    }

def reference(A_x, A_k_cache, A_v_cache, A_wq, A_wo, B_x, B_k_cache, B_v_cache, B_wq, B_wo):
    def _A_ref(x, k_cache, v_cache, wq, wo):
        B, Sq, D = x.shape
        H, Dh = 16, 256
        q = (lambda x, *d: x.permute(*d))((x @ wq).reshape(B, Sq, H, Dh), 0, 2, 1, 3)
        scores = torch.einsum("bhqd,bhkd->bhqk", q, k_cache) * (Dh ** -0.5)
        p = _softmax(scores, axis=-1)
        o = torch.einsum("bhqk,bhkd->bhqd", p, v_cache)
        return (lambda x, *d: x.permute(*d))(o, 0, 2, 1, 3).reshape(B, Sq, H * Dh) @ wo

    def _B_ref(x, k_cache, v_cache, wq, wo):
        B, Sq, D = x.shape
        Hq, Dh = 16, 256
        Hkv = k_cache.shape[1]
        rep = Hq // Hkv
        q = (lambda x, *d: x.permute(*d))((x @ wq).reshape(B, Sq, Hq, Dh), 0, 2, 1, 3)
        k = (lambda x, n, axis: torch.repeat_interleave(x, n, dim=axis))(k_cache, rep, axis=1)
        v = (lambda x, n, axis: torch.repeat_interleave(x, n, dim=axis))(v_cache, rep, axis=1)
        scores = torch.einsum("bhqd,bhkd->bhqk", q, k) * (Dh ** -0.5)
        p = _softmax(scores, axis=-1)
        o = torch.einsum("bhqk,bhkd->bhqd", p, v)
        return (lambda x, *d: x.permute(*d))(o, 0, 2, 1, 3).reshape(B, Sq, Hq * Dh) @ wo

    a = _A_ref(A_x, A_k_cache, A_v_cache, A_wq, A_wo)
    b = _B_ref(B_x, B_k_cache, B_v_cache, B_wq, B_wo)
    return torch.concatenate([a, b], axis=-1)
```

```asm
; @launch grid=(256,1,1) block=(256,1,1) lds=163840
.amdgcn_target "amdgcn-amd-amdhsa--gfx950"
.text
.globl concat_heads__mha_block_cached__gqa_block_cached__near_ridge_kernel
.p2align 8
.type concat_heads__mha_block_cached__gqa_block_cached__near_ridge_kernel,@function
concat_heads__mha_block_cached__gqa_block_cached__near_ridge_kernel:
    s_cmp_ge_u32 s2, 256
    s_cbranch_scc1 L_end
    s_mov_b32 s90, 0
L_restart:
    s_getpc_b64 s[54:55]
    s_bfe_u32 s39, s2, 0x10002
    s_mul_i32 s5, s39, 40
    s_add_u32 s6, s0, s5
    s_addc_u32 s7, s1, 0
    s_load_dwordx8 s[40:47], s[6:7], 0
    v_readfirstlane_b32 s3, v0
    s_lshr_b32 s4, s2, 3
    s_lshl_b32 s4, s4, 8
    v_add_u32 v247, s4, v0
    v_bfe_u32 v246, v247, 6, 6
    v_and_b32 v0, 63, v0
    v_lshlrev_b32 v247, 7, v0
    v_min_u32 v247, 988, v247
    v_mul_u32_u24 v246, 992, v246
    v_add_u32 v1, v246, v247
    global_load_dword v6, v1, s[54:55]
    s_lshr_b32 s3, s3, 6
    s_and_b32 s4, s2, 3
    s_bfe_u32 s5, s2, 0x20003
    s_lshl2_add_u32 s37, s4, s5
    v_lshrrev_b32_e64 v244, 5, v0
    v_lshlrev_b32_e64 v4, 17, v244
    v_and_b32_e64 v244, 31, v0
    v_lshl_add_u32 v4, v244, 4, v4
    s_and_b32 s36, s3, 1
    s_lshl_b32 s64, s3, 13
    s_mul_i32 s66, s3, 4128
    s_mul_i32 s4, s36, 24
    s_sub_u32 s66, s66, s4
    s_add_u32 s66, s66, 66560
    s_lshl_b32 s4, s37, 9
    s_sub_u32 s22, 3670016, s4
    s_mov_b32 s23, 0x20000
    s_waitcnt lgkmcnt(0)
    s_add_u32 s20, s46, s4
    s_addc_u32 s21, s47, 0
    s_and_b32 s21, s21, 0xffff
    s_mov_b32 m0, s66
    s_add_u32 s65, s64, 0
    buffer_load_dwordx4 v4, s[20:23], s65 offen lds
    s_add_u32 s65, s64, 31744
    buffer_load_dwordx4 v4, s[20:23], s65 offen offset:1024 lds
    s_add_u32 m0, s66, 16512
    s_add_u32 s65, s64, 65536
    buffer_load_dwordx4 v4, s[20:23], s65 offen lds
    s_add_u32 s65, s64, 97280
    buffer_load_dwordx4 v4, s[20:23], s65 offen offset:1024 lds
    s_load_dwordx2 s[48:49], s[6:7], 32
    s_load_dwordx2 s[50:51], s[0:1], 96
    s_load_dwordx4 s[76:79], s[0:1], 80
    s_lshr_b32 s38, s2, 5
    v_lshrrev_b32 v241, 4, v0
    v_and_b32 v245, 7, v0
    s_lshl_b32 s4, s36, 2
    v_xor_b32 v244, v245, v241
    v_xor_b32 v244, s4, v244
    v_lshrrev_b32 v246, 3, v0
    v_mul_u32_u24 v25, 896, v246
    v_lshl_add_u32 v25, v244, 4, v25
    s_mul_i32 s56, s3, 7168
    s_lshl_b32 s57, s3, 10
    s_add_u32 s57, s57, 133120
    s_mul_i32 s4, s38, 200704
    s_mov_b32 s10, 200704
    s_mov_b32 s11, 0x20000
    s_add_u32 s8, s40, s4
    s_addc_u32 s9, s41, 0
    s_and_b32 s9, s9, 0xffff
    s_add_u32 m0, s57, 0
    s_add_u32 s65, s56, 0
    buffer_load_dwordx4 v25, s[8:11], s65 offen lds
    s_add_u32 m0, s57, 4096
    s_add_u32 s65, s56, 28672
    buffer_load_dwordx4 v25, s[8:11], s65 offen lds
    s_add_u32 m0, s57, 8192
    s_add_u32 s65, s56, 57344
    buffer_load_dwordx4 v25, s[8:11], s65 offen lds
    s_add_u32 m0, s57, 12288
    s_add_u32 s65, s56, 86016
    buffer_load_dwordx4 v25, s[8:11], s65 offen lds
    s_add_u32 m0, s57, 16384
    s_add_u32 s65, s56, 114688
    buffer_load_dwordx4 v25, s[8:11], s65 offen lds
    s_add_u32 m0, s57, 20480
    s_add_u32 s65, s56, 143360
    buffer_load_dwordx4 v25, s[8:11], s65 offen lds
    s_add_u32 m0, s57, 24576
    s_add_u32 s65, s56, 172032
    buffer_load_dwordx4 v25, s[8:11], s65 offen lds
    s_add_u32 s56, s56, 128
    s_mov_b32 s82, 4294934016
    s_mov_b32 s83, 0
    v_and_b32 v243, 3, v0
    s_waitcnt lgkmcnt(0)
    s_cmp_eq_u32 s36, 0
    s_cbranch_scc1 L_w0
    s_lshr_b32 s5, s3, 1
    s_lshl_b32 s85, s38, 1
    s_add_u32 s85, s85, s5
    s_lshl_b32 s85, s85, 15
    v_lshrrev_b32_e64 v27, 2, v0
    v_lshlrev_b32_e64 v27, 13, v27
    v_lshl_add_u32 v27, v243, 7, v27
    v_cmp_gt_u32 vcc, 16, v0
    v_add_u32 v27, s85, v27
    v_mov_b32 v246, 0x80000000
    v_cndmask_b32 v27, v246, v27, vcc
    s_add_u32 s83, s83, 524288
    s_min_u32 s83, s83, 3145728
    buffer_load_dword v6, v27, s[20:23], s83 offen
    s_branch L_w1
L_w0:
    s_lshr_b32 s5, s3, 1
    s_and_b32 s85, s37, 3
    s_lshl_b32 s85, s85, 1
    s_add_u32 s85, s85, s5
    s_mul_i32 s85, s85, 25088
    v_mul_u32_u24 v27, 896, v0
    v_cmp_gt_u32 vcc, 28, v0
    v_add_u32 v27, s85, v27
    v_mov_b32 v246, 0x80000000
    v_cndmask_b32 v27, v246, v27, vcc
    s_add_u32 s83, s83, 128
    s_min_u32 s83, s83, 768
    buffer_load_dword v6, v27, s[8:11], s83 offen
L_w1:
    v_and_b32_e64 v240, 15, v0
    v_bfe_u32 v244, v0, 2, 3
    v_lshlrev_b32 v9, 12, v244
    v_and_b32 v246, 1, v244
    v_lshl_add_u32 v9, v246, 3, v9
    v_lshrrev_b32_e64 v246, 1, v244
    v_lshl_add_u32 v9, v246, 6, v9
    v_lshrrev_b32_e64 v246, 5, v0
    v_lshl_add_u32 v9, v246, 9, v9
    v_lshl_add_u32 v9, v243, 4, v9
    v_add_u32 v9, 66560, v9
    v_lshrrev_b32 v244, 1, v240
    v_xor_b32 v244, v244, v241
    v_lshlrev_b32_e64 v244, 4, v244
    v_lshl_add_u32 v244, v240, 7, v244
    v_xor_b32_e64 v246, 64, v244
    s_mul_i32 s4, s3, 6144
    s_add_u32 s4, s4, 133120
    s_lshr_b32 s5, s3, 1
    s_lshl_b32 s5, s5, 11
    s_add_u32 s5, s5, 157696
    v_add_u32_e64 v12, s4, v244
    v_add_u32_e64 v13, s4, v246
    v_add_u32_e64 v14, s5, v244
    v_add_u32_e64 v15, s5, v246
    v_accvgpr_write_b32 a223, v1
    v_lshlrev_b32_e64 v26, 4, v0
    s_mov_b32 s14, 262144
    s_mov_b32 s15, 0x20000
    s_lshl_b32 s81, s3, 11
    s_mul_i32 s71, s3, 2080
    s_lshl4_add_u32 s85, s38, s37
    s_lshl_b32 s85, s85, 18
    s_add_u32 s58, s42, s85
    s_addc_u32 s59, s43, 0
    s_and_b32 s59, s59, 0xffff
    s_add_u32 s60, s44, s85
    s_addc_u32 s61, s45, 0
    s_and_b32 s61, s61, 0xffff
    s_mov_b32 m0, s66
    s_add_u32 s65, s64, 260096
    buffer_load_dwordx4 v4, s[20:23], s65 offen offset:2048 lds
    s_add_u32 s65, s64, 291840
    buffer_load_dwordx4 v4, s[20:23], s65 offen offset:3072 lds
    s_add_u32 m0, s66, 16512
    s_add_u32 s65, s64, 325632
    buffer_load_dwordx4 v4, s[20:23], s65 offen offset:2048 lds
    s_add_u32 s65, s64, 357376
    buffer_load_dwordx4 v4, s[20:23], s65 offen offset:3072 lds
    s_add_u32 s64, s64, 524288
    s_add_u32 s66, s66, s82
    s_sub_u32 s82, 0, s82
    s_mov_b64 s[12:13], s[58:59]
    s_add_u32 s69, s81, 0
    s_add_u32 m0, s71, 99840
    s_nop 0
    buffer_load_dwordx4 v26, s[12:15], s69 offen nt lds
    buffer_load_dwordx4 v26, s[12:15], s69 offen offset:1024 nt lds
    s_add_u32 s69, s81, 8192
    s_add_u32 m0, s71, 108160
    s_nop 0
    buffer_load_dwordx4 v26, s[12:15], s69 offen nt lds
    buffer_load_dwordx4 v26, s[12:15], s69 offen offset:1024 nt lds
    s_cmp_eq_u32 s36, 1
    s_cbranch_scc1 L_odd
    s_waitcnt vmcnt(9)
    s_barrier
    ds_read_b64_tr_b16 v[32:33], v9 offset:0
    ds_read_b64_tr_b16 v[34:35], v9 offset:1024
    ds_read_b64_tr_b16 v[36:37], v9 offset:8
    ds_read_b64_tr_b16 v[38:39], v9 offset:1032
    ds_read_b128 a[236:239], v14 offset:0
    ds_read_b128 a[224:227], v12 offset:0
    ds_read_b64_tr_b16 v[40:41], v9 offset:128
    ds_read_b64_tr_b16 v[42:43], v9 offset:1152
    ds_read_b64_tr_b16 v[44:45], v9 offset:136
    ds_read_b64_tr_b16 v[46:47], v9 offset:1160
    ds_read_b128 a[228:231], v12 offset:2048
    ds_read_b128 a[232:235], v12 offset:4096
    ds_read_b128 a[240:243], v13 offset:0
    ds_read_b128 a[244:247], v13 offset:2048
    ds_read_b128 a[248:251], v13 offset:4096
    ds_read_b128 a[252:255], v15 offset:0
    s_waitcnt lgkmcnt(11)
    v_mfma_f32_16x16x32_bf16 v[216:219], v[32:35], a[236:239], 0
    s_mov_b32 m0, s66
    ds_read_b64_tr_b16 v[48:49], v9 offset:256
    s_add_u32 s65, s64, 0
    v_mfma_f32_16x16x32_bf16 v[64:67], v[36:39], a[236:239], 0
    s_waitcnt lgkmcnt(11)
    ds_read_b64_tr_b16 v[50:51], v9 offset:1280
    v_mfma_f32_16x16x32_bf16 v[120:123], v[32:35], a[224:227], 0
    buffer_load_dwordx4 v4, s[20:23], s65 offen lds
    v_mfma_f32_16x16x32_bf16 v[68:71], v[36:39], a[224:227], 0
    s_waitcnt lgkmcnt(8)
    ds_read_b64_tr_b16 v[52:53], v9 offset:264
    v_mov_b32 v237, 0x80000000
    v_cmp_gt_u32 vcc, 16, v0
    v_lshlrev_b32 v236, 2, v0
    v_mov_b32 v5, 0
    v_cndmask_b32 v3, v237, v236, vcc
    v_cmp_eq_u32 vcc, 0, v0
    v_mfma_f32_16x16x32_bf16 v[220:223], v[40:43], a[236:239], 0
    s_add_u32 s65, s64, 31744
    ds_read_b64_tr_b16 v[54:55], v9 offset:1288
    s_or_b32 s85, s3, s90
    v_mfma_f32_16x16x32_bf16 a[0:3], v[44:47], a[236:239], 0
    buffer_load_dwordx4 v4, s[20:23], s65 offen offset:1024 lds
    v_mfma_f32_16x16x32_bf16 v[128:131], v[40:43], a[224:227], 0
    s_add_u32 s65, s64, 260096
    ds_read_b64_tr_b16 v[56:57], v9 offset:384
    s_cmp_eq_u32 s85, 0
    s_cselect_b32 s53, 0, 0x80000000
    v_cndmask_b32 v11, v237, v5, vcc
    v_mfma_f32_16x16x32_bf16 a[4:7], v[44:47], a[224:227], 0
    s_waitcnt lgkmcnt(10)
    ds_read_b64_tr_b16 v[58:59], v9 offset:1408
    s_and_b32 s89, s37, 1
    v_mfma_f32_16x16x32_bf16 v[152:155], v[32:35], a[228:231], 0
    s_lshl_b32 s95, s3, 6
    ds_read_b64_tr_b16 v[60:61], v9 offset:392
    s_add_u32 s95, s95, 2752512
    v_mfma_f32_16x16x32_bf16 v[72:75], v[36:39], a[228:231], 0
    buffer_load_dwordx4 v4, s[20:23], s65 offen offset:2048 lds
    v_mfma_f32_16x16x32_bf16 v[160:163], v[40:43], a[228:231], 0
    s_add_u32 s65, s64, 291840
    ds_read_b64_tr_b16 v[62:63], v9 offset:1416
    s_lshr_b32 s85, s37, 1
    v_mfma_f32_16x16x32_bf16 a[8:11], v[44:47], a[228:231], 0
    s_waitcnt lgkmcnt(12)
    s_lshl2_add_u32 s95, s85, s95
    s_lshl_b32 s85, s89, 8
    v_mfma_f32_16x16x32_bf16 v[184:187], v[32:35], a[232:235], 0
    s_add_u32 s95, s95, s85
    ds_read_b64_tr_b16 v[32:33], v9 offset:64
    s_mov_b32 s62, 0xccccf0cc
    v_mfma_f32_16x16x32_bf16 v[76:79], v[36:39], a[232:235], 0
    s_waitcnt lgkmcnt(9)
    s_barrier
    v_mfma_f32_16x16x32_bf16 v[192:195], v[40:43], a[232:235], 0
    buffer_load_dwordx4 v4, s[20:23], s65 offen offset:3072 lds
    v_mfma_f32_16x16x32_bf16 a[12:15], v[44:47], a[232:235], 0
    s_waitcnt lgkmcnt(5)
    ds_read_b64_tr_b16 v[34:35], v9 offset:1088
    s_add_u32 m0, s57, 0
    v_mfma_f32_16x16x32_bf16 v[224:227], v[48:51], a[236:239], 0
    s_add_u32 s65, s56, 0
    ds_read_b64_tr_b16 v[36:37], v9 offset:72
    s_mov_b32 s63, 0xcccccccc
    v_mfma_f32_16x16x32_bf16 a[16:19], v[52:55], a[236:239], 0
    buffer_load_dwordx4 v25, s[8:11], s65 offen lds
    v_mfma_f32_16x16x32_bf16 v[136:139], v[48:51], a[224:227], 0
    s_add_u32 m0, s57, 4096
    ds_read_b64_tr_b16 v[38:39], v9 offset:1096
    s_add_u32 s65, s56, 28672
    v_mfma_f32_16x16x32_bf16 a[20:23], v[52:55], a[224:227], 0
    s_mov_b32 s70, 16
    ds_read_b64_tr_b16 v[40:41], v9 offset:192
    s_add_u32 s67, s81, 32768
    v_mfma_f32_16x16x32_bf16 v[168:171], v[48:51], a[228:231], 0
    s_add_u32 s68, s81, 0
    ds_read_b64_tr_b16 v[42:43], v9 offset:1216
    s_and_b32 s85, s37, 14
    v_mfma_f32_16x16x32_bf16 v[16:19], v[52:55], a[228:231], 0
    buffer_load_dwordx4 v25, s[8:11], s65 offen lds
    v_mfma_f32_16x16x32_bf16 v[200:203], v[48:51], a[232:235], 0
    s_add_u32 m0, s57, 8192
    ds_read_b64_tr_b16 v[44:45], v9 offset:200
    s_add_u32 s65, s56, 57344
    v_mfma_f32_16x16x32_bf16 v[20:23], v[52:55], a[232:235], 0
    s_waitcnt lgkmcnt(7)
    ds_read_b64_tr_b16 v[46:47], v9 offset:1224
    s_mul_i32 s85, s85, 229376
    v_mfma_f32_16x16x32_bf16 v[228:231], v[56:59], a[236:239], 0
    s_add_u32 s24, s48, s85
    s_addc_u32 s25, s49, 0
    ds_read_b64_tr_b16 v[48:49], v9 offset:320
    s_and_b32 s25, s25, 0xffff
    v_mfma_f32_16x16x32_bf16 v[232:235], v[60:63], a[236:239], 0
    buffer_load_dwordx4 v25, s[8:11], s65 offen lds
    v_mfma_f32_16x16x32_bf16 v[144:147], v[56:59], a[224:227], 0
    s_add_u32 m0, s57, 12288
    ds_read_b64_tr_b16 v[50:51], v9 offset:1344
    s_add_u32 s65, s56, 86016
    v_mfma_f32_16x16x32_bf16 v[28:31], v[60:63], a[224:227], 0
    s_mov_b32 s26, 458752
    ds_read_b64_tr_b16 v[52:53], v9 offset:328
    s_mov_b32 s27, 0x20000
    v_mfma_f32_16x16x32_bf16 v[176:179], v[56:59], a[228:231], 0
    s_mul_i32 s88, s89, 229376
    ds_read_b64_tr_b16 v[54:55], v9 offset:1352
    s_mul_i32 s74, s3, 4128
    v_mfma_f32_16x16x32_bf16 v[244:247], v[60:63], a[228:231], 0
    buffer_load_dwordx4 v25, s[8:11], s65 offen lds
    v_mfma_f32_16x16x32_bf16 v[208:211], v[56:59], a[232:235], 0
    s_add_u32 m0, s57, 16384
    ds_read_b64_tr_b16 v[56:57], v9 offset:448
    s_add_u32 s65, s56, 114688
    v_mfma_f32_16x16x32_bf16 v[248:251], v[60:63], a[232:235], 0
    s_waitcnt lgkmcnt(9)
    ds_read_b64_tr_b16 v[58:59], v9 offset:1472
    s_mov_b32 s84, 0x3db8aa3b
    v_mfma_f32_16x16x32_bf16 v[124:127], v[32:35], a[224:227], 0
    ds_read_b64_tr_b16 v[60:61], v9 offset:456
    v_bfe_u32 v236, v0, 2, 3
    v_mfma_f32_16x16x32_bf16 v[252:255], v[36:39], a[224:227], 0
    buffer_load_dwordx4 v25, s[8:11], s65 offen lds
    v_mfma_f32_16x16x32_bf16 v[156:159], v[32:35], a[228:231], 0
    s_add_u32 m0, s57, 20480
    ds_read_b64_tr_b16 v[62:63], v9 offset:1480
    v_mul_u32_u24 v2, 2080, v236
    v_mfma_f32_16x16x32_bf16 v[240:243], v[36:39], a[228:231], 0
    s_add_u32 s65, s56, 143360
    s_waitcnt vmcnt(13)
    s_barrier
    v_mfma_f32_16x16x32_bf16 v[188:191], v[32:35], a[232:235], 0
    ds_read_b64_tr_b16 v[32:33], v9 offset:2048
    v_lshrrev_b32 v236, 5, v0
    v_lshl_add_u32 v2, v236, 9, v2
    v_and_b32 v239, 3, v0
    v_lshl_add_u32 v2, v239, 3, v2
    v_mfma_f32_16x16x32_bf16 v[96:99], v[36:39], a[232:235], 0
    s_waitcnt lgkmcnt(9)
    ds_read_b64_tr_b16 v[34:35], v9 offset:3072
    s_mul_i32 s85, s3, 7168
    v_mfma_f32_16x16x32_bf16 v[132:135], v[40:43], a[224:227], 0
    buffer_load_dwordx4 v25, s[8:11], s65 offen lds
    v_mfma_f32_16x16x32_bf16 v[100:103], v[44:47], a[224:227], 0
    s_add_u32 m0, s57, 24576
    ds_read_b64_tr_b16 v[36:37], v9 offset:2056
    s_add_u32 s65, s56, 172032
    v_mfma_f32_16x16x32_bf16 v[164:167], v[40:43], a[228:231], 0
    s_add_u32 s85, s85, s88
    ds_read_b64_tr_b16 v[38:39], v9 offset:3080
    v_lshl_add_u32 v10, v0, 7, s85
    v_mfma_f32_16x16x32_bf16 v[104:107], v[44:47], a[228:231], 0
    buffer_load_dwordx4 v25, s[8:11], s65 offen lds
    v_mfma_f32_16x16x32_bf16 v[196:199], v[40:43], a[232:235], 0
    s_add_u32 s56, s56, 128
    ds_read_b64_tr_b16 v[40:41], v9 offset:2176
    v_and_b32_e64 v238, 7, v0
    v_mfma_f32_16x16x32_bf16 v[80:83], v[44:47], a[232:235], 0
    s_waitcnt lgkmcnt(9)
    ds_read_b64_tr_b16 v[42:43], v9 offset:3200
    v_mul_u32_u24 v1, 2080, v238
    v_bfe_u32 v236, v0, 3, 1
    v_lshl_add_u32 v1, v236, 9, v1
    v_lshrrev_b32_e64 v237, 4, v0
    v_lshl_add_u32 v1, v237, 4, v1
    v_add_u32 v1, 66560, v1
    v_lshrrev_b32_e64 v236, 3, v0
    v_mfma_f32_16x16x32_bf16 v[140:143], v[48:51], a[224:227], 0
    s_add_u32 s69, s81, 16384
    ds_read_b64_tr_b16 v[44:45], v9 offset:2184
    v_mul_u32_u24 v24, 3584, v236
    v_mfma_f32_16x16x32_bf16 v[84:87], v[52:55], a[224:227], 0
    s_add_u32 s83, s83, 128
    ds_read_b64_tr_b16 v[46:47], v9 offset:3208
    v_lshl_add_u32 v24, v238, 4, v24
    v_mfma_f32_16x16x32_bf16 v[172:175], v[48:51], a[228:231], 0
    s_min_u32 s83, s83, 768
    s_add_u32 m0, s66, 16512
    s_add_u32 s65, s64, 65536
    v_mfma_f32_16x16x32_bf16 v[88:91], v[52:55], a[228:231], 0
    buffer_load_dwordx4 v4, s[20:23], s65 offen lds
    v_mfma_f32_16x16x32_bf16 v[204:207], v[48:51], a[232:235], 0
    s_add_u32 s65, s64, 97280
    ds_read_b64_tr_b16 v[48:49], v9 offset:2304
    s_lshl_b32 s85, s3, 12
    v_mfma_f32_16x16x32_bf16 v[92:95], v[52:55], a[232:235], 0
    s_waitcnt lgkmcnt(9)
    ds_read_b64_tr_b16 v[50:51], v9 offset:3328
    s_add_u32 s85, s85, 133120
    v_add_u32_e64 v7, s85, v26
    v_mfma_f32_16x16x32_bf16 v[148:151], v[56:59], a[224:227], 0
    buffer_load_dwordx4 v4, s[20:23], s65 offen offset:1024 lds
    v_mfma_f32_16x16x32_bf16 v[108:111], v[60:63], a[224:227], 0
    s_add_u32 s65, s64, 325632
    ds_read_b64_tr_b16 v[52:53], v9 offset:2312
    s_xor_b32 s86, s3, 1
    v_mfma_f32_16x16x32_bf16 v[180:183], v[56:59], a[228:231], 0
    s_lshl_b32 s86, s86, 12
    ds_read_b64_tr_b16 v[54:55], v9 offset:3336
    s_add_u32 s86, s86, 133120
    v_mfma_f32_16x16x32_bf16 v[112:115], v[60:63], a[228:231], 0
    buffer_load_dwordx4 v4, s[20:23], s65 offen offset:2048 lds
    v_mfma_f32_16x16x32_bf16 v[212:215], v[56:59], a[232:235], 0
    s_add_u32 s65, s64, 357376
    ds_read_b64_tr_b16 v[56:57], v9 offset:2432
    v_add_u32 v8, s86, v26
    v_mfma_f32_16x16x32_bf16 v[116:119], v[60:63], a[232:235], 0
    s_waitcnt lgkmcnt(9)
    ds_read_b64_tr_b16 v[58:59], v9 offset:3456
    v_bfe_u32 v236, v0, 2, 2
    v_mfma_f32_16x16x32_bf16 v[216:219], v[32:35], a[252:255], v[216:219]
    ds_read_b64_tr_b16 v[60:61], v9 offset:2440
    v_mul_u32_u24 v0, 4128, v236
    v_lshl_add_u32 v0, v237, 7, v0
    v_lshl_add_u32 v0, v239, 3, v0
    v_mfma_f32_16x16x32_bf16 v[64:67], v[36:39], a[252:255], v[64:67]
    buffer_load_dwordx4 v4, s[20:23], s65 offen offset:3072 lds
    v_mfma_f32_16x16x32_bf16 v[120:123], v[32:35], a[240:243], v[120:123]
    s_add_u32 m0, s71, 116480
    ds_read_b64_tr_b16 v[62:63], v9 offset:3464
    s_lshl_b32 s85, s3, 5
    v_mfma_f32_16x16x32_bf16 v[68:71], v[36:39], a[240:243], v[68:71]
    v_add_u32_e64 v0, s85, v0
    s_lshr_b32 s75, s37, 1
    v_mfma_f32_16x16x32_bf16 v[152:155], v[32:35], a[244:247], v[152:155]
    s_add_u32 s75, s75, 1
    s_cmp_ge_u32 s75, 7
    s_cselect_b32 s85, 7, 0
    s_sub_u32 s75, s75, s85
    v_mfma_f32_16x16x32_bf16 v[72:75], v[36:39], a[244:247], v[72:75]
    buffer_load_dwordx4 v26, s[12:15], s69 offen nt lds
    v_mfma_f32_16x16x32_bf16 v[184:187], v[32:35], a[248:251], v[184:187]
    s_mul_i32 s80, s3, 28672
    ds_read_b64_tr_b16 v[32:33], v9 offset:2112
    s_lshr_b32 s85, s37, 1
    v_mfma_f32_16x16x32_bf16 v[76:79], v[36:39], a[248:251], v[76:79]
    s_waitcnt lgkmcnt(9)
    ds_read_b64_tr_b16 v[34:35], v9 offset:3136
    s_mul_i32 s85, s85, 3584
    v_mfma_f32_16x16x32_bf16 v[220:223], v[40:43], a[252:255], v[220:223]
    buffer_load_dwordx4 v26, s[12:15], s69 offen offset:1024 nt lds
    v_mfma_f32_16x16x32_bf16 a[0:3], v[44:47], a[252:255], a[0:3]
    buffer_load_dword v6, v27, s[8:11], s83 offen
    v_mfma_f32_16x16x32_bf16 v[128:131], v[40:43], a[240:243], v[128:131]
    s_add_u32 s64, s64, 524288
    ds_read_b64_tr_b16 v[36:37], v9 offset:2120
    s_add_u32 s66, s66, s82
    v_mfma_f32_16x16x32_bf16 a[4:7], v[44:47], a[240:243], a[4:7]
    s_sub_u32 s82, 0, s82
    ds_read_b64_tr_b16 v[38:39], v9 offset:3144
    s_add_u32 s80, s80, s85
    v_mfma_f32_16x16x32_bf16 v[160:163], v[40:43], a[244:247], v[160:163]
    s_mul_i32 s85, s89, 114688
    s_add_u32 s80, s80, s85
    s_mul_i32 s85, s3, 896
    v_mfma_f32_16x16x32_bf16 a[8:11], v[44:47], a[244:247], a[8:11]
    s_add_u32 s88, s88, s85
    s_mov_b32 s72, 66560
    s_mov_b32 s73, 2
    v_mfma_f32_16x16x32_bf16 v[192:195], v[40:43], a[248:251], v[192:195]
    s_mov_b32 s52, 400000
    ds_read_b64_tr_b16 v[40:41], v9 offset:2240
    s_mov_b32 s30, 2756608
    v_mfma_f32_16x16x32_bf16 a[12:15], v[44:47], a[248:251], a[12:15]
    s_waitcnt lgkmcnt(9)
    ds_read_b64_tr_b16 v[42:43], v9 offset:3264
    s_mov_b32 s31, 0x20000
    v_mfma_f32_16x16x32_bf16 v[224:227], v[48:51], a[252:255], v[224:227]
    s_mov_b32 s34, 16
    ds_read_b64_tr_b16 v[44:45], v9 offset:2248
    s_mov_b32 s35, 0x20000
    v_mfma_f32_16x16x32_bf16 a[16:19], v[52:55], a[252:255], a[16:19]
    s_mul_i32 s5, s39, 896
    ds_read_b64_tr_b16 v[46:47], v9 offset:3272
    s_lshr_b32 s87, s37, 1
    v_mfma_f32_16x16x32_bf16 v[136:139], v[48:51], a[240:243], v[136:139]
    s_lshl_b32 s87, s87, 7
    s_add_u32 s5, s5, s87
    s_sub_u32 s18, 401408, s5
    v_mfma_f32_16x16x32_bf16 a[20:23], v[52:55], a[240:243], a[20:23]
    s_mov_b32 s19, 0x20000
    s_lshl3_add_u32 s86, s39, s38
    s_mul_i32 s85, s86, 2756608
    v_mfma_f32_16x16x32_bf16 v[168:171], v[48:51], a[244:247], v[168:171]
    s_add_u32 s28, s50, s85
    s_addc_u32 s29, s51, 0
    s_and_b32 s29, s29, 0xffff
    s_lshl_b32 s85, s86, 4
    v_mfma_f32_16x16x32_bf16 v[16:19], v[52:55], a[244:247], v[16:19]
    s_add_u32 s32, s78, s85
    s_addc_u32 s33, s79, 0
    s_and_b32 s33, s33, 0xffff
    s_lshl_b32 s85, s37, 8
    v_mfma_f32_16x16x32_bf16 v[200:203], v[48:51], a[248:251], v[200:203]
    s_add_u32 s85, s85, 2752512
    ds_read_b64_tr_b16 v[48:49], v9 offset:2368
    v_lshrrev_b32_e64 v236, 2, v26
    v_mfma_f32_16x16x32_bf16 v[20:23], v[52:55], a[248:251], v[20:23]
    s_waitcnt lgkmcnt(9)
    ds_read_b64_tr_b16 v[50:51], v9 offset:3392
    v_or_b32 v236, s53, v236
    v_mfma_f32_16x16x32_bf16 v[228:231], v[56:59], a[252:255], v[228:231]
    ds_read_b64_tr_b16 v[52:53], v9 offset:2376
    v_mfma_f32_16x16x32_bf16 v[232:235], v[60:63], a[252:255], v[232:235]
    ds_read_b64_tr_b16 v[54:55], v9 offset:3400
    v_mfma_f32_16x16x32_bf16 v[144:147], v[56:59], a[240:243], v[144:147]
    buffer_store_dword v5, v236, s[28:31], s85 offen sc1
    v_mfma_f32_16x16x32_bf16 v[28:31], v[60:63], a[240:243], v[28:31]
    s_mul_i32 s85, s38, 401408
    s_add_u32 s85, s85, s5
    s_add_u32 s16, s76, s85
    s_addc_u32 s17, s77, 0
    v_mfma_f32_16x16x32_bf16 v[176:179], v[56:59], a[244:247], v[176:179]
    s_and_b32 s17, s17, 0xffff
    s_mov_b32 s76, s75
    s_mul_i32 s85, s38, 28672
    v_mfma_f32_16x16x32_bf16 v[244:247], v[60:63], a[244:247], v[244:247]
    v_add_u32 v10, s85, v10
    v_cmp_gt_u32 vcc, 192, v26
    v_mfma_f32_16x16x32_bf16 v[208:211], v[56:59], a[248:251], v[208:211]
    ds_read_b64_tr_b16 v[56:57], v9 offset:2496
    v_mov_b32 v5, 0x80000000
    v_mfma_f32_16x16x32_bf16 v[248:251], v[60:63], a[248:251], v[248:251]
    s_waitcnt lgkmcnt(9)
    ds_read_b64_tr_b16 v[58:59], v9 offset:3520
    s_nop 0
    v_mfma_f32_16x16x32_bf16 v[124:127], v[32:35], a[240:243], v[124:127]
    ds_read_b64_tr_b16 v[60:61], v9 offset:2504
    v_cndmask_b32 v10, v5, v10, vcc
    v_mfma_f32_16x16x32_bf16 v[252:255], v[36:39], a[240:243], v[252:255]
    ds_read_b64_tr_b16 v[62:63], v9 offset:3528
    v_add_u32 v9, s82, v9
    v_mfma_f32_16x16x32_bf16 v[156:159], v[32:35], a[244:247], v[156:159]
    v_mov_b32 v5, 1
    v_accvgpr_write_b32 a24, 0
    v_accvgpr_write_b32 a25, 0
    v_accvgpr_write_b32 a26, 0
    v_accvgpr_write_b32 a27, 0
    v_accvgpr_write_b32 a28, 0
    v_accvgpr_write_b32 a29, 0
    v_accvgpr_write_b32 a30, 0
    v_mfma_f32_16x16x32_bf16 v[240:243], v[36:39], a[244:247], v[240:243]
    v_accvgpr_write_b32 a31, 0
    v_accvgpr_write_b32 a32, 0
    v_mfma_f32_16x16x32_bf16 v[188:191], v[32:35], a[248:251], v[188:191]
    v_accvgpr_write_b32 a33, 0
    v_accvgpr_write_b32 a34, 0
    v_mfma_f32_16x16x32_bf16 v[96:99], v[36:39], a[248:251], v[96:99]
    s_waitcnt vmcnt(4) lgkmcnt(0)
    s_barrier
    v_mfma_f32_16x16x32_bf16 v[132:135], v[40:43], a[240:243], v[132:135]
    ds_read_b64_tr_b16 v[32:33], v9 offset:0
    v_accvgpr_write_b32 a35, 0
    v_mfma_f32_16x16x32_bf16 v[100:103], v[44:47], a[240:243], v[100:103]
    ds_read_b64_tr_b16 v[34:35], v9 offset:1024
    v_accvgpr_write_b32 a36, 0
    v_mfma_f32_16x16x32_bf16 v[164:167], v[40:43], a[244:247], v[164:167]
    ds_read_b64_tr_b16 v[36:37], v9 offset:2048
    v_accvgpr_write_b32 a37, 0
    v_accvgpr_write_b32 a38, 0
    v_accvgpr_write_b32 a39, 0
    v_accvgpr_write_b32 a40, 0
    v_accvgpr_write_b32 a41, 0
    v_accvgpr_write_b32 a42, 0
    v_accvgpr_write_b32 a43, 0
    v_mfma_f32_16x16x32_bf16 v[104:107], v[44:47], a[244:247], v[104:107]
    ds_read_b64_tr_b16 v[38:39], v9 offset:3072
    v_accvgpr_write_b32 a44, 0
    v_mfma_f32_16x16x32_bf16 v[196:199], v[40:43], a[248:251], v[196:199]
    ds_read_b128 a[236:239], v14 offset:0
    v_accvgpr_write_b32 a45, 0
    v_mfma_f32_16x16x32_bf16 v[80:83], v[44:47], a[248:251], v[80:83]
    ds_read_b128 a[252:255], v15 offset:0
    v_accvgpr_write_b32 a46, 0
    v_mfma_f32_16x16x32_bf16 v[140:143], v[48:51], a[240:243], v[140:143]
    ds_read_b64_tr_b16 v[40:41], v9 offset:8
    v_accvgpr_write_b32 a47, 0
    v_accvgpr_write_b32 a48, 0
    v_accvgpr_write_b32 a49, 0
    v_accvgpr_write_b32 a50, 0
    v_accvgpr_write_b32 a51, 0
    v_accvgpr_write_b32 a52, 0
    v_accvgpr_write_b32 a53, 0
    v_mfma_f32_16x16x32_bf16 v[84:87], v[52:55], a[240:243], v[84:87]
    ds_read_b64_tr_b16 v[42:43], v9 offset:1032
    v_accvgpr_write_b32 a54, 0
    v_mfma_f32_16x16x32_bf16 v[148:151], v[56:59], a[240:243], v[148:151]
    ds_read_b64_tr_b16 v[44:45], v9 offset:2056
    v_accvgpr_write_b32 a55, 0
    v_mfma_f32_16x16x32_bf16 v[108:111], v[60:63], a[240:243], v[108:111]
    ds_read_b128 a[224:227], v12 offset:0
    v_accvgpr_write_b32 a56, 0
    v_accvgpr_write_b32 a57, 0
    v_accvgpr_write_b32 a58, 0
    v_accvgpr_write_b32 a59, 0
    v_accvgpr_write_b32 a60, 0
    v_accvgpr_write_b32 a61, 0
    v_accvgpr_write_b32 a62, 0
    v_mfma_f32_16x16x32_bf16 v[172:175], v[48:51], a[244:247], v[172:175]
    ds_read_b128 a[240:243], v13 offset:0
    v_accvgpr_write_b32 a63, 0
    v_mfma_f32_16x16x32_bf16 v[88:91], v[52:55], a[244:247], v[88:91]
    ds_read_b64_tr_b16 v[46:47], v9 offset:3080
    v_accvgpr_write_b32 a64, 0
    v_mfma_f32_16x16x32_bf16 v[180:183], v[56:59], a[244:247], v[180:183]
    v_accvgpr_write_b32 a65, 0
    v_accvgpr_write_b32 a66, 0
    v_mfma_f32_16x16x32_bf16 v[112:115], v[60:63], a[244:247], v[112:115]
    ds_read_b128 a[228:231], v12 offset:2048
    v_accvgpr_write_b32 a67, 0
    v_mfma_f32_16x16x32_bf16 v[204:207], v[48:51], a[248:251], v[204:207]
    ds_read_b128 a[244:247], v13 offset:2048
    v_accvgpr_write_b32 a68, 0
    v_mfma_f32_16x16x32_bf16 v[92:95], v[52:55], a[248:251], v[92:95]
    v_accvgpr_write_b32 a69, 0
    v_accvgpr_write_b32 a70, 0
    v_mfma_f32_16x16x32_bf16 v[212:215], v[56:59], a[248:251], v[212:215]
    v_accvgpr_write_b32 a71, 0
    v_accvgpr_write_b32 a72, 0
    v_mfma_f32_16x16x32_bf16 v[116:119], v[60:63], a[248:251], v[116:119]
    ds_read_b128 a[232:235], v12 offset:4096
    v_accvgpr_write_b32 a73, 0
    ds_read_b128 a[248:251], v13 offset:4096
    v_accvgpr_write_b32 a74, 0
    v_accvgpr_write_b32 a75, 0
    v_accvgpr_write_b32 a76, 0
    v_accvgpr_write_b32 a77, 0
    v_accvgpr_write_b32 a78, 0
    v_accvgpr_write_b32 a79, 0
    v_accvgpr_write_b32 a80, 0
    v_accvgpr_write_b32 a81, 0
    v_accvgpr_write_b32 a82, 0
    v_accvgpr_write_b32 a83, 0
    v_accvgpr_write_b32 a84, 0
    v_accvgpr_write_b32 a85, 0
    v_accvgpr_write_b32 a86, 0
    v_accvgpr_write_b32 a87, 0
    v_accvgpr_write_b32 a88, 0
    v_accvgpr_write_b32 a89, 0
    v_accvgpr_write_b32 a90, 0
    v_accvgpr_write_b32 a91, 0
    v_accvgpr_write_b32 a92, 0
    v_accvgpr_write_b32 a93, 0
    v_accvgpr_write_b32 a94, 0
    v_accvgpr_write_b32 a95, 0
    v_accvgpr_write_b32 a96, 0
    v_accvgpr_write_b32 a97, 0
    v_accvgpr_write_b32 a98, 0
    v_accvgpr_write_b32 a99, 0
    v_accvgpr_write_b32 a100, 0
    v_accvgpr_write_b32 a101, 0
    v_accvgpr_write_b32 a102, 0
    v_accvgpr_write_b32 a103, 0
    v_accvgpr_write_b32 a104, 0
    v_accvgpr_write_b32 a105, 0
    v_accvgpr_write_b32 a106, 0
    v_accvgpr_write_b32 a107, 0
    v_accvgpr_write_b32 a108, 0
    v_accvgpr_write_b32 a109, 0
    v_accvgpr_write_b32 a110, 0
    v_accvgpr_write_b32 a111, 0
    v_accvgpr_write_b32 a112, 0
    v_accvgpr_write_b32 a113, 0
    v_accvgpr_write_b32 a114, 0
    v_accvgpr_write_b32 a115, 0
    v_accvgpr_write_b32 a116, 0
    v_accvgpr_write_b32 a117, 0
    v_accvgpr_write_b32 a118, 0
    v_accvgpr_write_b32 a119, 0
    v_accvgpr_write_b32 a120, 0
    v_accvgpr_write_b32 a121, 0
    v_accvgpr_write_b32 a122, 0
    v_accvgpr_write_b32 a123, 0
    s_waitcnt lgkmcnt(10)
    v_mfma_f32_16x16x32_bf16 v[216:219], v[32:35], a[236:239], v[216:219]
    s_mov_b32 m0, s66
    ds_read_b64_tr_b16 v[48:49], v9 offset:128
    s_add_u32 s65, s64, 0
    v_mfma_f32_16x16x32_bf16 v[216:219], v[36:39], a[252:255], v[216:219]
    s_waitcnt lgkmcnt(6)
    ds_read_b64_tr_b16 v[50:51], v9 offset:1152
    v_mfma_f32_16x16x32_bf16 v[120:123], v[32:35], a[224:227], v[120:123]
    buffer_load_dwordx4 v4, s[20:23], s65 offen lds
    v_mfma_f32_16x16x32_bf16 v[120:123], v[36:39], a[240:243], v[120:123]
    s_waitcnt lgkmcnt(6)
    ds_read_b64_tr_b16 v[52:53], v9 offset:2176
    v_accvgpr_write_b32 a124, 0
    v_accvgpr_write_b32 a125, 0
    v_accvgpr_write_b32 a126, 0
    v_accvgpr_write_b32 a127, 0
    v_accvgpr_write_b32 a128, 0
    v_accvgpr_write_b32 a129, 0
    v_accvgpr_write_b32 a130, 0
    v_mfma_f32_16x16x32_bf16 v[64:67], v[40:43], a[236:239], v[64:67]
    s_add_u32 s65, s64, 31744
    ds_read_b64_tr_b16 v[54:55], v9 offset:3200
    v_mfma_f32_16x16x32_bf16 v[64:67], v[44:47], a[252:255], v[64:67]
    buffer_load_dwordx4 v4, s[20:23], s65 offen offset:1024 lds
    v_mfma_f32_16x16x32_bf16 v[68:71], v[40:43], a[224:227], v[68:71]
    s_add_u32 s65, s64, 260096
    ds_read_b64_tr_b16 v[56:57], v9 offset:136
    v_mfma_f32_16x16x32_bf16 v[68:71], v[44:47], a[240:243], v[68:71]
    s_waitcnt lgkmcnt(7)
    ds_read_b64_tr_b16 v[58:59], v9 offset:1160
    v_mfma_f32_16x16x32_bf16 v[152:155], v[32:35], a[228:231], v[152:155]
    ds_read_b64_tr_b16 v[60:61], v9 offset:2184
    v_mfma_f32_16x16x32_bf16 v[152:155], v[36:39], a[244:247], v[152:155]
    buffer_load_dwordx4 v4, s[20:23], s65 offen offset:2048 lds
    v_mfma_f32_16x16x32_bf16 v[72:75], v[40:43], a[228:231], v[72:75]
    s_add_u32 s65, s64, 291840
    ds_read_b64_tr_b16 v[62:63], v9 offset:3208
    v_accvgpr_write_b32 a131, 0
    v_mfma_f32_16x16x32_bf16 v[72:75], v[44:47], a[244:247], v[72:75]
    s_waitcnt lgkmcnt(8)
    v_accvgpr_write_b32 a132, 0
    v_accvgpr_write_b32 a133, 0
    v_mfma_f32_16x16x32_bf16 v[184:187], v[32:35], a[232:235], v[184:187]
    ds_read_b64_tr_b16 v[32:33], v9 offset:256
    v_accvgpr_write_b32 a134, 0
    v_mfma_f32_16x16x32_bf16 v[184:187], v[36:39], a[248:251], v[184:187]
    s_barrier
    v_mfma_f32_16x16x32_bf16 v[76:79], v[40:43], a[232:235], v[76:79]
    buffer_load_dwordx4 v4, s[20:23], s65 offen offset:3072 lds
    v_mfma_f32_16x16x32_bf16 v[76:79], v[44:47], a[248:251], v[76:79]
    s_waitcnt lgkmcnt(5)
    ds_read_b64_tr_b16 v[34:35], v9 offset:1280
    v_accvgpr_write_b32 a135, 0
    v_mfma_f32_16x16x32_bf16 v[220:223], v[48:51], a[236:239], v[220:223]
    s_add_u32 m0, s57, 0
    ds_read_b64_tr_b16 v[36:37], v9 offset:2304
    v_accvgpr_write_b32 a136, 0
    v_accvgpr_write_b32 a137, 0
    v_accvgpr_write_b32 a138, 0
    v_accvgpr_write_b32 a139, 0
    v_accvgpr_write_b32 a140, 0
    v_accvgpr_write_b32 a141, 0
    v_accvgpr_write_b32 a142, 0
    v_mfma_f32_16x16x32_bf16 v[220:223], v[52:55], a[252:255], v[220:223]
    s_add_u32 s65, s56, 0
    ds_read_b64_tr_b16 v[38:39], v9 offset:3328
    v_accvgpr_write_b32 a143, 0
    v_mfma_f32_16x16x32_bf16 v[128:131], v[48:51], a[224:227], v[128:131]
    buffer_load_dwordx4 v25, s[8:11], s65 offen lds
    v_mfma_f32_16x16x32_bf16 v[128:131], v[52:55], a[240:243], v[128:131]
    s_add_u32 m0, s57, 4096
    ds_read_b64_tr_b16 v[40:41], v9 offset:264
    v_accvgpr_write_b32 a144, 0
    v_mfma_f32_16x16x32_bf16 v[160:163], v[48:51], a[228:231], v[160:163]
    s_add_u32 s65, s56, 28672
    ds_read_b64_tr_b16 v[42:43], v9 offset:1288
    v_mfma_f32_16x16x32_bf16 v[160:163], v[52:55], a[244:247], v[160:163]
    buffer_load_dwordx4 v25, s[8:11], s65 offen lds
    v_mfma_f32_16x16x32_bf16 v[192:195], v[48:51], a[232:235], v[192:195]
    s_add_u32 m0, s57, 8192
    ds_read_b64_tr_b16 v[44:45], v9 offset:2312
    s_add_u32 s65, s56, 57344
    v_mfma_f32_16x16x32_bf16 v[192:195], v[52:55], a[248:251], v[192:195]
    s_waitcnt lgkmcnt(7)
    ds_read_b64_tr_b16 v[46:47], v9 offset:3336
    v_accvgpr_write_b32 a145, 0
    v_accvgpr_write_b32 a146, 0
    v_accvgpr_write_b32 a147, 0
    v_accvgpr_write_b32 a148, 0
    v_accvgpr_write_b32 a149, 0
    v_accvgpr_write_b32 a150, 0
    v_accvgpr_write_b32 a151, 0
    v_mfma_f32_16x16x32_bf16 a[0:3], v[56:59], a[236:239], a[0:3]
    ds_read_b64_tr_b16 v[48:49], v9 offset:384
    v_mfma_f32_16x16x32_bf16 a[0:3], v[60:63], a[252:255], a[0:3]
    buffer_load_dwordx4 v25, s[8:11], s65 offen lds
    v_mfma_f32_16x16x32_bf16 a[4:7], v[56:59], a[224:227], a[4:7]
    s_add_u32 m0, s57, 12288
    ds_read_b64_tr_b16 v[50:51], v9 offset:1408
    s_add_u32 s65, s56, 86016
    v_mfma_f32_16x16x32_bf16 a[4:7], v[60:63], a[240:243], a[4:7]
    ds_read_b64_tr_b16 v[52:53], v9 offset:2432
    v_mfma_f32_16x16x32_bf16 a[8:11], v[56:59], a[228:231], a[8:11]
    ds_read_b64_tr_b16 v[54:55], v9 offset:3456
    v_mfma_f32_16x16x32_bf16 a[8:11], v[60:63], a[244:247], a[8:11]
    buffer_load_dwordx4 v25, s[8:11], s65 offen lds
    v_mfma_f32_16x16x32_bf16 a[12:15], v[56:59], a[232:235], a[12:15]
    s_add_u32 m0, s57, 16384
    ds_read_b64_tr_b16 v[56:57], v9 offset:392
    v_accvgpr_write_b32 a152, 0
    v_accvgpr_write_b32 a153, 0
    v_accvgpr_write_b32 a154, 0
    v_accvgpr_write_b32 a155, 0
    v_accvgpr_write_b32 a156, 0
    v_accvgpr_write_b32 a157, 0
    v_accvgpr_write_b32 a158, 0
    v_mfma_f32_16x16x32_bf16 a[12:15], v[60:63], a[248:251], a[12:15]
    s_waitcnt lgkmcnt(9)
    ds_read_b64_tr_b16 v[58:59], v9 offset:1416
    s_add_u32 s65, s56, 114688
    v_mfma_f32_16x16x32_bf16 v[224:227], v[32:35], a[236:239], v[224:227]
    ds_read_b64_tr_b16 v[60:61], v9 offset:2440
    v_mfma_f32_16x16x32_bf16 v[224:227], v[36:39], a[252:255], v[224:227]
    buffer_load_dwordx4 v25, s[8:11], s65 offen lds
    v_mfma_f32_16x16x32_bf16 v[136:139], v[32:35], a[224:227], v[136:139]
    s_add_u32 m0, s57, 20480
    ds_read_b64_tr_b16 v[62:63], v9 offset:3464
    s_add_u32 s65, s56, 143360
    v_mfma_f32_16x16x32_bf16 v[136:139], v[36:39], a[240:243], v[136:139]
    v_mfma_f32_16x16x32_bf16 v[168:171], v[32:35], a[228:231], v[168:171]
    v_mfma_f32_16x16x32_bf16 v[168:171], v[36:39], a[244:247], v[168:171]
    buffer_load_dwordx4 v25, s[8:11], s65 offen lds
    v_mfma_f32_16x16x32_bf16 v[200:203], v[32:35], a[232:235], v[200:203]
    s_add_u32 m0, s57, 24576
    ds_read_b64_tr_b16 v[32:33], v9 offset:64
    v_accvgpr_write_b32 a159, 0
    v_mfma_f32_16x16x32_bf16 v[200:203], v[36:39], a[248:251], v[200:203]
    s_waitcnt lgkmcnt(9)
    ds_read_b64_tr_b16 v[34:35], v9 offset:1088
    v_accvgpr_write_b32 a160, 0
    v_mfma_f32_16x16x32_bf16 a[16:19], v[40:43], a[236:239], a[16:19]
    s_add_u32 s65, s56, 172032
    ds_read_b64_tr_b16 v[36:37], v9 offset:2112
    v_accvgpr_write_b32 a161, 0
    v_mfma_f32_16x16x32_bf16 a[16:19], v[44:47], a[252:255], a[16:19]
    buffer_load_dwordx4 v25, s[8:11], s65 offen lds
    v_mfma_f32_16x16x32_bf16 a[20:23], v[40:43], a[224:227], a[20:23]
    s_add_u32 s56, s56, 128
    ds_read_b64_tr_b16 v[38:39], v9 offset:3136
    v_accvgpr_write_b32 a162, 0
    v_mfma_f32_16x16x32_bf16 a[20:23], v[44:47], a[240:243], a[20:23]
    s_add_u32 s69, s81, 24576
    v_accvgpr_write_b32 a163, 0
    v_accvgpr_write_b32 a164, 0
    v_mfma_f32_16x16x32_bf16 v[16:19], v[40:43], a[228:231], v[16:19]
    s_add_u32 s83, s83, 128
    v_accvgpr_write_b32 a165, 0
    v_accvgpr_write_b32 a166, 0
    v_accvgpr_write_b32 a167, 0
    v_accvgpr_write_b32 a168, 0
    v_accvgpr_write_b32 a169, 0
    v_accvgpr_write_b32 a170, 0
    v_accvgpr_write_b32 a171, 0
    v_accvgpr_write_b32 a172, 0
    v_mfma_f32_16x16x32_bf16 v[16:19], v[44:47], a[244:247], v[16:19]
    s_min_u32 s83, s83, 768
    s_add_u32 m0, s66, 16512
    s_add_u32 s65, s64, 65536
    v_mfma_f32_16x16x32_bf16 v[20:23], v[40:43], a[232:235], v[20:23]
    buffer_load_dwordx4 v4, s[20:23], s65 offen lds
    v_mfma_f32_16x16x32_bf16 v[20:23], v[44:47], a[248:251], v[20:23]
    s_waitcnt lgkmcnt(8)
    ds_read_b64_tr_b16 v[40:41], v9 offset:72
    s_add_u32 s65, s64, 97280
    v_mfma_f32_16x16x32_bf16 v[228:231], v[48:51], a[236:239], v[228:231]
    ds_read_b64_tr_b16 v[42:43], v9 offset:1096
    v_mfma_f32_16x16x32_bf16 v[228:231], v[52:55], a[252:255], v[228:231]
    buffer_load_dwordx4 v4, s[20:23], s65 offen offset:1024 lds
    v_mfma_f32_16x16x32_bf16 v[144:147], v[48:51], a[224:227], v[144:147]
    s_add_u32 s65, s64, 325632
    ds_read_b64_tr_b16 v[44:45], v9 offset:2120
    v_mfma_f32_16x16x32_bf16 v[144:147], v[52:55], a[240:243], v[144:147]
    ds_read_b64_tr_b16 v[46:47], v9 offset:3144
    v_accvgpr_write_b32 a173, 0
    v_accvgpr_write_b32 a174, 0
    v_accvgpr_write_b32 a175, 0
    v_accvgpr_write_b32 a176, 0
    v_accvgpr_write_b32 a177, 0
    v_accvgpr_write_b32 a178, 0
    v_accvgpr_write_b32 a179, 0
    v_mfma_f32_16x16x32_bf16 v[176:179], v[48:51], a[228:231], v[176:179]
    v_mfma_f32_16x16x32_bf16 v[176:179], v[52:55], a[244:247], v[176:179]
    buffer_load_dwordx4 v4, s[20:23], s65 offen offset:2048 lds
    v_mfma_f32_16x16x32_bf16 v[208:211], v[48:51], a[232:235], v[208:211]
    s_add_u32 s65, s64, 357376
    ds_read_b64_tr_b16 v[48:49], v9 offset:192
    v_mfma_f32_16x16x32_bf16 v[208:211], v[52:55], a[248:251], v[208:211]
    s_waitcnt lgkmcnt(9)
    ds_read_b64_tr_b16 v[50:51], v9 offset:1216
    v_mfma_f32_16x16x32_bf16 v[232:235], v[56:59], a[236:239], v[232:235]
    ds_read_b64_tr_b16 v[52:53], v9 offset:2240
    v_mfma_f32_16x16x32_bf16 v[232:235], v[60:63], a[252:255], v[232:235]
    buffer_load_dwordx4 v4, s[20:23], s65 offen offset:3072 lds
    v_mfma_f32_16x16x32_bf16 v[28:31], v[56:59], a[224:227], v[28:31]
    s_add_u32 m0, s71, 124800
    ds_read_b64_tr_b16 v[54:55], v9 offset:3264
    v_accvgpr_write_b32 a180, 0
    v_accvgpr_write_b32 a181, 0
    v_accvgpr_write_b32 a182, 0
    v_accvgpr_write_b32 a183, 0
    v_accvgpr_write_b32 a184, 0
    v_accvgpr_write_b32 a185, 0
    v_accvgpr_write_b32 a186, 0
    v_mfma_f32_16x16x32_bf16 v[28:31], v[60:63], a[240:243], v[28:31]
    v_mfma_f32_16x16x32_bf16 v[244:247], v[56:59], a[228:231], v[244:247]
    v_mfma_f32_16x16x32_bf16 v[244:247], v[60:63], a[244:247], v[244:247]
    buffer_load_dwordx4 v26, s[12:15], s69 offen nt lds
    v_mfma_f32_16x16x32_bf16 v[248:251], v[56:59], a[232:235], v[248:251]
    ds_read_b64_tr_b16 v[56:57], v9 offset:200
    v_mfma_f32_16x16x32_bf16 v[248:251], v[60:63], a[248:251], v[248:251]
    s_waitcnt lgkmcnt(9)
    ds_read_b64_tr_b16 v[58:59], v9 offset:1224
    v_mfma_f32_16x16x32_bf16 v[124:127], v[32:35], a[224:227], v[124:127]
    buffer_load_dwordx4 v26, s[12:15], s69 offen offset:1024 nt lds
    v_mfma_f32_16x16x32_bf16 v[124:127], v[36:39], a[240:243], v[124:127]
    buffer_load_dword v6, v27, s[8:11], s83 offen
    v_mfma_f32_16x16x32_bf16 v[156:159], v[32:35], a[228:231], v[156:159]
    ds_read_b64_tr_b16 v[60:61], v9 offset:2248
    v_accvgpr_write_b32 a187, 0
    v_mfma_f32_16x16x32_bf16 v[156:159], v[36:39], a[244:247], v[156:159]
    buffer_load_dword v6, v10, s[24:27], 0 offen
    v_mfma_f32_16x16x32_bf16 v[188:191], v[32:35], a[232:235], v[188:191]
    ds_read_b64_tr_b16 v[62:63], v9 offset:3272
    v_add_u32 v10, 1536, v10
    v_mfma_f32_16x16x32_bf16 v[188:191], v[36:39], a[248:251], v[188:191]
    s_waitcnt lgkmcnt(8)
    ds_read_b64_tr_b16 v[32:33], v9 offset:320
    s_add_u32 s64, s64, 524288
    v_mfma_f32_16x16x32_bf16 v[252:255], v[40:43], a[224:227], v[252:255]
    s_add_u32 s66, s66, s82
    ds_read_b64_tr_b16 v[34:35], v9 offset:1344
    s_sub_u32 s82, 0, s82
    v_mfma_f32_16x16x32_bf16 v[252:255], v[44:47], a[240:243], v[252:255]
    ds_read_b64_tr_b16 v[36:37], v9 offset:2368
    v_accvgpr_write_b32 a188, 0
    v_mfma_f32_16x16x32_bf16 v[240:243], v[40:43], a[228:231], v[240:243]
    ds_read_b64_tr_b16 v[38:39], v9 offset:3392
    v_accvgpr_write_b32 a189, 0
    v_accvgpr_write_b32 a190, 0
    v_accvgpr_write_b32 a191, 0
    v_accvgpr_write_b32 a192, 0
    v_accvgpr_write_b32 a193, 0
    v_accvgpr_write_b32 a194, 0
    v_accvgpr_write_b32 a195, 0
    v_mfma_f32_16x16x32_bf16 v[240:243], v[44:47], a[244:247], v[240:243]
    v_accvgpr_write_b32 a196, 0
    v_accvgpr_write_b32 a197, 0
    v_mfma_f32_16x16x32_bf16 v[96:99], v[40:43], a[232:235], v[96:99]
    ds_read_b64_tr_b16 v[40:41], v9 offset:328
    v_accvgpr_write_b32 a198, 0
    v_mfma_f32_16x16x32_bf16 v[96:99], v[44:47], a[248:251], v[96:99]
    s_waitcnt lgkmcnt(9)
    ds_read_b64_tr_b16 v[42:43], v9 offset:1352
    v_accvgpr_write_b32 a199, 0
    v_mfma_f32_16x16x32_bf16 v[132:135], v[48:51], a[224:227], v[132:135]
    ds_read_b64_tr_b16 v[44:45], v9 offset:2376
    v_accvgpr_write_b32 a200, 0
    v_mfma_f32_16x16x32_bf16 v[132:135], v[52:55], a[240:243], v[132:135]
    ds_read_b64_tr_b16 v[46:47], v9 offset:3400
    v_mfma_f32_16x16x32_bf16 v[164:167], v[48:51], a[228:231], v[164:167]
    v_mfma_f32_16x16x32_bf16 v[164:167], v[52:55], a[244:247], v[164:167]
    v_accvgpr_write_b32 a201, 0
    v_accvgpr_write_b32 a202, 0
    v_accvgpr_write_b32 a203, 0
    v_accvgpr_write_b32 a204, 0
    v_accvgpr_write_b32 a205, 0
    v_accvgpr_write_b32 a206, 0
    v_accvgpr_write_b32 a207, 0
    v_mfma_f32_16x16x32_bf16 v[196:199], v[48:51], a[232:235], v[196:199]
    ds_read_b64_tr_b16 v[48:49], v9 offset:448
    v_mfma_f32_16x16x32_bf16 v[196:199], v[52:55], a[248:251], v[196:199]
    s_waitcnt lgkmcnt(9)
    ds_read_b64_tr_b16 v[50:51], v9 offset:1472
    v_mfma_f32_16x16x32_bf16 v[100:103], v[56:59], a[224:227], v[100:103]
    ds_read_b64_tr_b16 v[52:53], v9 offset:2496
    v_mfma_f32_16x16x32_bf16 v[100:103], v[60:63], a[240:243], v[100:103]
    ds_read_b64_tr_b16 v[54:55], v9 offset:3520
    v_mfma_f32_16x16x32_bf16 v[104:107], v[56:59], a[228:231], v[104:107]
    v_mfma_f32_16x16x32_bf16 v[104:107], v[60:63], a[244:247], v[104:107]
    v_mfma_f32_16x16x32_bf16 v[80:83], v[56:59], a[232:235], v[80:83]
    ds_read_b64_tr_b16 v[56:57], v9 offset:456
    v_accvgpr_write_b32 a208, 0
    v_accvgpr_write_b32 a209, 0
    v_accvgpr_write_b32 a210, 0
    v_accvgpr_write_b32 a211, 0
    v_accvgpr_write_b32 a212, 0
    v_accvgpr_write_b32 a213, 0
    v_accvgpr_write_b32 a214, 0
    v_mfma_f32_16x16x32_bf16 v[80:83], v[60:63], a[248:251], v[80:83]
    s_waitcnt lgkmcnt(9)
    ds_read_b64_tr_b16 v[58:59], v9 offset:1480
    v_mfma_f32_16x16x32_bf16 v[140:143], v[32:35], a[224:227], v[140:143]
    ds_read_b64_tr_b16 v[60:61], v9 offset:2504
    v_mfma_f32_16x16x32_bf16 v[140:143], v[36:39], a[240:243], v[140:143]
    ds_read_b64_tr_b16 v[62:63], v9 offset:3528
    v_add_u32 v9, s82, v9
    v_mfma_f32_16x16x32_bf16 v[172:175], v[32:35], a[228:231], v[172:175]
    v_mfma_f32_16x16x32_bf16 v[172:175], v[36:39], a[244:247], v[172:175]
    v_mfma_f32_16x16x32_bf16 v[204:207], v[32:35], a[232:235], v[204:207]
    v_mfma_f32_16x16x32_bf16 v[204:207], v[36:39], a[248:251], v[204:207]
    s_waitcnt vmcnt(4) lgkmcnt(0)
    s_barrier
    v_mfma_f32_16x16x32_bf16 v[84:87], v[40:43], a[224:227], v[84:87]
    ds_read_b64_tr_b16 v[32:33], v9 offset:0
    v_accvgpr_write_b32 a215, 0
    v_mfma_f32_16x16x32_bf16 v[84:87], v[44:47], a[240:243], v[84:87]
    ds_read_b64_tr_b16 v[34:35], v9 offset:1024
    v_accvgpr_write_b32 a216, 0
    v_mfma_f32_16x16x32_bf16 v[88:91], v[40:43], a[228:231], v[88:91]
    ds_read_b64_tr_b16 v[36:37], v9 offset:2048
    v_accvgpr_write_b32 a217, 0
    v_mfma_f32_16x16x32_bf16 v[88:91], v[44:47], a[244:247], v[88:91]
    ds_read_b64_tr_b16 v[38:39], v9 offset:3072
    v_accvgpr_write_b32 a218, 0
    v_mfma_f32_16x16x32_bf16 v[92:95], v[40:43], a[232:235], v[92:95]
    ds_read_b128 a[236:239], v14 offset:0
    v_accvgpr_write_b32 a219, 0
    v_mfma_f32_16x16x32_bf16 v[92:95], v[44:47], a[248:251], v[92:95]
    ds_read_b128 a[252:255], v15 offset:0
    v_accvgpr_write_b32 a220, 0
    v_mfma_f32_16x16x32_bf16 v[148:151], v[48:51], a[224:227], v[148:151]
    ds_read_b64_tr_b16 v[40:41], v9 offset:8
    v_accvgpr_write_b32 a221, 0
    v_accvgpr_write_b32 a222, 0
    v_mfma_f32_16x16x32_bf16 v[148:151], v[52:55], a[240:243], v[148:151]
    ds_read_b64_tr_b16 v[42:43], v9 offset:1032
    v_mfma_f32_16x16x32_bf16 v[108:111], v[56:59], a[224:227], v[108:111]
    ds_read_b64_tr_b16 v[44:45], v9 offset:2056
    v_mfma_f32_16x16x32_bf16 v[108:111], v[60:63], a[240:243], v[108:111]
    ds_read_b128 a[224:227], v12 offset:0
    v_mfma_f32_16x16x32_bf16 v[180:183], v[48:51], a[228:231], v[180:183]
    ds_read_b128 a[240:243], v13 offset:0
    v_mfma_f32_16x16x32_bf16 v[180:183], v[52:55], a[244:247], v[180:183]
    ds_read_b64_tr_b16 v[46:47], v9 offset:3080
    v_mfma_f32_16x16x32_bf16 v[112:115], v[56:59], a[228:231], v[112:115]
    v_mfma_f32_16x16x32_bf16 v[112:115], v[60:63], a[244:247], v[112:115]
    ds_read_b128 a[228:231], v12 offset:2048
    v_mfma_f32_16x16x32_bf16 v[212:215], v[48:51], a[232:235], v[212:215]
    ds_read_b128 a[244:247], v13 offset:2048
    v_mfma_f32_16x16x32_bf16 v[212:215], v[52:55], a[248:251], v[212:215]
    v_mfma_f32_16x16x32_bf16 v[116:119], v[56:59], a[232:235], v[116:119]
    v_mfma_f32_16x16x32_bf16 v[116:119], v[60:63], a[248:251], v[116:119]
    ds_read_b128 a[232:235], v12 offset:4096
    ds_read_b128 a[248:251], v13 offset:4096
L_q0:
    s_waitcnt lgkmcnt(10)
    v_mfma_f32_16x16x32_bf16 v[216:219], v[32:35], a[236:239], v[216:219]
    s_mov_b32 m0, s66
    ds_read_b64_tr_b16 v[48:49], v9 offset:128
    s_add_u32 s65, s64, 0
    v_mfma_f32_16x16x32_bf16 v[216:219], v[36:39], a[252:255], v[216:219]
    s_waitcnt lgkmcnt(6)
    ds_read_b64_tr_b16 v[50:51], v9 offset:1152
    v_mfma_f32_16x16x32_bf16 v[120:123], v[32:35], a[224:227], v[120:123]
    buffer_load_dwordx4 v4, s[20:23], s65 offen lds
    v_mfma_f32_16x16x32_bf16 v[120:123], v[36:39], a[240:243], v[120:123]
    s_waitcnt lgkmcnt(6)
    ds_read_b64_tr_b16 v[52:53], v9 offset:2176
    s_add_u32 s65, s64, 31744
    v_mfma_f32_16x16x32_bf16 v[64:67], v[40:43], a[236:239], v[64:67]
    ds_read_b64_tr_b16 v[54:55], v9 offset:3200
    v_mfma_f32_16x16x32_bf16 v[64:67], v[44:47], a[252:255], v[64:67]
    buffer_load_dwordx4 v4, s[20:23], s65 offen offset:1024 lds
    v_mfma_f32_16x16x32_bf16 v[68:71], v[40:43], a[224:227], v[68:71]
    s_add_u32 s65, s64, 260096
    ds_read_b64_tr_b16 v[56:57], v9 offset:136
    v_mfma_f32_16x16x32_bf16 v[68:71], v[44:47], a[240:243], v[68:71]
    s_waitcnt lgkmcnt(7)
    ds_read_b64_tr_b16 v[58:59], v9 offset:1160
    v_mfma_f32_16x16x32_bf16 v[152:155], v[32:35], a[228:231], v[152:155]
    ds_read_b64_tr_b16 v[60:61], v9 offset:2184
    v_mfma_f32_16x16x32_bf16 v[152:155], v[36:39], a[244:247], v[152:155]
    buffer_load_dwordx4 v4, s[20:23], s65 offen offset:2048 lds
    v_mfma_f32_16x16x32_bf16 v[72:75], v[40:43], a[228:231], v[72:75]
    s_add_u32 s65, s64, 291840
    ds_read_b64_tr_b16 v[62:63], v9 offset:3208
    v_mfma_f32_16x16x32_bf16 v[72:75], v[44:47], a[244:247], v[72:75]
    s_waitcnt lgkmcnt(8)
    v_mfma_f32_16x16x32_bf16 v[184:187], v[32:35], a[232:235], v[184:187]
    ds_read_b64_tr_b16 v[32:33], v9 offset:256
    v_mfma_f32_16x16x32_bf16 v[184:187], v[36:39], a[248:251], v[184:187]
    s_barrier
    v_mfma_f32_16x16x32_bf16 v[76:79], v[40:43], a[232:235], v[76:79]
    buffer_load_dwordx4 v4, s[20:23], s65 offen offset:3072 lds
    v_mfma_f32_16x16x32_bf16 v[76:79], v[44:47], a[248:251], v[76:79]
    s_waitcnt lgkmcnt(5)
    ds_read_b64_tr_b16 v[34:35], v9 offset:1280
    s_add_u32 m0, s57, 0
    v_mfma_f32_16x16x32_bf16 v[220:223], v[48:51], a[236:239], v[220:223]
    s_add_u32 s65, s56, 0
    ds_read_b64_tr_b16 v[36:37], v9 offset:2304
    v_mfma_f32_16x16x32_bf16 v[220:223], v[52:55], a[252:255], v[220:223]
    buffer_load_dwordx4 v25, s[8:11], s65 offen lds
    v_mfma_f32_16x16x32_bf16 v[128:131], v[48:51], a[224:227], v[128:131]
    s_add_u32 m0, s57, 4096
    ds_read_b64_tr_b16 v[38:39], v9 offset:3328
    s_add_u32 s65, s56, 28672
    v_mfma_f32_16x16x32_bf16 v[128:131], v[52:55], a[240:243], v[128:131]
    ds_read_b64_tr_b16 v[40:41], v9 offset:264
    v_mfma_f32_16x16x32_bf16 v[160:163], v[48:51], a[228:231], v[160:163]
    ds_read_b64_tr_b16 v[42:43], v9 offset:1288
    v_mfma_f32_16x16x32_bf16 v[160:163], v[52:55], a[244:247], v[160:163]
    buffer_load_dwordx4 v25, s[8:11], s65 offen lds
    v_mfma_f32_16x16x32_bf16 v[192:195], v[48:51], a[232:235], v[192:195]
    s_add_u32 m0, s57, 8192
    ds_read_b64_tr_b16 v[44:45], v9 offset:2312
    s_add_u32 s65, s56, 57344
    v_mfma_f32_16x16x32_bf16 v[192:195], v[52:55], a[248:251], v[192:195]
    s_waitcnt lgkmcnt(7)
    ds_read_b64_tr_b16 v[46:47], v9 offset:3336
    v_mfma_f32_16x16x32_bf16 a[0:3], v[56:59], a[236:239], a[0:3]
    ds_read_b64_tr_b16 v[48:49], v9 offset:384
    v_mfma_f32_16x16x32_bf16 a[0:3], v[60:63], a[252:255], a[0:3]
    buffer_load_dwordx4 v25, s[8:11], s65 offen lds
    v_mfma_f32_16x16x32_bf16 a[4:7], v[56:59], a[224:227], a[4:7]
    s_add_u32 m0, s57, 12288
    ds_read_b64_tr_b16 v[50:51], v9 offset:1408
    s_add_u32 s65, s56, 86016
    v_mfma_f32_16x16x32_bf16 a[4:7], v[60:63], a[240:243], a[4:7]
    ds_read_b64_tr_b16 v[52:53], v9 offset:2432
    v_mfma_f32_16x16x32_bf16 a[8:11], v[56:59], a[228:231], a[8:11]
    ds_read_b64_tr_b16 v[54:55], v9 offset:3456
    v_mfma_f32_16x16x32_bf16 a[8:11], v[60:63], a[244:247], a[8:11]
    buffer_load_dwordx4 v25, s[8:11], s65 offen lds
    v_mfma_f32_16x16x32_bf16 a[12:15], v[56:59], a[232:235], a[12:15]
    s_add_u32 m0, s57, 16384
    ds_read_b64_tr_b16 v[56:57], v9 offset:392
    s_add_u32 s65, s56, 114688
    v_mfma_f32_16x16x32_bf16 a[12:15], v[60:63], a[248:251], a[12:15]
    s_waitcnt lgkmcnt(9)
    ds_read_b64_tr_b16 v[58:59], v9 offset:1416
    v_mfma_f32_16x16x32_bf16 v[224:227], v[32:35], a[236:239], v[224:227]
    ds_read_b64_tr_b16 v[60:61], v9 offset:2440
    v_mfma_f32_16x16x32_bf16 v[224:227], v[36:39], a[252:255], v[224:227]
    buffer_load_dwordx4 v25, s[8:11], s65 offen lds
    v_mfma_f32_16x16x32_bf16 v[136:139], v[32:35], a[224:227], v[136:139]
    s_add_u32 m0, s57, 20480
    ds_read_b64_tr_b16 v[62:63], v9 offset:3464
    s_add_u32 s65, s56, 143360
    v_mfma_f32_16x16x32_bf16 v[136:139], v[36:39], a[240:243], v[136:139]
    v_mfma_f32_16x16x32_bf16 v[168:171], v[32:35], a[228:231], v[168:171]
    v_mfma_f32_16x16x32_bf16 v[168:171], v[36:39], a[244:247], v[168:171]
    buffer_load_dwordx4 v25, s[8:11], s65 offen lds
    v_mfma_f32_16x16x32_bf16 v[200:203], v[32:35], a[232:235], v[200:203]
    s_add_u32 m0, s57, 24576
    ds_read_b64_tr_b16 v[32:33], v9 offset:64
    s_add_u32 s65, s56, 172032
    v_mfma_f32_16x16x32_bf16 v[200:203], v[36:39], a[248:251], v[200:203]
    s_waitcnt lgkmcnt(9)
    ds_read_b64_tr_b16 v[34:35], v9 offset:1088
    v_mfma_f32_16x16x32_bf16 a[16:19], v[40:43], a[236:239], a[16:19]
    ds_read_b64_tr_b16 v[36:37], v9 offset:2112
    v_mfma_f32_16x16x32_bf16 a[16:19], v[44:47], a[252:255], a[16:19]
    buffer_load_dwordx4 v25, s[8:11], s65 offen lds
    v_mfma_f32_16x16x32_bf16 a[20:23], v[40:43], a[224:227], a[20:23]
    s_add_u32 s56, s56, 128
    ds_read_b64_tr_b16 v[38:39], v9 offset:3136
    s_bitcmp1_b64 s[62:63], s70
    v_mfma_f32_16x16x32_bf16 a[20:23], v[44:47], a[240:243], a[20:23]
    s_cselect_b64 s[12:13], s[58:59], s[60:61]
    s_cselect_b32 s69, s67, s68
    s_cselect_b32 s87, 8192, 0
    v_mfma_f32_16x16x32_bf16 v[16:19], v[40:43], a[228:231], v[16:19]
    s_add_u32 s67, s67, s87
    s_xor_b32 s87, s87, 8192
    s_add_u32 s68, s68, s87
    v_mfma_f32_16x16x32_bf16 v[16:19], v[44:47], a[244:247], v[16:19]
    s_and_b32 s87, s70, 15
    s_mul_i32 s87, s87, 8320
    s_add_u32 s83, s83, 128
    v_mfma_f32_16x16x32_bf16 v[20:23], v[40:43], a[232:235], v[20:23]
    s_min_u32 s83, s83, 768
    ds_read_b64_tr_b16 v[40:41], v9 offset:72
    s_add_u32 s73, s73, 1
    v_mfma_f32_16x16x32_bf16 v[20:23], v[44:47], a[248:251], v[20:23]
    s_waitcnt lgkmcnt(9)
    ds_read_b64_tr_b16 v[42:43], v9 offset:1096
    s_add_u32 m0, s66, 16512
    v_mfma_f32_16x16x32_bf16 v[228:231], v[48:51], a[236:239], v[228:231]
    s_add_u32 s65, s64, 65536
    ds_read_b64_tr_b16 v[44:45], v9 offset:2120
    v_mfma_f32_16x16x32_bf16 v[228:231], v[52:55], a[252:255], v[228:231]
    buffer_load_dwordx4 v4, s[20:23], s65 offen lds
    v_mfma_f32_16x16x32_bf16 v[144:147], v[48:51], a[224:227], v[144:147]
    s_add_u32 s65, s64, 97280
    ds_read_b64_tr_b16 v[46:47], v9 offset:3144
    v_mfma_f32_16x16x32_bf16 v[144:147], v[52:55], a[240:243], v[144:147]
    buffer_load_dwordx4 v4, s[20:23], s65 offen offset:1024 lds
    v_mfma_f32_16x16x32_bf16 v[176:179], v[48:51], a[228:231], v[176:179]
    s_add_u32 s65, s64, 325632
    v_mfma_f32_16x16x32_bf16 v[176:179], v[52:55], a[244:247], v[176:179]
    buffer_load_dwordx4 v4, s[20:23], s65 offen offset:2048 lds
    v_mfma_f32_16x16x32_bf16 v[208:211], v[48:51], a[232:235], v[208:211]
    s_add_u32 s65, s64, 357376
    ds_read_b64_tr_b16 v[48:49], v9 offset:192
    v_mfma_f32_16x16x32_bf16 v[208:211], v[52:55], a[248:251], v[208:211]
    s_waitcnt lgkmcnt(9)
    ds_read_b64_tr_b16 v[50:51], v9 offset:1216
    v_mfma_f32_16x16x32_bf16 v[232:235], v[56:59], a[236:239], v[232:235]
    ds_read_b64_tr_b16 v[52:53], v9 offset:2240
    v_mfma_f32_16x16x32_bf16 v[232:235], v[60:63], a[252:255], v[232:235]
    buffer_load_dwordx4 v4, s[20:23], s65 offen offset:3072 lds
    v_mfma_f32_16x16x32_bf16 v[28:31], v[56:59], a[224:227], v[28:31]
    s_add_u32 m0, s87, s71
    ds_read_b64_tr_b16 v[54:55], v9 offset:3264
    s_add_u32 s70, s70, 1
    v_mfma_f32_16x16x32_bf16 v[28:31], v[60:63], a[240:243], v[28:31]
    v_mfma_f32_16x16x32_bf16 v[244:247], v[56:59], a[228:231], v[244:247]
    v_mfma_f32_16x16x32_bf16 v[244:247], v[60:63], a[244:247], v[244:247]
    buffer_load_dwordx4 v26, s[12:15], s69 offen nt lds
    v_mfma_f32_16x16x32_bf16 v[248:251], v[56:59], a[232:235], v[248:251]
    ds_read_b64_tr_b16 v[56:57], v9 offset:200
    v_mfma_f32_16x16x32_bf16 v[248:251], v[60:63], a[248:251], v[248:251]
    s_waitcnt lgkmcnt(9)
    ds_read_b64_tr_b16 v[58:59], v9 offset:1224
    v_mfma_f32_16x16x32_bf16 v[124:127], v[32:35], a[224:227], v[124:127]
    buffer_load_dwordx4 v26, s[12:15], s69 offen offset:1024 nt lds
    v_mfma_f32_16x16x32_bf16 v[124:127], v[36:39], a[240:243], v[124:127]
    buffer_load_dword v6, v27, s[8:11], s83 offen
    v_mfma_f32_16x16x32_bf16 v[156:159], v[32:35], a[228:231], v[156:159]
    ds_read_b64_tr_b16 v[60:61], v9 offset:2248
    v_mfma_f32_16x16x32_bf16 v[156:159], v[36:39], a[244:247], v[156:159]
    buffer_load_dword v6, v10, s[24:27], 0 offen
    v_mfma_f32_16x16x32_bf16 v[188:191], v[32:35], a[232:235], v[188:191]
    ds_read_b64_tr_b16 v[62:63], v9 offset:3272
    v_add_u32 v10, 1536, v10
    v_mfma_f32_16x16x32_bf16 v[188:191], v[36:39], a[248:251], v[188:191]
    s_waitcnt lgkmcnt(8)
    ds_read_b64_tr_b16 v[32:33], v9 offset:320
    s_add_u32 s64, s64, 524288
    v_mfma_f32_16x16x32_bf16 v[252:255], v[40:43], a[224:227], v[252:255]
    s_add_u32 s66, s66, s82
    ds_read_b64_tr_b16 v[34:35], v9 offset:1344
    s_sub_u32 s82, 0, s82
    v_mfma_f32_16x16x32_bf16 v[252:255], v[44:47], a[240:243], v[252:255]
    ds_read_b64_tr_b16 v[36:37], v9 offset:2368
    v_mfma_f32_16x16x32_bf16 v[240:243], v[40:43], a[228:231], v[240:243]
    ds_read_b64_tr_b16 v[38:39], v9 offset:3392
    v_mfma_f32_16x16x32_bf16 v[240:243], v[44:47], a[244:247], v[240:243]
    v_mfma_f32_16x16x32_bf16 v[96:99], v[40:43], a[232:235], v[96:99]
    ds_read_b64_tr_b16 v[40:41], v9 offset:328
    v_mfma_f32_16x16x32_bf16 v[96:99], v[44:47], a[248:251], v[96:99]
    s_waitcnt lgkmcnt(9)
    ds_read_b64_tr_b16 v[42:43], v9 offset:1352
    v_mfma_f32_16x16x32_bf16 v[132:135], v[48:51], a[224:227], v[132:135]
    ds_read_b64_tr_b16 v[44:45], v9 offset:2376
    v_mfma_f32_16x16x32_bf16 v[132:135], v[52:55], a[240:243], v[132:135]
    ds_read_b64_tr_b16 v[46:47], v9 offset:3400
    v_mfma_f32_16x16x32_bf16 v[164:167], v[48:51], a[228:231], v[164:167]
    v_mfma_f32_16x16x32_bf16 v[164:167], v[52:55], a[244:247], v[164:167]
    v_mfma_f32_16x16x32_bf16 v[196:199], v[48:51], a[232:235], v[196:199]
    ds_read_b64_tr_b16 v[48:49], v9 offset:448
    v_mfma_f32_16x16x32_bf16 v[196:199], v[52:55], a[248:251], v[196:199]
    s_waitcnt lgkmcnt(9)
    ds_read_b64_tr_b16 v[50:51], v9 offset:1472
    v_mfma_f32_16x16x32_bf16 v[100:103], v[56:59], a[224:227], v[100:103]
    ds_read_b64_tr_b16 v[52:53], v9 offset:2496
    v_mfma_f32_16x16x32_bf16 v[100:103], v[60:63], a[240:243], v[100:103]
    ds_read_b64_tr_b16 v[54:55], v9 offset:3520
    v_mfma_f32_16x16x32_bf16 v[104:107], v[56:59], a[228:231], v[104:107]
    v_mfma_f32_16x16x32_bf16 v[104:107], v[60:63], a[244:247], v[104:107]
    v_mfma_f32_16x16x32_bf16 v[80:83], v[56:59], a[232:235], v[80:83]
    ds_read_b64_tr_b16 v[56:57], v9 offset:456
    v_mfma_f32_16x16x32_bf16 v[80:83], v[60:63], a[248:251], v[80:83]
    s_waitcnt lgkmcnt(9)
    ds_read_b64_tr_b16 v[58:59], v9 offset:1480
    v_mfma_f32_16x16x32_bf16 v[140:143], v[32:35], a[224:227], v[140:143]
    ds_read_b64_tr_b16 v[60:61], v9 offset:2504
    v_mfma_f32_16x16x32_bf16 v[140:143], v[36:39], a[240:243], v[140:143]
    ds_read_b64_tr_b16 v[62:63], v9 offset:3528
    v_add_u32_e64 v9, s82, v9
    v_mfma_f32_16x16x32_bf16 v[172:175], v[32:35], a[228:231], v[172:175]
    v_mfma_f32_16x16x32_bf16 v[172:175], v[36:39], a[244:247], v[172:175]
    v_mfma_f32_16x16x32_bf16 v[204:207], v[32:35], a[232:235], v[204:207]
    v_mfma_f32_16x16x32_bf16 v[204:207], v[36:39], a[248:251], v[204:207]
    s_waitcnt vmcnt(4) lgkmcnt(0)
    s_barrier
    v_mfma_f32_16x16x32_bf16 v[84:87], v[40:43], a[224:227], v[84:87]
    ds_read_b64_tr_b16 v[32:33], v9 offset:0
    v_mfma_f32_16x16x32_bf16 v[84:87], v[44:47], a[240:243], v[84:87]
    ds_read_b64_tr_b16 v[34:35], v9 offset:1024
    v_mfma_f32_16x16x32_bf16 v[88:91], v[40:43], a[228:231], v[88:91]
    ds_read_b64_tr_b16 v[36:37], v9 offset:2048
    v_mfma_f32_16x16x32_bf16 v[88:91], v[44:47], a[244:247], v[88:91]
    ds_read_b64_tr_b16 v[38:39], v9 offset:3072
    v_mfma_f32_16x16x32_bf16 v[92:95], v[40:43], a[232:235], v[92:95]
    ds_read_b128 a[236:239], v14 offset:0
    v_mfma_f32_16x16x32_bf16 v[92:95], v[44:47], a[248:251], v[92:95]
    ds_read_b128 a[252:255], v15 offset:0
    v_mfma_f32_16x16x32_bf16 v[148:151], v[48:51], a[224:227], v[148:151]
    ds_read_b64_tr_b16 v[40:41], v9 offset:8
    v_mfma_f32_16x16x32_bf16 v[148:151], v[52:55], a[240:243], v[148:151]
    ds_read_b64_tr_b16 v[42:43], v9 offset:1032
    v_mfma_f32_16x16x32_bf16 v[108:111], v[56:59], a[224:227], v[108:111]
    ds_read_b64_tr_b16 v[44:45], v9 offset:2056
    v_mfma_f32_16x16x32_bf16 v[108:111], v[60:63], a[240:243], v[108:111]
    ds_read_b128 a[224:227], v12 offset:0
    v_mfma_f32_16x16x32_bf16 v[180:183], v[48:51], a[228:231], v[180:183]
    ds_read_b128 a[240:243], v13 offset:0
    v_mfma_f32_16x16x32_bf16 v[180:183], v[52:55], a[244:247], v[180:183]
    ds_read_b64_tr_b16 v[46:47], v9 offset:3080
    v_mfma_f32_16x16x32_bf16 v[112:115], v[56:59], a[228:231], v[112:115]
    v_mfma_f32_16x16x32_bf16 v[112:115], v[60:63], a[244:247], v[112:115]
    ds_read_b128 a[228:231], v12 offset:2048
    v_mfma_f32_16x16x32_bf16 v[212:215], v[48:51], a[232:235], v[212:215]
    ds_read_b128 a[244:247], v13 offset:2048
    v_mfma_f32_16x16x32_bf16 v[212:215], v[52:55], a[248:251], v[212:215]
    v_mfma_f32_16x16x32_bf16 v[116:119], v[56:59], a[232:235], v[116:119]
    v_mfma_f32_16x16x32_bf16 v[116:119], v[60:63], a[248:251], v[116:119]
    ds_read_b128 a[232:235], v12 offset:4096
    ds_read_b128 a[248:251], v13 offset:4096
    s_cmp_lt_u32 s73, 6
    s_cbranch_scc1 L_q0
    s_waitcnt lgkmcnt(10)
    v_mfma_f32_16x16x32_bf16 v[216:219], v[32:35], a[236:239], v[216:219]
    s_mov_b32 s70, 29
    ds_read_b64_tr_b16 v[48:49], v9 offset:128
    v_readfirstlane_b32 s85, v10
    v_mfma_f32_16x16x32_bf16 v[216:219], v[36:39], a[252:255], v[216:219]
    s_waitcnt lgkmcnt(6)
    ds_read_b64_tr_b16 v[50:51], v9 offset:1152
    v_mov_b32 v12, 0
    v_mfma_f32_16x16x32_bf16 v[120:123], v[32:35], a[224:227], v[120:123]
    s_sub_u32 s85, s85, 7680
    ds_read_b64_tr_b16 v[52:53], v9 offset:2176
    v_lshl_add_u32 v10, v26, 3, s85
    v_mfma_f32_16x16x32_bf16 v[120:123], v[36:39], a[240:243], v[120:123]
    s_waitcnt lgkmcnt(7)
    ds_read_b64_tr_b16 v[54:55], v9 offset:3200
    v_cvt_pk_bf16_f32 v216, v216, v217
    v_mfma_f32_16x16x32_bf16 v[64:67], v[40:43], a[236:239], v[64:67]
    buffer_load_dword v6, v10, s[24:27], 0 offen
    v_mfma_f32_16x16x32_bf16 v[64:67], v[44:47], a[252:255], v[64:67]
    s_add_u32 s67, s81, 81920
    ds_read_b64_tr_b16 v[56:57], v9 offset:136
    v_accvgpr_read_b32 v25, a223
    v_mfma_f32_16x16x32_bf16 v[68:71], v[40:43], a[224:227], v[68:71]
    s_add_u32 s68, s81, 57344
    ds_read_b64_tr_b16 v[58:59], v9 offset:1160
    v_cvt_pk_bf16_f32 v217, v218, v219
    v_mfma_f32_16x16x32_bf16 v[68:71], v[44:47], a[240:243], v[68:71]
    s_waitcnt lgkmcnt(8)
    ds_read_b64_tr_b16 v[60:61], v9 offset:2184
    v_cvt_pk_bf16_f32 v120, v120, v121
    v_mfma_f32_16x16x32_bf16 v[152:155], v[32:35], a[228:231], v[152:155]
    s_mov_b32 s73, 0
    ds_read_b64_tr_b16 v[62:63], v9 offset:3208
    v_cvt_pk_bf16_f32 v121, v122, v123
    v_mfma_f32_16x16x32_bf16 v[152:155], v[36:39], a[244:247], v[152:155]
    s_lshl_b32 s86, s3, 10
    v_mov_b32_e64 v13, 0
    v_mov_b32_e64 v14, 0
    v_mfma_f32_16x16x32_bf16 v[72:75], v[40:43], a[228:231], v[72:75]
    s_add_u32 s86, s86, 149504
    v_mov_b32_e64 v15, 0
    v_mfma_f32_16x16x32_bf16 v[72:75], v[44:47], a[244:247], v[72:75]
    s_waitcnt lgkmcnt(8)
    v_mfma_f32_16x16x32_bf16 v[184:187], v[32:35], a[232:235], v[184:187]
    ds_read_b64_tr_b16 v[32:33], v9 offset:256
    v_cvt_pk_bf16_f32 v152, v152, v153
    v_mfma_f32_16x16x32_bf16 v[184:187], v[36:39], a[248:251], v[184:187]
    s_barrier
    v_mfma_f32_16x16x32_bf16 v[76:79], v[40:43], a[232:235], v[76:79]
    global_load_dword v6, v25, s[54:55]
    v_mfma_f32_16x16x32_bf16 v[76:79], v[44:47], a[248:251], v[76:79]
    s_waitcnt lgkmcnt(5)
    ds_read_b64_tr_b16 v[34:35], v9 offset:1280
    v_cvt_pk_bf16_f32 v153, v154, v155
    v_mfma_f32_16x16x32_bf16 v[220:223], v[48:51], a[236:239], v[220:223]
    ds_read_b64_tr_b16 v[36:37], v9 offset:2304
    v_cvt_pk_bf16_f32 v184, v184, v185
    v_mfma_f32_16x16x32_bf16 v[220:223], v[52:55], a[252:255], v[220:223]
    ds_read_b64_tr_b16 v[38:39], v9 offset:3328
    v_cvt_pk_bf16_f32 v185, v186, v187
    v_mfma_f32_16x16x32_bf16 v[128:131], v[48:51], a[224:227], v[128:131]
    ds_read_b64_tr_b16 v[40:41], v9 offset:264
    v_accvgpr_write_b32 a223, 0
    v_mfma_f32_16x16x32_bf16 v[128:131], v[52:55], a[240:243], v[128:131]
    ds_read_b64_tr_b16 v[42:43], v9 offset:1288
    v_lshrrev_b32_e64 v27, 1, v26
    v_mfma_f32_16x16x32_bf16 v[160:163], v[48:51], a[228:231], v[160:163]
    s_mov_b64 s[12:13], s[60:61]
    ds_read_b64_tr_b16 v[44:45], v9 offset:2312
    v_cvt_pk_bf16_f32 v218, v64, v65
    v_mfma_f32_16x16x32_bf16 v[160:163], v[52:55], a[244:247], v[160:163]
    s_add_u32 s69, s81, 16384
    ds_read_b64_tr_b16 v[46:47], v9 offset:3336
    v_cvt_pk_bf16_f32 v219, v66, v67
    v_mfma_f32_16x16x32_bf16 v[192:195], v[48:51], a[232:235], v[192:195]
    ds_write_b128 v7, v[216:219] offset:0
    v_mfma_f32_16x16x32_bf16 v[192:195], v[52:55], a[248:251], v[192:195]
    s_waitcnt lgkmcnt(9)
    ds_read_b64_tr_b16 v[48:49], v9 offset:384
    v_cvt_pk_bf16_f32 v122, v68, v69
    v_mfma_f32_16x16x32_bf16 a[0:3], v[56:59], a[236:239], a[0:3]
    s_add_u32 m0, s71, 33280
    ds_read_b64_tr_b16 v[50:51], v9 offset:1408
    v_cvt_pk_bf16_f32 v123, v70, v71
    v_mfma_f32_16x16x32_bf16 a[0:3], v[60:63], a[252:255], a[0:3]
    buffer_load_dwordx4 v26, s[12:15], s69 offen nt lds
    v_mfma_f32_16x16x32_bf16 a[4:7], v[56:59], a[224:227], a[4:7]
    ds_read_b64_tr_b16 v[52:53], v9 offset:2432
    v_cvt_pk_bf16_f32 v154, v72, v73
    v_mfma_f32_16x16x32_bf16 a[4:7], v[60:63], a[240:243], a[4:7]
    ds_read_b64_tr_b16 v[54:55], v9 offset:3456
    v_cvt_pk_bf16_f32 v155, v74, v75
    v_mfma_f32_16x16x32_bf16 a[8:11], v[56:59], a[228:231], a[8:11]
    v_cvt_pk_bf16_f32 v186, v76, v77
    v_cvt_pk_bf16_f32 v187, v78, v79
    v_mfma_f32_16x16x32_bf16 a[8:11], v[60:63], a[244:247], a[8:11]
    v_cvt_pk_bf16_f32 v220, v220, v221
    v_cvt_pk_bf16_f32 v221, v222, v223
    v_mfma_f32_16x16x32_bf16 a[12:15], v[56:59], a[232:235], a[12:15]
    ds_read_b64_tr_b16 v[56:57], v9 offset:392
    v_cvt_pk_bf16_f32 v128, v128, v129
    v_mfma_f32_16x16x32_bf16 a[12:15], v[60:63], a[248:251], a[12:15]
    s_waitcnt lgkmcnt(10)
    ds_read_b64_tr_b16 v[58:59], v9 offset:1416
    v_cvt_pk_bf16_f32 v129, v130, v131
    v_mfma_f32_16x16x32_bf16 v[224:227], v[32:35], a[236:239], v[224:227]
    ds_read_b64_tr_b16 v[60:61], v9 offset:2440
    v_cvt_pk_bf16_f32 v160, v160, v161
    v_mfma_f32_16x16x32_bf16 v[224:227], v[36:39], a[252:255], v[224:227]
    ds_read_b64_tr_b16 v[62:63], v9 offset:3464
    v_cvt_pk_bf16_f32 v161, v162, v163
    v_mfma_f32_16x16x32_bf16 v[136:139], v[32:35], a[224:227], v[136:139]
    v_cvt_pk_bf16_f32 v192, v192, v193
    v_cvt_pk_bf16_f32 v193, v194, v195
    v_mfma_f32_16x16x32_bf16 v[136:139], v[36:39], a[240:243], v[136:139]
    v_accvgpr_read_b32 v236, a0
    v_accvgpr_read_b32 v237, a1
    v_mfma_f32_16x16x32_bf16 v[168:171], v[32:35], a[228:231], v[168:171]
    buffer_load_dwordx4 v26, s[12:15], s69 offen offset:1024 nt lds
    v_mfma_f32_16x16x32_bf16 v[168:171], v[36:39], a[244:247], v[168:171]
    s_add_u32 s69, s81, 24576
    v_accvgpr_read_b32 v238, a2
    v_accvgpr_read_b32 v239, a3
    v_mfma_f32_16x16x32_bf16 v[200:203], v[32:35], a[232:235], v[200:203]
    s_add_u32 m0, s71, 41600
    ds_read_b64_tr_b16 v[32:33], v9 offset:64
    v_cvt_pk_bf16_f32 v222, v236, v237
    v_mfma_f32_16x16x32_bf16 v[200:203], v[36:39], a[248:251], v[200:203]
    s_waitcnt lgkmcnt(10)
    ds_read_b64_tr_b16 v[34:35], v9 offset:1088
    v_cvt_pk_bf16_f32 v223, v238, v239
    v_mfma_f32_16x16x32_bf16 a[16:19], v[40:43], a[236:239], a[16:19]
    ds_write_b128 v7, v[220:223] offset:1024
    v_mfma_f32_16x16x32_bf16 a[16:19], v[44:47], a[252:255], a[16:19]
    ds_read_b64_tr_b16 v[36:37], v9 offset:2112
    v_accvgpr_read_b32 v236, a4
    v_mfma_f32_16x16x32_bf16 a[20:23], v[40:43], a[224:227], a[20:23]
    ds_read_b64_tr_b16 v[38:39], v9 offset:3136
    v_accvgpr_read_b32 v237, a5
    v_mfma_f32_16x16x32_bf16 a[20:23], v[44:47], a[240:243], a[20:23]
    v_accvgpr_read_b32 v238, a6
    v_accvgpr_read_b32 v239, a7
    v_mfma_f32_16x16x32_bf16 v[16:19], v[40:43], a[228:231], v[16:19]
    v_cvt_pk_bf16_f32 v130, v236, v237
    v_cvt_pk_bf16_f32 v131, v238, v239
    v_mfma_f32_16x16x32_bf16 v[16:19], v[44:47], a[244:247], v[16:19]
    v_accvgpr_read_b32 v236, a8
    v_accvgpr_read_b32 v237, a9
    v_mfma_f32_16x16x32_bf16 v[20:23], v[40:43], a[232:235], v[20:23]
    ds_read_b64_tr_b16 v[40:41], v9 offset:72
    v_accvgpr_read_b32 v238, a10
    v_mfma_f32_16x16x32_bf16 v[20:23], v[44:47], a[248:251], v[20:23]
    s_waitcnt lgkmcnt(10)
    ds_read_b64_tr_b16 v[42:43], v9 offset:1096
    v_accvgpr_read_b32 v239, a11
    v_mfma_f32_16x16x32_bf16 v[228:231], v[48:51], a[236:239], v[228:231]
    ds_read_b64_tr_b16 v[44:45], v9 offset:2120
    v_cvt_pk_bf16_f32 v162, v236, v237
    v_mfma_f32_16x16x32_bf16 v[228:231], v[52:55], a[252:255], v[228:231]
    ds_read_b64_tr_b16 v[46:47], v9 offset:3144
    v_cvt_pk_bf16_f32 v163, v238, v239
    v_mfma_f32_16x16x32_bf16 v[144:147], v[48:51], a[224:227], v[144:147]
    v_accvgpr_read_b32 v236, a12
    v_accvgpr_read_b32 v237, a13
    v_mfma_f32_16x16x32_bf16 v[144:147], v[52:55], a[240:243], v[144:147]
    v_accvgpr_read_b32 v238, a14
    v_accvgpr_read_b32 v239, a15
    v_mfma_f32_16x16x32_bf16 v[176:179], v[48:51], a[228:231], v[176:179]
    v_cvt_pk_bf16_f32 v194, v236, v237
    v_cvt_pk_bf16_f32 v195, v238, v239
    v_mfma_f32_16x16x32_bf16 v[176:179], v[52:55], a[244:247], v[176:179]
    buffer_load_dwordx4 v26, s[12:15], s69 offen nt lds
    v_mfma_f32_16x16x32_bf16 v[208:211], v[48:51], a[232:235], v[208:211]
    ds_read_b64_tr_b16 v[48:49], v9 offset:192
    v_cvt_pk_bf16_f32 v224, v224, v225
    v_mfma_f32_16x16x32_bf16 v[208:211], v[52:55], a[248:251], v[208:211]
    s_waitcnt lgkmcnt(10)
    ds_read_b64_tr_b16 v[50:51], v9 offset:1216
    v_cvt_pk_bf16_f32 v225, v226, v227
    v_mfma_f32_16x16x32_bf16 v[232:235], v[56:59], a[236:239], v[232:235]
    ds_read_b64_tr_b16 v[52:53], v9 offset:2240
    v_cvt_pk_bf16_f32 v136, v136, v137
    v_mfma_f32_16x16x32_bf16 v[232:235], v[60:63], a[252:255], v[232:235]
    ds_read_b64_tr_b16 v[54:55], v9 offset:3264
    v_cvt_pk_bf16_f32 v137, v138, v139
    v_mfma_f32_16x16x32_bf16 v[28:31], v[56:59], a[224:227], v[28:31]
    v_cvt_pk_bf16_f32 v168, v168, v169
    v_cvt_pk_bf16_f32 v169, v170, v171
    v_mfma_f32_16x16x32_bf16 v[28:31], v[60:63], a[240:243], v[28:31]
    v_cvt_pk_bf16_f32 v200, v200, v201
    v_cvt_pk_bf16_f32 v201, v202, v203
    v_mfma_f32_16x16x32_bf16 v[244:247], v[56:59], a[228:231], v[244:247]
    buffer_load_dwordx4 v26, s[12:15], s69 offen offset:1024 nt lds
    v_mfma_f32_16x16x32_bf16 v[244:247], v[60:63], a[244:247], v[244:247]
    s_mov_b64 s[12:13], s[58:59]
    v_accvgpr_read_b32 v236, a16
    v_accvgpr_read_b32 v237, a17
    v_mfma_f32_16x16x32_bf16 v[248:251], v[56:59], a[232:235], v[248:251]
    s_add_u32 s69, s81, 49152
    ds_read_b64_tr_b16 v[56:57], v9 offset:200
    v_accvgpr_read_b32 v238, a18
    v_mfma_f32_16x16x32_bf16 v[248:251], v[60:63], a[248:251], v[248:251]
    s_waitcnt lgkmcnt(9)
    ds_read_b64_tr_b16 v[58:59], v9 offset:1224
    v_accvgpr_read_b32 v239, a19
    v_mfma_f32_16x16x32_bf16 v[124:127], v[32:35], a[224:227], v[124:127]
    s_add_u32 m0, s71, 49920
    ds_read_b64_tr_b16 v[60:61], v9 offset:2248
    v_cvt_pk_bf16_f32 v226, v236, v237
    v_mfma_f32_16x16x32_bf16 v[124:127], v[36:39], a[240:243], v[124:127]
    ds_read_b64_tr_b16 v[62:63], v9 offset:3272
    v_cvt_pk_bf16_f32 v227, v238, v239
    v_mfma_f32_16x16x32_bf16 v[156:159], v[32:35], a[228:231], v[156:159]
    ds_write_b128 v7, v[224:227] offset:2048
    v_mfma_f32_16x16x32_bf16 v[156:159], v[36:39], a[244:247], v[156:159]
    v_accvgpr_read_b32 v236, a20
    v_accvgpr_read_b32 v237, a21
    v_mfma_f32_16x16x32_bf16 v[188:191], v[32:35], a[232:235], v[188:191]
    ds_read_b64_tr_b16 v[32:33], v9 offset:320
    v_accvgpr_read_b32 v238, a22
    v_mfma_f32_16x16x32_bf16 v[188:191], v[36:39], a[248:251], v[188:191]
    s_waitcnt lgkmcnt(10)
    ds_read_b64_tr_b16 v[34:35], v9 offset:1344
    v_accvgpr_read_b32 v239, a23
    v_mfma_f32_16x16x32_bf16 v[252:255], v[40:43], a[224:227], v[252:255]
    ds_read_b64_tr_b16 v[36:37], v9 offset:2368
    v_cvt_pk_bf16_f32 v138, v236, v237
    v_mfma_f32_16x16x32_bf16 v[252:255], v[44:47], a[240:243], v[252:255]
    ds_read_b64_tr_b16 v[38:39], v9 offset:3392
    v_cvt_pk_bf16_f32 v139, v238, v239
    v_mfma_f32_16x16x32_bf16 v[240:243], v[40:43], a[228:231], v[240:243]
    v_cvt_pk_bf16_f32 v170, v16, v17
    v_cvt_pk_bf16_f32 v171, v18, v19
    v_mfma_f32_16x16x32_bf16 v[240:243], v[44:47], a[244:247], v[240:243]
    v_cvt_pk_bf16_f32 v202, v20, v21
    v_cvt_pk_bf16_f32 v203, v22, v23
    v_mfma_f32_16x16x32_bf16 v[96:99], v[40:43], a[232:235], v[96:99]
    ds_read_b64_tr_b16 v[40:41], v9 offset:328
    v_cvt_pk_bf16_f32 v228, v228, v229
    v_mfma_f32_16x16x32_bf16 v[96:99], v[44:47], a[248:251], v[96:99]
    s_waitcnt lgkmcnt(10)
    ds_read_b64_tr_b16 v[42:43], v9 offset:1352
    v_cvt_pk_bf16_f32 v229, v230, v231
    v_mfma_f32_16x16x32_bf16 v[132:135], v[48:51], a[224:227], v[132:135]
    ds_read_b64_tr_b16 v[44:45], v9 offset:2376
    v_cvt_pk_bf16_f32 v144, v144, v145
    v_mfma_f32_16x16x32_bf16 v[132:135], v[52:55], a[240:243], v[132:135]
    ds_read_b64_tr_b16 v[46:47], v9 offset:3400
    v_cvt_pk_bf16_f32 v145, v146, v147
    v_mfma_f32_16x16x32_bf16 v[164:167], v[48:51], a[228:231], v[164:167]
    v_cvt_pk_bf16_f32 v176, v176, v177
    v_cvt_pk_bf16_f32 v177, v178, v179
    v_mfma_f32_16x16x32_bf16 v[164:167], v[52:55], a[244:247], v[164:167]
    v_cvt_pk_bf16_f32 v208, v208, v209
    v_cvt_pk_bf16_f32 v209, v210, v211
    v_mfma_f32_16x16x32_bf16 v[196:199], v[48:51], a[232:235], v[196:199]
    buffer_load_dwordx4 v26, s[12:15], s69 offen nt lds
    v_mfma_f32_16x16x32_bf16 v[196:199], v[52:55], a[248:251], v[196:199]
    s_waitcnt lgkmcnt(9)
    ds_read_b64_tr_b16 v[48:49], v9 offset:448
    v_cvt_pk_bf16_f32 v230, v232, v233
    v_mfma_f32_16x16x32_bf16 v[100:103], v[56:59], a[224:227], v[100:103]
    ds_read_b64_tr_b16 v[50:51], v9 offset:1472
    v_cvt_pk_bf16_f32 v231, v234, v235
    v_mfma_f32_16x16x32_bf16 v[100:103], v[60:63], a[240:243], v[100:103]
    ds_write_b128 v7, v[228:231] offset:3072
    v_mfma_f32_16x16x32_bf16 v[104:107], v[56:59], a[228:231], v[104:107]
    ds_read_b64_tr_b16 v[52:53], v9 offset:2496
    v_cvt_pk_bf16_f32 v146, v28, v29
    v_mfma_f32_16x16x32_bf16 v[104:107], v[60:63], a[244:247], v[104:107]
    ds_read_b64_tr_b16 v[54:55], v9 offset:3520
    v_cvt_pk_bf16_f32 v147, v30, v31
    v_mfma_f32_16x16x32_bf16 v[80:83], v[56:59], a[232:235], v[80:83]
    ds_read_b64_tr_b16 v[56:57], v9 offset:456
    v_cvt_pk_bf16_f32 v178, v244, v245
    v_mfma_f32_16x16x32_bf16 v[80:83], v[60:63], a[248:251], v[80:83]
    s_waitcnt lgkmcnt(10)
    ds_read_b64_tr_b16 v[58:59], v9 offset:1480
    v_cvt_pk_bf16_f32 v179, v246, v247
    v_mfma_f32_16x16x32_bf16 v[140:143], v[32:35], a[224:227], v[140:143]
    ds_read_b64_tr_b16 v[60:61], v9 offset:2504
    v_cvt_pk_bf16_f32 v210, v248, v249
    v_mfma_f32_16x16x32_bf16 v[140:143], v[36:39], a[240:243], v[140:143]
    ds_read_b64_tr_b16 v[62:63], v9 offset:3528
    v_cvt_pk_bf16_f32 v211, v250, v251
    v_mfma_f32_16x16x32_bf16 v[172:175], v[32:35], a[228:231], v[172:175]
    buffer_load_dwordx4 v26, s[12:15], s69 offen offset:1024 nt lds
    v_mfma_f32_16x16x32_bf16 v[172:175], v[36:39], a[244:247], v[172:175]
    s_add_u32 s69, s81, 57344
    v_cvt_pk_bf16_f32 v124, v124, v125
    v_cvt_pk_bf16_f32 v125, v126, v127
    v_mfma_f32_16x16x32_bf16 v[204:207], v[32:35], a[232:235], v[204:207]
    s_add_u32 m0, s71, 58240
    ds_read_b128 v[32:35], v1 offset:33280
    v_cvt_pk_bf16_f32 v156, v156, v157
    v_mfma_f32_16x16x32_bf16 v[204:207], v[36:39], a[248:251], v[204:207]
    s_waitcnt lgkmcnt(10)
    ds_read_b128 v[36:39], v1 offset:33408
    v_cvt_pk_bf16_f32 v157, v158, v159
    v_mfma_f32_16x16x32_bf16 v[84:87], v[40:43], a[224:227], v[84:87]
    v_cvt_pk_bf16_f32 v188, v188, v189
    v_cvt_pk_bf16_f32 v189, v190, v191
    v_mfma_f32_16x16x32_bf16 v[84:87], v[44:47], a[240:243], v[84:87]
    v_cvt_pk_bf16_f32 v126, v252, v253
    v_cvt_pk_bf16_f32 v127, v254, v255
    v_mfma_f32_16x16x32_bf16 v[88:91], v[40:43], a[228:231], v[88:91]
    v_cvt_pk_bf16_f32 v158, v240, v241
    v_cvt_pk_bf16_f32 v159, v242, v243
    v_mfma_f32_16x16x32_bf16 v[88:91], v[44:47], a[244:247], v[88:91]
    v_cvt_pk_bf16_f32 v190, v96, v97
    v_cvt_pk_bf16_f32 v191, v98, v99
    v_mfma_f32_16x16x32_bf16 v[92:95], v[40:43], a[232:235], v[92:95]
    buffer_load_dwordx4 v26, s[12:15], s69 offen nt lds
    v_mfma_f32_16x16x32_bf16 v[92:95], v[44:47], a[248:251], v[92:95]
    s_waitcnt lgkmcnt(6)
    ds_read_b128 v[40:43], v1 offset:33536
    v_cvt_pk_bf16_f32 v132, v132, v133
    v_mfma_f32_16x16x32_bf16 v[148:151], v[48:51], a[224:227], v[148:151]
    ds_read_b128 v[44:47], v1 offset:33664
    v_cvt_pk_bf16_f32 v133, v134, v135
    v_mfma_f32_16x16x32_bf16 v[148:151], v[52:55], a[240:243], v[148:151]
    v_cvt_pk_bf16_f32 v164, v164, v165
    v_cvt_pk_bf16_f32 v165, v166, v167
    v_mfma_f32_16x16x32_bf16 v[180:183], v[48:51], a[228:231], v[180:183]
    v_cvt_pk_bf16_f32 v196, v196, v197
    v_cvt_pk_bf16_f32 v197, v198, v199
    v_mfma_f32_16x16x32_bf16 v[180:183], v[52:55], a[244:247], v[180:183]
    buffer_load_dwordx4 v26, s[12:15], s69 offen offset:1024 nt lds
    v_mfma_f32_16x16x32_bf16 v[212:215], v[48:51], a[232:235], v[212:215]
    v_cvt_pk_bf16_f32 v134, v100, v101
    v_cvt_pk_bf16_f32 v135, v102, v103
    v_mfma_f32_16x16x32_bf16 v[212:215], v[52:55], a[248:251], v[212:215]
    s_waitcnt lgkmcnt(4)
    v_cvt_pk_bf16_f32 v166, v104, v105
    v_cvt_pk_bf16_f32 v167, v106, v107
    v_mfma_f32_16x16x32_bf16 v[108:111], v[56:59], a[224:227], v[108:111]
    v_cvt_pk_bf16_f32 v198, v80, v81
    v_cvt_pk_bf16_f32 v199, v82, v83
    v_mfma_f32_16x16x32_bf16 v[108:111], v[60:63], a[240:243], v[108:111]
    v_cvt_pk_bf16_f32 v140, v140, v141
    v_cvt_pk_bf16_f32 v141, v142, v143
    v_mfma_f32_16x16x32_bf16 v[112:115], v[56:59], a[228:231], v[112:115]
    v_cvt_pk_bf16_f32 v172, v172, v173
    v_cvt_pk_bf16_f32 v173, v174, v175
    v_mfma_f32_16x16x32_bf16 v[112:115], v[60:63], a[244:247], v[112:115]
    v_cvt_pk_bf16_f32 v204, v204, v205
    v_cvt_pk_bf16_f32 v205, v206, v207
    v_mfma_f32_16x16x32_bf16 v[116:119], v[56:59], a[232:235], v[116:119]
    v_cvt_pk_bf16_f32 v142, v84, v85
    v_cvt_pk_bf16_f32 v143, v86, v87
    v_mfma_f32_16x16x32_bf16 v[116:119], v[60:63], a[248:251], v[116:119]
    s_waitcnt lgkmcnt(3)
    v_cvt_pk_bf16_f32 v174, v88, v89
    v_cvt_pk_bf16_f32 v175, v90, v91
    v_mfma_f32_16x16x32_bf16 v[64:67], v[32:35], v[120:123], 0
    s_waitcnt lgkmcnt(2)
    v_cvt_pk_bf16_f32 v206, v92, v93
    v_cvt_pk_bf16_f32 v207, v94, v95
    v_mfma_f32_16x16x32_bf16 v[64:67], v[36:39], v[128:131], v[64:67]
    s_barrier
    v_mfma_f32_16x16x32_bf16 v[68:71], v[32:35], v[152:155], 0
    s_mov_b64 s[12:13], s[60:61]
    ds_read_b128 a[224:227], v8 offset:0
    v_cvt_pk_bf16_f32 v148, v148, v149
    v_mfma_f32_16x16x32_bf16 v[68:71], v[36:39], v[160:163], v[68:71]
    s_add_u32 s69, s81, 32768
    ds_read_b128 a[228:231], v8 offset:1024
    v_cvt_pk_bf16_f32 v149, v150, v151
    v_mfma_f32_16x16x32_bf16 v[72:75], v[32:35], v[184:187], 0
    s_add_u32 m0, s71, 66560
    ds_read_b128 v[48:51], v1 offset:33344
    v_cvt_pk_bf16_f32 v180, v180, v181
    v_mfma_f32_16x16x32_bf16 v[72:75], v[36:39], v[192:195], v[72:75]
    ds_read_b128 v[52:55], v1 offset:33472
    v_cvt_pk_bf16_f32 v181, v182, v183
    v_mfma_f32_16x16x32_bf16 v[76:79], v[32:35], v[216:219], 0
    ds_read_b128 a[232:235], v8 offset:2048
    v_cvt_pk_bf16_f32 v212, v212, v213
    v_mfma_f32_16x16x32_bf16 v[76:79], v[36:39], v[220:223], v[76:79]
    s_waitcnt lgkmcnt(5)
    ds_read_b128 a[236:239], v8 offset:3072
    v_cvt_pk_bf16_f32 v213, v214, v215
    v_mfma_f32_16x16x32_bf16 v[64:67], v[40:43], v[136:139], v[64:67]
    ds_read_b128 v[56:59], v1 offset:33600
    v_cvt_pk_bf16_f32 v150, v108, v109
    v_mfma_f32_16x16x32_bf16 v[64:67], v[44:47], v[144:147], v[64:67]
    ds_read_b128 v[60:63], v1 offset:33728
    v_cvt_pk_bf16_f32 v151, v110, v111
    v_mfma_f32_16x16x32_bf16 v[68:71], v[40:43], v[168:171], v[68:71]
    ds_read_b128 v[32:35], v1 offset:34304
    v_cvt_pk_bf16_f32 v182, v112, v113
    v_mfma_f32_16x16x32_bf16 v[68:71], v[44:47], v[176:179], v[68:71]
    ds_read_b128 v[36:39], v1 offset:34432
    v_cvt_pk_bf16_f32 v183, v114, v115
    v_mfma_f32_16x16x32_bf16 v[72:75], v[40:43], v[200:203], v[72:75]
    v_cvt_pk_bf16_f32 v214, v116, v117
    v_cvt_pk_bf16_f32 v215, v118, v119
    v_mfma_f32_16x16x32_bf16 v[72:75], v[44:47], v[208:211], v[72:75]
    v_add_u32 v7, s86, v26
    v_xor_b32 v8, 1024, v7
    v_mfma_f32_16x16x32_bf16 v[76:79], v[40:43], v[224:227], v[76:79]
    ds_read_b128 v[40:43], v1 offset:34560
    v_accvgpr_write_b32 a0, 0
    v_mfma_f32_16x16x32_bf16 v[76:79], v[44:47], v[228:231], v[76:79]
    s_waitcnt lgkmcnt(7)
    ds_read_b128 v[44:47], v1 offset:34688
    v_accvgpr_write_b32 a1, 0
    v_mfma_f32_16x16x32_bf16 v[64:67], v[48:51], v[124:127], v[64:67]
    buffer_load_dwordx4 v26, s[12:15], s69 offen nt lds
    v_mfma_f32_16x16x32_bf16 v[64:67], v[52:55], v[132:135], v[64:67]
    v_accvgpr_write_b32 a2, 0
    v_accvgpr_write_b32 a3, 0
    v_mfma_f32_16x16x32_bf16 v[68:71], v[48:51], v[156:159], v[68:71]
    v_accvgpr_write_b32 a4, 0
    v_accvgpr_write_b32 a5, 0
    v_mfma_f32_16x16x32_bf16 v[68:71], v[52:55], v[164:167], v[68:71]
    v_accvgpr_write_b32 a6, 0
    v_accvgpr_write_b32 a7, 0
    v_mfma_f32_16x16x32_bf16 v[72:75], v[48:51], v[188:191], v[72:75]
    v_accvgpr_write_b32 a8, 0
    v_accvgpr_write_b32 a9, 0
    v_mfma_f32_16x16x32_bf16 v[72:75], v[52:55], v[196:199], v[72:75]
    v_accvgpr_write_b32 a10, 0
    v_accvgpr_write_b32 a11, 0
    v_mfma_f32_16x16x32_bf16 v[76:79], v[48:51], a[224:227], v[76:79]
    ds_read_b128 v[48:51], v1 offset:34368
    v_accvgpr_write_b32 a12, 0
    v_mfma_f32_16x16x32_bf16 v[76:79], v[52:55], a[228:231], v[76:79]
    s_waitcnt lgkmcnt(5)
    ds_read_b128 v[52:55], v1 offset:34496
    v_accvgpr_write_b32 a13, 0
    v_mfma_f32_16x16x32_bf16 v[64:67], v[56:59], v[140:143], v[64:67]
    v_accvgpr_write_b32 a14, 0
    v_accvgpr_write_b32 a15, 0
    v_mfma_f32_16x16x32_bf16 v[64:67], v[60:63], v[148:151], v[64:67]
    v_accvgpr_write_b32 a16, 0
    v_accvgpr_write_b32 a17, 0
    v_mfma_f32_16x16x32_bf16 v[68:71], v[56:59], v[172:175], v[68:71]
    buffer_load_dwordx4 v26, s[12:15], s69 offen offset:1024 nt lds
    v_mfma_f32_16x16x32_bf16 v[68:71], v[60:63], v[180:183], v[68:71]
    s_add_u32 s69, s81, 40960
    v_accvgpr_write_b32 a18, 0
    v_accvgpr_write_b32 a19, 0
    v_mfma_f32_16x16x32_bf16 v[72:75], v[56:59], v[204:207], v[72:75]
    s_add_u32 m0, s71, 74880
    v_max3_f32 v16, v64, v65, v66
    v_accvgpr_write_b32 a20, 0
    v_mfma_f32_16x16x32_bf16 v[72:75], v[60:63], v[212:215], v[72:75]
    v_max3_f32 v17, v68, v69, v70
    v_accvgpr_write_b32 a21, 0
    v_mfma_f32_16x16x32_bf16 v[76:79], v[56:59], a[232:235], v[76:79]
    ds_read_b128 v[56:59], v1 offset:34624
    v_accvgpr_write_b32 a22, 0
    v_mfma_f32_16x16x32_bf16 v[76:79], v[60:63], a[236:239], v[76:79]
    s_waitcnt lgkmcnt(5)
    ds_read_b128 v[60:63], v1 offset:34752
    v_accvgpr_write_b32 a23, 0
    v_mfma_f32_16x16x32_bf16 v[96:99], v[32:35], v[120:123], 0
    v_max3_f32 v18, v72, v73, v74
    v_mfma_f32_16x16x32_bf16 v[96:99], v[36:39], v[128:131], v[96:99]
    v_mfma_f32_16x16x32_bf16 v[100:103], v[32:35], v[152:155], 0
    v_mfma_f32_16x16x32_bf16 v[100:103], v[36:39], v[160:163], v[100:103]
    v_mfma_f32_16x16x32_bf16 v[104:107], v[32:35], v[184:187], 0
    ds_read_b128 v[32:35], v1 offset:49920
    v_max3_f32 v19, v76, v77, v78
    v_mfma_f32_16x16x32_bf16 v[104:107], v[36:39], v[192:195], v[104:107]
    s_waitcnt lgkmcnt(5)
    ds_read_b128 v[36:39], v1 offset:49984
    v_max_f32 v16, v16, v67
    v_mfma_f32_16x16x32_bf16 v[96:99], v[40:43], v[136:139], v[96:99]
    v_max_f32 v17, v17, v71
    v_max_f32 v18, v18, v75
    v_mfma_f32_16x16x32_bf16 v[96:99], v[44:47], v[144:147], v[96:99]
    v_max_f32 v19, v19, v79
    v_mov_b32 v20, v16
    v_mfma_f32_16x16x32_bf16 v[100:103], v[40:43], v[168:171], v[100:103]
    v_mov_b32 v21, v17
    v_mov_b32 v22, v18
    v_mfma_f32_16x16x32_bf16 v[100:103], v[44:47], v[176:179], v[100:103]
    v_mov_b32 v23, v19
    v_permlane16_swap_b32 v16, v20
    v_mfma_f32_16x16x32_bf16 v[104:107], v[40:43], v[200:203], v[104:107]
    ds_read_b128 v[40:43], v1 offset:50048
    v_permlane16_swap_b32 v17, v21
    v_mfma_f32_16x16x32_bf16 v[104:107], v[44:47], v[208:211], v[104:107]
    s_waitcnt lgkmcnt(5)
    ds_read_b128 v[44:47], v1 offset:50112
    v_permlane16_swap_b32 v18, v22
    v_mfma_f32_16x16x32_bf16 v[96:99], v[48:51], v[124:127], v[96:99]
    v_permlane16_swap_b32 v19, v23
    v_max_f32_e64 v16, v16, v20
    v_mfma_f32_16x16x32_bf16 v[96:99], v[52:55], v[132:135], v[96:99]
    v_max_f32 v17, v17, v21
    v_max_f32 v18, v18, v22
    v_mfma_f32_16x16x32_bf16 v[100:103], v[48:51], v[156:159], v[100:103]
    v_max_f32 v19, v19, v23
    v_mov_b32 v20, v16
    v_mfma_f32_16x16x32_bf16 v[100:103], v[52:55], v[164:167], v[100:103]
    v_mov_b32 v21, v17
    v_mov_b32 v22, v18
    v_mfma_f32_16x16x32_bf16 v[104:107], v[48:51], v[188:191], v[104:107]
    ds_read_b128 v[48:51], v1 offset:50176
    v_mov_b32_e64 v23, v19
    v_mfma_f32_16x16x32_bf16 v[104:107], v[52:55], v[196:199], v[104:107]
    s_waitcnt lgkmcnt(5)
    ds_read_b128 v[52:55], v1 offset:50240
    v_permlane32_swap_b32 v16, v20
    v_mfma_f32_16x16x32_bf16 v[96:99], v[56:59], v[140:143], v[96:99]
    v_permlane32_swap_b32 v17, v21
    v_permlane32_swap_b32 v18, v22
    v_mfma_f32_16x16x32_bf16 v[96:99], v[60:63], v[148:151], v[96:99]
    v_permlane32_swap_b32 v19, v23
    v_max_f32 v16, v16, v20
    v_max_f32 v17, v17, v21
    v_mfma_f32_16x16x32_bf16 v[100:103], v[56:59], v[172:175], v[100:103]
    v_max_f32 v18, v18, v22
    v_max_f32_e64 v19, v19, v23
    v_mul_f32 v16, -v16, s84
    v_mfma_f32_16x16x32_bf16 v[100:103], v[60:63], v[180:183], v[100:103]
    v_mul_f32 v17, -v17, s84
    v_mul_f32 v18, -v18, s84
    v_mul_f32 v19, -v19, s84
    v_mfma_f32_16x16x32_bf16 v[104:107], v[56:59], v[204:207], v[104:107]
    s_cmp_lg_u32 s90, 0
    s_cbranch_scc1 L_max0
    L_maxok0:
    ds_read_b128 v[56:59], v1 offset:50304
    v_fma_f32 v76, v76, s84, v19
    v_fma_f32 v77, v77, s84, v19
    v_mfma_f32_16x16x32_bf16 v[104:107], v[60:63], v[212:215], v[104:107]
    s_waitcnt lgkmcnt(5)
    ds_read_b128 v[60:63], v1 offset:50368
    v_fma_f32 v78, v78, s84, v19
    v_fma_f32 v79, v79, s84, v19
    v_mfma_f32_16x16x32_bf16 v[92:95], v[32:35], v[216:219], 0
    buffer_load_dwordx4 v26, s[12:15], s69 offen nt lds
    v_mfma_f32_16x16x32_bf16 v[92:95], v[36:39], a[224:227], v[92:95]
    buffer_load_dwordx4 v26, s[12:15], s69 offen offset:1024 nt lds
    v_mfma_f32_16x16x32_bf16 v[80:83], v[32:35], v[120:123], 0
    s_mov_b64 s[12:13], s[58:59]
    v_exp_f32_e64 v76, v76
    v_fma_f32 v64, v64, s84, v16
    v_mfma_f32_16x16x32_bf16 v[80:83], v[36:39], v[124:127], v[80:83]
    s_add_u32 s69, s81, 65536
    v_exp_f32_e64 v77, v77
    v_fma_f32 v65, v65, s84, v16
    v_mfma_f32_16x16x32_bf16 v[84:87], v[32:35], v[152:155], 0
    s_add_u32 m0, s71, 83200
    v_exp_f32_e64 v78, v78
    v_fma_f32 v66, v66, s84, v16
    v_mfma_f32_16x16x32_bf16 v[84:87], v[36:39], v[156:159], v[84:87]
    v_exp_f32_e64 v79, v79
    v_fma_f32 v67, v67, s84, v16
    v_mfma_f32_16x16x32_bf16 v[88:91], v[32:35], v[184:187], 0
    ds_read_b128 v[32:35], v1 offset:50944
    v_add_f32 v15, v15, v76
    v_add_f32 v15, v15, v77
    v_mfma_f32_16x16x32_bf16 v[88:91], v[36:39], v[188:191], v[88:91]
    s_waitcnt lgkmcnt(5)
    ds_read_b128 v[36:39], v1 offset:51008
    v_cvt_pk_bf16_f32 v76, v76, v77
    v_add_f32 v15, v15, v78
    v_mfma_f32_16x16x32_bf16 v[92:95], v[40:43], v[220:223], v[92:95]
    v_add_f32_e64 v15, v15, v79
    v_cvt_pk_bf16_f32 v77, v78, v79
    v_fma_f32 v68, v68, s84, v17
    v_mfma_f32_16x16x32_bf16 v[92:95], v[44:47], a[228:231], v[92:95]
    ds_write_b64 v7, v[76:77] offset:8192
    v_mfma_f32_16x16x32_bf16 v[80:83], v[40:43], v[128:131], v[80:83]
    v_exp_f32_e64 v64, v64
    v_fma_f32 v69, v69, s84, v17
    v_mfma_f32_16x16x32_bf16 v[80:83], v[44:47], v[132:135], v[80:83]
    v_exp_f32 v65, v65
    v_fma_f32 v70, v70, s84, v17
    v_mfma_f32_16x16x32_bf16 v[84:87], v[40:43], v[160:163], v[84:87]
    v_exp_f32 v66, v66
    v_fma_f32 v71, v71, s84, v17
    v_mfma_f32_16x16x32_bf16 v[84:87], v[44:47], v[164:167], v[84:87]
    v_exp_f32 v67, v67
    v_add_f32 v12, v12, v64
    v_mfma_f32_16x16x32_bf16 v[88:91], v[40:43], v[192:195], v[88:91]
    buffer_load_dwordx4 v26, s[12:15], s69 offen nt lds
    v_mfma_f32_16x16x32_bf16 v[88:91], v[44:47], v[196:199], v[88:91]
    s_waitcnt lgkmcnt(5)
    ds_read_b128 v[40:43], v1 offset:51072
    v_add_f32 v12, v12, v65
    v_cvt_pk_bf16_f32 v64, v64, v65
    v_mfma_f32_16x16x32_bf16 v[92:95], v[48:51], v[224:227], v[92:95]
    ds_read_b128 v[44:47], v1 offset:51136
    v_add_f32 v12, v12, v66
    v_add_f32 v12, v12, v67
    v_mfma_f32_16x16x32_bf16 v[92:95], v[52:55], a[232:235], v[92:95]
    v_cvt_pk_bf16_f32 v65, v66, v67
    v_exp_f32 v68, v68
    v_mfma_f32_16x16x32_bf16 v[80:83], v[48:51], v[136:139], v[80:83]
    v_exp_f32 v69, v69
    v_fma_f32 v72, v72, s84, v18
    v_mfma_f32_16x16x32_bf16 v[80:83], v[52:55], v[140:143], v[80:83]
    v_exp_f32_e64 v70, v70
    v_fma_f32 v73, v73, s84, v18
    v_mfma_f32_16x16x32_bf16 v[84:87], v[48:51], v[168:171], v[84:87]
    v_exp_f32_e64 v71, v71
    v_fma_f32 v74, v74, s84, v18
    v_mfma_f32_16x16x32_bf16 v[84:87], v[52:55], v[172:175], v[84:87]
    v_fma_f32 v75, v75, s84, v18
    v_add_f32 v13, v13, v68
    v_add_f32 v13, v13, v69
    v_mfma_f32_16x16x32_bf16 v[88:91], v[48:51], v[200:203], v[88:91]
    ds_read_b128 v[48:51], v1 offset:51200
    v_cvt_pk_bf16_f32 v68, v68, v69
    v_add_f32 v13, v13, v70
    v_mfma_f32_16x16x32_bf16 v[88:91], v[52:55], v[204:207], v[88:91]
    s_waitcnt lgkmcnt(6)
    ds_read_b128 v[52:55], v1 offset:51264
    v_add_f32_e64 v13, v13, v71
    v_cvt_pk_bf16_f32 v69, v70, v71
    v_mfma_f32_16x16x32_bf16 v[92:95], v[56:59], v[228:231], v[92:95]
    buffer_load_dwordx4 v26, s[12:15], s69 offen offset:1024 nt lds
    v_mfma_f32_16x16x32_bf16 v[92:95], v[60:63], a[236:239], v[92:95]
    s_add_u32 s69, s81, 73728
    v_exp_f32_e64 v72, v72
    v_fma_f32 v96, v96, s84, v16
    v_mfma_f32_16x16x32_bf16 v[80:83], v[56:59], v[144:147], v[80:83]
    s_add_u32 m0, s71, 91520
    v_exp_f32_e64 v73, v73
    v_fma_f32 v97, v97, s84, v16
    v_mfma_f32_16x16x32_bf16 v[80:83], v[60:63], v[148:151], v[80:83]
    v_exp_f32 v74, v74
    v_fma_f32 v98, v98, s84, v16
    v_mfma_f32_16x16x32_bf16 v[84:87], v[56:59], v[176:179], v[84:87]
    v_exp_f32 v75, v75
    v_fma_f32 v99, v99, s84, v16
    v_mfma_f32_16x16x32_bf16 v[84:87], v[60:63], v[180:183], v[84:87]
    v_add_f32_e64 v14, v14, v72
    v_add_f32_e64 v14, v14, v73
    v_cvt_pk_bf16_f32 v72, v72, v73
    v_mfma_f32_16x16x32_bf16 v[88:91], v[56:59], v[208:211], v[88:91]
    ds_read_b128 v[56:59], v1 offset:51328
    v_add_f32_e64 v14, v14, v74
    v_add_f32 v14, v14, v75
    v_mfma_f32_16x16x32_bf16 v[88:91], v[60:63], v[212:215], v[88:91]
    s_waitcnt lgkmcnt(7)
    ds_read_b128 v[60:63], v1 offset:51392
    v_cvt_pk_bf16_f32 v73, v74, v75
    v_fma_f32 v100, v100, s84, v17
    v_mfma_f32_16x16x32_bf16 v[108:111], v[32:35], v[120:123], 0
    s_waitcnt vmcnt(56) lgkmcnt(6)
    v_exp_f32 v96, v96
    v_fma_f32 v101, v101, s84, v17
    v_mfma_f32_16x16x32_bf16 v[108:111], v[36:39], v[124:127], v[108:111]
    s_barrier
    v_mfma_f32_16x16x32_bf16 v[112:115], v[32:35], v[152:155], 0
    v_exp_f32 v97, v97
    v_fma_f32 v102, v102, s84, v17
    v_mfma_f32_16x16x32_bf16 v[112:115], v[36:39], v[156:159], v[112:115]
    v_exp_f32_e64 v98, v98
    v_fma_f32 v103, v103, s84, v17
    v_mfma_f32_16x16x32_bf16 v[116:119], v[32:35], v[184:187], 0
    ds_read_b64_tr_b16 v[32:33], v2 offset:256
    v_exp_f32 v99, v99
    v_mfma_f32_16x16x32_bf16 v[116:119], v[36:39], v[188:191], v[116:119]
    s_waitcnt lgkmcnt(5)
    ds_read_b64_tr_b16 v[34:35], v2 offset:1280
    v_add_f32 v12, v12, v96
    v_add_f32 v12, v12, v97
    v_mfma_f32_16x16x32_bf16 v[108:111], v[40:43], v[128:131], v[108:111]
    ds_read_b64_tr_b16 v[36:37], v2 offset:288
    v_cvt_pk_bf16_f32 v66, v96, v97
    v_add_f32 v12, v12, v98
    v_mfma_f32_16x16x32_bf16 v[108:111], v[44:47], v[132:135], v[108:111]
    ds_read_b64_tr_b16 v[38:39], v2 offset:1312
    v_add_f32 v12, v12, v99
    v_cvt_pk_bf16_f32 v67, v98, v99
    v_mfma_f32_16x16x32_bf16 v[112:115], v[40:43], v[160:163], v[112:115]
    buffer_load_dwordx4 v26, s[12:15], s69 offen nt lds
    v_mfma_f32_16x16x32_bf16 v[112:115], v[44:47], v[164:167], v[112:115]
    ds_read_b64 v[78:79], v8 offset:8192
    v_exp_f32 v100, v100
    v_mfma_f32_16x16x32_bf16 v[116:119], v[40:43], v[192:195], v[116:119]
    ds_read_b64_tr_b16 v[40:41], v2 offset:0
    v_exp_f32 v101, v101
    v_mfma_f32_16x16x32_bf16 v[116:119], v[44:47], v[196:199], v[116:119]
    s_waitcnt lgkmcnt(8)
    ds_read_b64_tr_b16 v[42:43], v2 offset:1024
    v_exp_f32 v102, v102
    v_mfma_f32_16x16x32_bf16 v[108:111], v[48:51], v[136:139], v[108:111]
    ds_read_b64_tr_b16 v[44:45], v2 offset:32
    v_exp_f32_e64 v103, v103
    v_mfma_f32_16x16x32_bf16 v[108:111], v[52:55], v[140:143], v[108:111]
    ds_read_b64_tr_b16 v[46:47], v2 offset:1056
    v_fma_f32 v104, v104, s84, v18
    v_fma_f32 v105, v105, s84, v18
    v_mfma_f32_16x16x32_bf16 v[112:115], v[48:51], v[168:171], v[112:115]
    v_fma_f32 v106, v106, s84, v18
    v_fma_f32 v107, v107, s84, v18
    v_add_f32 v13, v13, v100
    v_mfma_f32_16x16x32_bf16 v[112:115], v[52:55], v[172:175], v[112:115]
    v_add_f32 v13, v13, v101
    v_cvt_pk_bf16_f32 v70, v100, v101
    v_add_f32_e64 v13, v13, v102
    v_mfma_f32_16x16x32_bf16 v[116:119], v[48:51], v[200:203], v[116:119]
    v_add_f32 v13, v13, v103
    v_cvt_pk_bf16_f32 v71, v102, v103
    v_subrev_u32 v1, s72, v1
    v_mfma_f32_16x16x32_bf16 v[116:119], v[52:55], v[204:207], v[116:119]
    s_waitcnt lgkmcnt(9)
    v_exp_f32 v104, v104
    v_mfma_f32_16x16x32_bf16 v[108:111], v[56:59], v[144:147], v[108:111]
    v_exp_f32 v105, v105
    v_add_f32 v14, v14, v104
    v_mfma_f32_16x16x32_bf16 v[108:111], v[60:63], v[148:151], v[108:111]
    v_exp_f32 v106, v106
    v_add_f32 v14, v14, v105
    v_mfma_f32_16x16x32_bf16 v[112:115], v[56:59], v[176:179], v[112:115]
    v_exp_f32_e64 v107, v107
    v_cvt_pk_bf16_f32 v74, v104, v105
    v_mfma_f32_16x16x32_bf16 v[112:115], v[60:63], v[180:183], v[112:115]
    v_add_f32 v14, v14, v106
    v_add_f32 v14, v14, v107
    v_cvt_pk_bf16_f32 v75, v106, v107
    v_mfma_f32_16x16x32_bf16 v[116:119], v[56:59], v[208:211], v[116:119]
    buffer_load_dwordx4 v26, s[12:15], s69 offen offset:1024 nt lds
    v_mfma_f32_16x16x32_bf16 v[116:119], v[60:63], v[212:215], v[116:119]
    s_mov_b64 s[12:13], s[60:61]
    s_add_u32 s69, s81, 49152
    s_add_u32 m0, s71, 99840
    s_nop 0
    buffer_load_dwordx4 v26, s[12:15], s69 offen nt lds
    buffer_load_dwordx4 v26, s[12:15], s69 offen offset:1024 nt lds
    v_or_b32 v4, s53, v11
    buffer_atomic_add v5, v4, s[32:35], 0 offen
    s_nop 1
L_attn0:
    s_waitcnt lgkmcnt(5)
    v_mfma_f32_16x16x32_bf16 a[32:35], v[32:35], v[64:67], a[32:35]
    s_bitcmp1_b64 s[62:63], s70
    ds_read_b64_tr_b16 v[48:49], v2 offset:320
    s_cselect_b64 s[12:13], s[58:59], s[60:61]
    v_mfma_f32_16x16x32_bf16 a[36:39], v[36:39], v[64:67], a[36:39]
    s_cselect_b32 s69, s67, s68
    ds_read_b64_tr_b16 v[50:51], v2 offset:1344
    s_cselect_b32 s87, 8192, 0
    v_mfma_f32_16x16x32_bf16 a[96:99], v[32:35], v[68:71], a[96:99]
    s_add_u32 s67, s67, s87
    ds_read_b64_tr_b16 v[52:53], v2 offset:352
    v_fma_f32 v92, v92, s84, v19
    v_mfma_f32_16x16x32_bf16 a[100:103], v[36:39], v[68:71], a[100:103]
    s_xor_b32 s87, s87, 8192
    ds_read_b64_tr_b16 v[54:55], v2 offset:1376
    v_fma_f32 v93, v93, s84, v19
    v_mfma_f32_16x16x32_bf16 a[160:163], v[32:35], v[72:75], a[160:163]
    s_add_u32 s68, s68, s87
    ds_read_b64_tr_b16 v[56:57], v2 offset:64
    v_fma_f32 v94, v94, s84, v19
    v_mfma_f32_16x16x32_bf16 a[164:167], v[36:39], v[72:75], a[164:167]
    s_waitcnt lgkmcnt(5)
    ds_read_b64_tr_b16 v[58:59], v2 offset:1088
    v_fma_f32 v95, v95, s84, v19
    v_mfma_f32_16x16x32_bf16 a[0:3], v[40:43], v[64:67], a[0:3]
    s_and_b32 s87, s70, 15
    ds_read_b64_tr_b16 v[60:61], v2 offset:96
    v_fma_f32 v80, v80, s84, v16
    v_mfma_f32_16x16x32_bf16 a[4:7], v[44:47], v[64:67], a[4:7]
    s_mul_i32 s87, s87, 8320
    ds_read_b64_tr_b16 v[62:63], v2 offset:1120
    v_fma_f32 v81, v81, s84, v16
    v_mfma_f32_16x16x32_bf16 a[64:67], v[40:43], v[68:71], a[64:67]
    s_add_u32 m0, s87, s71
    v_exp_f32 v92, v92
    v_mfma_f32_16x16x32_bf16 a[68:71], v[44:47], v[68:71], a[68:71]
    s_add_u32 s70, s70, 1
    v_exp_f32 v93, v93
    v_mfma_f32_16x16x32_bf16 a[128:131], v[40:43], v[72:75], a[128:131]
    buffer_load_dwordx4 v26, s[12:15], s69 offen nt lds
    v_mfma_f32_16x16x32_bf16 a[132:135], v[44:47], v[72:75], a[132:135]
    v_exp_f32 v94, v94
    v_mfma_f32_16x16x32_bf16 a[192:195], v[40:43], v[76:79], a[192:195]
    v_exp_f32 v95, v95
    v_mfma_f32_16x16x32_bf16 a[196:199], v[44:47], v[76:79], a[196:199]
    s_waitcnt lgkmcnt(4)
    ds_read_b64_tr_b16 v[32:33], v2 offset:384
    v_add_f32 v15, v15, v92
    v_mfma_f32_16x16x32_bf16 a[40:43], v[48:51], v[64:67], a[40:43]
    ds_read_b64_tr_b16 v[34:35], v2 offset:1408
    v_add_f32_e64 v15, v15, v93
    v_mfma_f32_16x16x32_bf16 a[44:47], v[52:55], v[64:67], a[44:47]
    ds_read_b64_tr_b16 v[36:37], v2 offset:416
    v_cvt_pk_bf16_f32 v92, v92, v93
    v_mfma_f32_16x16x32_bf16 a[104:107], v[48:51], v[68:71], a[104:107]
    ds_read_b64_tr_b16 v[38:39], v2 offset:1440
    v_add_f32_e64 v15, v15, v94
    v_mfma_f32_16x16x32_bf16 a[108:111], v[52:55], v[68:71], a[108:111]
    ds_read_b64_tr_b16 v[40:41], v2 offset:128
    v_add_f32 v15, v15, v95
    v_mfma_f32_16x16x32_bf16 a[168:171], v[48:51], v[72:75], a[168:171]
    ds_read_b64_tr_b16 v[42:43], v2 offset:1152
    v_cvt_pk_bf16_f32 v93, v94, v95
    v_mfma_f32_16x16x32_bf16 a[172:175], v[52:55], v[72:75], a[172:175]
    s_waitcnt lgkmcnt(6)
    ds_read_b64_tr_b16 v[44:45], v2 offset:160
    v_fma_f32 v82, v82, s84, v16
    v_mfma_f32_16x16x32_bf16 a[8:11], v[56:59], v[64:67], a[8:11]
    ds_write_b64 v7, v[92:93] offset:8200
    v_mfma_f32_16x16x32_bf16 a[12:15], v[60:63], v[64:67], a[12:15]
    ds_read_b64_tr_b16 v[46:47], v2 offset:1184
    v_fma_f32 v83, v83, s84, v16
    v_mfma_f32_16x16x32_bf16 a[72:75], v[56:59], v[68:71], a[72:75]
    v_exp_f32 v80, v80
    v_mfma_f32_16x16x32_bf16 a[76:79], v[60:63], v[68:71], a[76:79]
    v_exp_f32 v81, v81
    v_mfma_f32_16x16x32_bf16 a[136:139], v[56:59], v[72:75], a[136:139]
    v_exp_f32_e64 v82, v82
    v_mfma_f32_16x16x32_bf16 a[140:143], v[60:63], v[72:75], a[140:143]
    buffer_load_dwordx4 v26, s[12:15], s69 offen offset:1024 nt lds
    v_mfma_f32_16x16x32_bf16 a[200:203], v[56:59], v[76:79], a[200:203]
    s_bitcmp1_b64 s[62:63], s70
    v_exp_f32_e64 v83, v83
    v_mfma_f32_16x16x32_bf16 a[204:207], v[60:63], v[76:79], a[204:207]
    s_waitcnt lgkmcnt(5)
    ds_read_b64_tr_b16 v[48:49], v2 offset:448
    v_add_f32 v12, v12, v80
    v_mfma_f32_16x16x32_bf16 a[48:51], v[32:35], v[64:67], a[48:51]
    s_cselect_b64 s[12:13], s[58:59], s[60:61]
    ds_read_b64_tr_b16 v[50:51], v2 offset:1472
    v_add_f32 v12, v12, v81
    v_mfma_f32_16x16x32_bf16 a[52:55], v[36:39], v[64:67], a[52:55]
    s_cselect_b32 s69, s67, s68
    ds_read_b64_tr_b16 v[52:53], v2 offset:480
    v_cvt_pk_bf16_f32 v80, v80, v81
    v_mfma_f32_16x16x32_bf16 a[112:115], v[32:35], v[68:71], a[112:115]
    s_cselect_b32 s87, 8192, 0
    ds_read_b64_tr_b16 v[54:55], v2 offset:1504
    v_add_f32_e64 v12, v12, v82
    v_mfma_f32_16x16x32_bf16 a[116:119], v[36:39], v[68:71], a[116:119]
    s_add_u32 s67, s67, s87
    ds_read_b64_tr_b16 v[56:57], v2 offset:192
    v_add_f32 v12, v12, v83
    v_mfma_f32_16x16x32_bf16 a[176:179], v[32:35], v[72:75], a[176:179]
    s_xor_b32 s87, s87, 8192
    ds_read_b64_tr_b16 v[58:59], v2 offset:1216
    v_cvt_pk_bf16_f32 v81, v82, v83
    v_mfma_f32_16x16x32_bf16 a[180:183], v[36:39], v[72:75], a[180:183]
    s_waitcnt lgkmcnt(6)
    ds_read_b64_tr_b16 v[60:61], v2 offset:224
    v_fma_f32 v108, v108, s84, v16
    v_mfma_f32_16x16x32_bf16 a[16:19], v[40:43], v[64:67], a[16:19]
    s_add_u32 s68, s68, s87
    ds_read_b64_tr_b16 v[62:63], v2 offset:1248
    v_fma_f32 v109, v109, s84, v16
    v_mfma_f32_16x16x32_bf16 a[20:23], v[44:47], v[64:67], a[20:23]
    s_and_b32 s87, s70, 15
    v_fma_f32 v110, v110, s84, v16
    v_fma_f32 v111, v111, s84, v16
    v_mfma_f32_16x16x32_bf16 a[80:83], v[40:43], v[68:71], a[80:83]
    s_mul_i32 s87, s87, 8320
    v_exp_f32 v108, v108
    v_mfma_f32_16x16x32_bf16 a[84:87], v[44:47], v[68:71], a[84:87]
    s_add_u32 m0, s87, s71
    v_exp_f32 v109, v109
    v_mfma_f32_16x16x32_bf16 a[144:147], v[40:43], v[72:75], a[144:147]
    s_add_u32 s70, s70, 1
    v_exp_f32 v110, v110
    v_mfma_f32_16x16x32_bf16 a[148:151], v[44:47], v[72:75], a[148:151]
    s_waitcnt vmcnt(8)
    v_exp_f32_e64 v111, v111
    v_mfma_f32_16x16x32_bf16 a[208:211], v[40:43], v[76:79], a[208:211]
    s_barrier
    v_mfma_f32_16x16x32_bf16 a[212:215], v[44:47], v[76:79], a[212:215]
    s_waitcnt lgkmcnt(4)
    ds_read_b128 v[32:35], v1 offset:16640
    v_add_f32 v12, v12, v108
    v_mfma_f32_16x16x32_bf16 a[56:59], v[48:51], v[64:67], a[56:59]
    buffer_load_dwordx4 v26, s[12:15], s69 offen nt lds
    v_mfma_f32_16x16x32_bf16 a[60:63], v[52:55], v[64:67], a[60:63]
    ds_read_b128 v[36:39], v1 offset:16704
    v_add_f32_e64 v12, v12, v109
    v_mfma_f32_16x16x32_bf16 a[120:123], v[48:51], v[68:71], a[120:123]
    ds_read_b128 v[40:43], v1 offset:16768
    v_cvt_pk_bf16_f32 v82, v108, v109
    v_mfma_f32_16x16x32_bf16 a[124:127], v[52:55], v[68:71], a[124:127]
    ds_read_b128 v[44:47], v1 offset:16832
    v_add_f32_e64 v12, v12, v110
    v_mfma_f32_16x16x32_bf16 a[184:187], v[48:51], v[72:75], a[184:187]
    ds_read_b128 v[48:51], v1 offset:16896
    v_add_f32 v12, v12, v111
    v_mfma_f32_16x16x32_bf16 a[188:191], v[52:55], v[72:75], a[188:191]
    s_waitcnt lgkmcnt(5)
    ds_read_b128 v[52:55], v1 offset:16960
    v_cvt_pk_bf16_f32 v83, v110, v111
    v_mfma_f32_16x16x32_bf16 a[24:27], v[56:59], v[64:67], a[24:27]
    v_fma_f32 v84, v84, s84, v17
    v_fma_f32 v85, v85, s84, v17
    v_mfma_f32_16x16x32_bf16 a[28:31], v[60:63], v[64:67], a[28:31]
    v_fma_f32 v86, v86, s84, v17
    v_fma_f32 v87, v87, s84, v17
    v_mfma_f32_16x16x32_bf16 a[88:91], v[56:59], v[68:71], a[88:91]
    v_exp_f32_e64 v84, v84
    v_mfma_f32_16x16x32_bf16 a[92:95], v[60:63], v[68:71], a[92:95]
    v_exp_f32 v85, v85
    v_mfma_f32_16x16x32_bf16 a[152:155], v[56:59], v[72:75], a[152:155]
    v_exp_f32 v86, v86
    v_mfma_f32_16x16x32_bf16 a[156:159], v[60:63], v[72:75], a[156:159]
    v_exp_f32_e64 v87, v87
    v_mfma_f32_16x16x32_bf16 a[216:219], v[56:59], v[76:79], a[216:219]
    ds_read_b128 v[56:59], v1 offset:17024
    v_add_f32_e64 v13, v13, v84
    v_mfma_f32_16x16x32_bf16 a[220:223], v[60:63], v[76:79], a[220:223]
    s_waitcnt lgkmcnt(5)
    ds_read_b128 v[60:63], v1 offset:17088
    v_add_f32 v13, v13, v85
    v_mfma_f32_16x16x32_bf16 v[76:79], v[32:35], v[216:219], 0
    v_cvt_pk_bf16_f32 v84, v84, v85
    v_add_f32_e64 v13, v13, v86
    v_mfma_f32_16x16x32_bf16 v[76:79], v[36:39], a[224:227], v[76:79]
    v_add_f32_e64 v13, v13, v87
    v_cvt_pk_bf16_f32 v85, v86, v87
    v_mfma_f32_16x16x32_bf16 v[64:67], v[32:35], v[120:123], 0
    buffer_load_dwordx4 v26, s[12:15], s69 offen offset:1024 nt lds
    v_mfma_f32_16x16x32_bf16 v[64:67], v[36:39], v[124:127], v[64:67]
    s_bitcmp1_b64 s[62:63], s70
    v_fma_f32 v112, v112, s84, v17
    v_fma_f32 v113, v113, s84, v17
    v_mfma_f32_16x16x32_bf16 v[68:71], v[32:35], v[152:155], 0
    s_cselect_b64 s[12:13], s[58:59], s[60:61]
    v_fma_f32 v114, v114, s84, v17
    v_fma_f32 v115, v115, s84, v17
    v_mfma_f32_16x16x32_bf16 v[68:71], v[36:39], v[156:159], v[68:71]
    s_cselect_b32 s69, s67, s68
    v_exp_f32 v112, v112
    v_mfma_f32_16x16x32_bf16 v[72:75], v[32:35], v[184:187], 0
    s_cselect_b32 s87, 8192, 0
    v_exp_f32 v113, v113
    v_mfma_f32_16x16x32_bf16 v[72:75], v[36:39], v[188:191], v[72:75]
    s_waitcnt lgkmcnt(4)
    v_exp_f32 v114, v114
    v_mfma_f32_16x16x32_bf16 v[76:79], v[40:43], v[220:223], v[76:79]
    s_add_u32 s67, s67, s87
    v_exp_f32_e64 v115, v115
    v_mfma_f32_16x16x32_bf16 v[76:79], v[44:47], a[228:231], v[76:79]
    s_xor_b32 s87, s87, 8192
    ds_read_b128 v[32:35], v1 offset:17664
    v_add_f32 v13, v13, v112
    v_mfma_f32_16x16x32_bf16 v[64:67], v[40:43], v[128:131], v[64:67]
    s_add_u32 s68, s68, s87
    ds_read_b128 v[36:39], v1 offset:17728
    v_add_f32 v13, v13, v113
    v_mfma_f32_16x16x32_bf16 v[64:67], v[44:47], v[132:135], v[64:67]
    s_and_b32 s87, s70, 15
    v_cvt_pk_bf16_f32 v86, v112, v113
    v_add_f32 v13, v13, v114
    v_mfma_f32_16x16x32_bf16 v[68:71], v[40:43], v[160:163], v[68:71]
    s_mul_i32 s87, s87, 8320
    v_add_f32 v13, v13, v115
    v_cvt_pk_bf16_f32 v87, v114, v115
    v_mfma_f32_16x16x32_bf16 v[68:71], v[44:47], v[164:167], v[68:71]
    s_add_u32 m0, s87, s71
    v_fma_f32 v88, v88, s84, v18
    v_fma_f32 v89, v89, s84, v18
    v_mfma_f32_16x16x32_bf16 v[72:75], v[40:43], v[192:195], v[72:75]
    s_add_u32 s70, s70, 1
    ds_read_b128 v[40:43], v1 offset:17792
    v_fma_f32 v90, v90, s84, v18
    v_mfma_f32_16x16x32_bf16 v[72:75], v[44:47], v[196:199], v[72:75]
    s_waitcnt lgkmcnt(5)
    ds_read_b128 v[44:47], v1 offset:17856
    v_fma_f32 v91, v91, s84, v18
    v_mfma_f32_16x16x32_bf16 v[76:79], v[48:51], v[224:227], v[76:79]
    v_exp_f32 v88, v88
    v_mfma_f32_16x16x32_bf16 v[76:79], v[52:55], a[232:235], v[76:79]
    v_exp_f32 v89, v89
    v_mfma_f32_16x16x32_bf16 v[64:67], v[48:51], v[136:139], v[64:67]
    v_exp_f32 v90, v90
    v_mfma_f32_16x16x32_bf16 v[64:67], v[52:55], v[140:143], v[64:67]
    v_exp_f32 v91, v91
    v_mfma_f32_16x16x32_bf16 v[68:71], v[48:51], v[168:171], v[68:71]
    buffer_load_dwordx4 v26, s[12:15], s69 offen nt lds
    v_mfma_f32_16x16x32_bf16 v[68:71], v[52:55], v[172:175], v[68:71]
    v_add_f32 v14, v14, v88
    v_add_f32_e64 v14, v14, v89
    v_mfma_f32_16x16x32_bf16 v[72:75], v[48:51], v[200:203], v[72:75]
    ds_read_b128 v[48:51], v1 offset:17920
    v_cvt_pk_bf16_f32 v88, v88, v89
    v_mfma_f32_16x16x32_bf16 v[72:75], v[52:55], v[204:207], v[72:75]
    s_waitcnt lgkmcnt(5)
    ds_read_b128 v[52:55], v1 offset:17984
    v_add_f32 v14, v14, v90
    v_mfma_f32_16x16x32_bf16 v[76:79], v[56:59], v[228:231], v[76:79]
    v_add_f32_e64 v14, v14, v91
    v_cvt_pk_bf16_f32 v89, v90, v91
    v_mfma_f32_16x16x32_bf16 v[76:79], v[60:63], a[236:239], v[76:79]
    v_fma_f32 v116, v116, s84, v18
    v_fma_f32 v117, v117, s84, v18
    v_mfma_f32_16x16x32_bf16 v[64:67], v[56:59], v[144:147], v[64:67]
    v_fma_f32 v118, v118, s84, v18
    v_fma_f32 v119, v119, s84, v18
    v_mfma_f32_16x16x32_bf16 v[64:67], v[60:63], v[148:151], v[64:67]
    v_exp_f32 v116, v116
    v_mfma_f32_16x16x32_bf16 v[68:71], v[56:59], v[176:179], v[68:71]
    v_exp_f32 v117, v117
    v_mfma_f32_16x16x32_bf16 v[68:71], v[60:63], v[180:183], v[68:71]
    v_exp_f32 v118, v118
    v_mfma_f32_16x16x32_bf16 v[72:75], v[56:59], v[208:211], v[72:75]
    v_exp_f32_e64 v119, v119
    v_mfma_f32_16x16x32_bf16 v[72:75], v[60:63], v[212:215], v[72:75]
    s_waitcnt lgkmcnt(4)
    ds_read_b128 v[56:59], v1 offset:18048
    v_add_f32 v14, v14, v116
    v_mfma_f32_16x16x32_bf16 v[96:99], v[32:35], v[120:123], 0
    ds_read_b128 v[60:63], v1 offset:18112
    v_add_f32 v14, v14, v117
    v_mfma_f32_16x16x32_bf16 v[96:99], v[36:39], v[124:127], v[96:99]
    s_waitcnt vmcnt(7) lgkmcnt(14)
    v_cvt_pk_bf16_f32 v90, v116, v117
    v_add_f32 v14, v14, v118
    v_mfma_f32_16x16x32_bf16 v[100:103], v[32:35], v[152:155], 0
    s_barrier
    v_mfma_f32_16x16x32_bf16 v[100:103], v[36:39], v[156:159], v[100:103]
    v_add_f32 v14, v14, v119
    v_cvt_pk_bf16_f32 v91, v118, v119
    v_mfma_f32_16x16x32_bf16 v[104:107], v[32:35], v[184:187], 0
    buffer_load_dwordx4 v26, s[12:15], s69 offen offset:1024 nt lds
    v_mfma_f32_16x16x32_bf16 v[104:107], v[36:39], v[188:191], v[104:107]
    s_waitcnt lgkmcnt(4)
    ds_read_b64_tr_b16 v[32:33], v2 offset:33536
    v_fma_f32 v76, v76, s84, v19
    v_mfma_f32_16x16x32_bf16 v[96:99], v[40:43], v[128:131], v[96:99]
    s_bitcmp1_b64 s[62:63], s70
    ds_read_b64_tr_b16 v[34:35], v2 offset:34560
    v_fma_f32 v77, v77, s84, v19
    v_mfma_f32_16x16x32_bf16 v[96:99], v[44:47], v[132:135], v[96:99]
    s_cselect_b64 s[12:13], s[58:59], s[60:61]
    ds_read_b64_tr_b16 v[36:37], v2 offset:33568
    v_fma_f32 v78, v78, s84, v19
    v_mfma_f32_16x16x32_bf16 v[100:103], v[40:43], v[160:163], v[100:103]
    s_cselect_b32 s69, s67, s68
    ds_read_b64_tr_b16 v[38:39], v2 offset:34592
    v_fma_f32 v79, v79, s84, v19
    v_mfma_f32_16x16x32_bf16 v[100:103], v[44:47], v[164:167], v[100:103]
    s_cselect_b32 s87, 8192, 0
    ds_read_b64 v[94:95], v8 offset:8200
    v_fma_f32 v64, v64, s84, v16
    v_mfma_f32_16x16x32_bf16 v[104:107], v[40:43], v[192:195], v[104:107]
    s_add_u32 s67, s67, s87
    ds_read_b64_tr_b16 v[40:41], v2 offset:33280
    v_fma_f32 v65, v65, s84, v16
    v_mfma_f32_16x16x32_bf16 v[104:107], v[44:47], v[196:199], v[104:107]
    s_waitcnt lgkmcnt(8)
    ds_read_b64_tr_b16 v[42:43], v2 offset:34304
    v_fma_f32 v66, v66, s84, v16
    v_mfma_f32_16x16x32_bf16 v[96:99], v[48:51], v[136:139], v[96:99]
    s_xor_b32 s87, s87, 8192
    ds_read_b64_tr_b16 v[44:45], v2 offset:33312
    v_fma_f32 v67, v67, s84, v16
    v_mfma_f32_16x16x32_bf16 v[96:99], v[52:55], v[140:143], v[96:99]
    s_add_u32 s68, s68, s87
    ds_read_b64_tr_b16 v[46:47], v2 offset:34336
    v_fma_f32 v68, v68, s84, v17
    v_mfma_f32_16x16x32_bf16 v[100:103], v[48:51], v[168:171], v[100:103]
    s_and_b32 s87, s70, 15
    v_exp_f32_e64 v76, v76
    v_mfma_f32_16x16x32_bf16 v[100:103], v[52:55], v[172:175], v[100:103]
    s_mul_i32 s87, s87, 8320
    v_exp_f32 v77, v77
    v_mfma_f32_16x16x32_bf16 v[104:107], v[48:51], v[200:203], v[104:107]
    s_add_u32 m0, s87, s71
    ds_read_b64_tr_b16 v[48:49], v2 offset:33600
    v_add_f32 v15, v15, v76
    v_mfma_f32_16x16x32_bf16 v[104:107], v[52:55], v[204:207], v[104:107]
    s_waitcnt lgkmcnt(10)
    ds_read_b64_tr_b16 v[50:51], v2 offset:34624
    v_add_f32 v15, v15, v77
    v_mfma_f32_16x16x32_bf16 v[96:99], v[56:59], v[144:147], v[96:99]
    s_add_u32 s70, s70, 1
    ds_read_b64_tr_b16 v[52:53], v2 offset:33632
    v_cvt_pk_bf16_f32 v76, v76, v77
    v_mfma_f32_16x16x32_bf16 v[96:99], v[60:63], v[148:151], v[96:99]
    buffer_load_dwordx4 v26, s[12:15], s69 offen nt lds
    v_mfma_f32_16x16x32_bf16 v[100:103], v[56:59], v[176:179], v[100:103]
    ds_read_b64_tr_b16 v[54:55], v2 offset:34656
    v_fma_f32 v69, v69, s84, v17
    v_mfma_f32_16x16x32_bf16 v[100:103], v[60:63], v[180:183], v[100:103]
    v_exp_f32_e64 v78, v78
    v_mfma_f32_16x16x32_bf16 v[104:107], v[56:59], v[208:211], v[104:107]
    ds_read_b64_tr_b16 v[56:57], v2 offset:33344
    v_add_f32 v15, v15, v78
    v_mfma_f32_16x16x32_bf16 v[104:107], v[60:63], v[212:215], v[104:107]
    s_waitcnt lgkmcnt(10)
    ds_read_b64_tr_b16 v[58:59], v2 offset:34368
    v_fma_f32 v70, v70, s84, v17
    v_mfma_f32_16x16x32_bf16 a[32:35], v[32:35], v[80:83], a[32:35]
    ds_read_b64_tr_b16 v[60:61], v2 offset:33376
    v_fma_f32 v71, v71, s84, v17
    v_mfma_f32_16x16x32_bf16 a[36:39], v[36:39], v[80:83], a[36:39]
    ds_read_b64_tr_b16 v[62:63], v2 offset:34400
    v_fma_f32 v72, v72, s84, v18
    v_mfma_f32_16x16x32_bf16 a[96:99], v[32:35], v[84:87], a[96:99]
    v_exp_f32 v79, v79
    v_mfma_f32_16x16x32_bf16 a[100:103], v[36:39], v[84:87], a[100:103]
    v_add_f32_e64 v15, v15, v79
    v_cvt_pk_bf16_f32 v77, v78, v79
    v_mfma_f32_16x16x32_bf16 a[160:163], v[32:35], v[88:91], a[160:163]
    ds_write_b64 v7, v[76:77] offset:8192
    v_mfma_f32_16x16x32_bf16 a[164:167], v[36:39], v[88:91], a[164:167]
    s_waitcnt lgkmcnt(9)
    ds_read_b64_tr_b16 v[32:33], v2 offset:33664
    v_fma_f32 v73, v73, s84, v18
    v_mfma_f32_16x16x32_bf16 a[0:3], v[40:43], v[80:83], a[0:3]
    ds_read_b64_tr_b16 v[34:35], v2 offset:34688
    v_fma_f32 v74, v74, s84, v18
    v_mfma_f32_16x16x32_bf16 a[4:7], v[44:47], v[80:83], a[4:7]
    ds_read_b64_tr_b16 v[36:37], v2 offset:33696
    v_fma_f32 v75, v75, s84, v18
    v_mfma_f32_16x16x32_bf16 a[64:67], v[40:43], v[84:87], a[64:67]
    ds_read_b64_tr_b16 v[38:39], v2 offset:34720
    v_fma_f32 v96, v96, s84, v16
    v_mfma_f32_16x16x32_bf16 a[68:71], v[44:47], v[84:87], a[68:71]
    buffer_load_dwordx4 v26, s[12:15], s69 offen offset:1024 nt lds
    v_mfma_f32_16x16x32_bf16 a[128:131], v[40:43], v[88:91], a[128:131]
    s_bitcmp1_b64 s[62:63], s70
    v_exp_f32 v64, v64
    v_mfma_f32_16x16x32_bf16 a[132:135], v[44:47], v[88:91], a[132:135]
    s_cselect_b64 s[12:13], s[58:59], s[60:61]
    v_exp_f32 v65, v65
    v_mfma_f32_16x16x32_bf16 a[192:195], v[40:43], v[92:95], a[192:195]
    s_cselect_b32 s69, s67, s68
    v_exp_f32 v66, v66
    v_mfma_f32_16x16x32_bf16 a[196:199], v[44:47], v[92:95], a[196:199]
    s_waitcnt lgkmcnt(9)
    v_exp_f32 v67, v67
    v_mfma_f32_16x16x32_bf16 a[40:43], v[48:51], v[80:83], a[40:43]
    s_cselect_b32 s87, 8192, 0
    ds_read_b64_tr_b16 v[40:41], v2 offset:33408
    v_add_f32_e64 v12, v12, v64
    v_mfma_f32_16x16x32_bf16 a[44:47], v[52:55], v[80:83], a[44:47]
    s_add_u32 s67, s67, s87
    ds_read_b64_tr_b16 v[42:43], v2 offset:34432
    v_add_f32 v12, v12, v65
    v_mfma_f32_16x16x32_bf16 a[104:107], v[48:51], v[84:87], a[104:107]
    s_xor_b32 s87, s87, 8192
    ds_read_b64_tr_b16 v[44:45], v2 offset:33440
    v_cvt_pk_bf16_f32 v64, v64, v65
    v_mfma_f32_16x16x32_bf16 a[108:111], v[52:55], v[84:87], a[108:111]
    s_add_u32 s68, s68, s87
    ds_read_b64_tr_b16 v[46:47], v2 offset:34464
    v_add_f32_e64 v12, v12, v66
    v_mfma_f32_16x16x32_bf16 a[168:171], v[48:51], v[88:91], a[168:171]
    s_and_b32 s87, s70, 15
    ds_read_b64_tr_b16 v[48:49], v2 offset:33728
    v_add_f32 v12, v12, v67
    v_mfma_f32_16x16x32_bf16 a[172:175], v[52:55], v[88:91], a[172:175]
    s_waitcnt lgkmcnt(10)
    ds_read_b64_tr_b16 v[50:51], v2 offset:34752
    v_cvt_pk_bf16_f32 v65, v66, v67
    v_mfma_f32_16x16x32_bf16 a[8:11], v[56:59], v[80:83], a[8:11]
    s_mul_i32 s87, s87, 8320
    ds_read_b64_tr_b16 v[52:53], v2 offset:33760
    v_fma_f32 v97, v97, s84, v16
    v_mfma_f32_16x16x32_bf16 a[12:15], v[60:63], v[80:83], a[12:15]
    s_add_u32 m0, s87, s71
    ds_read_b64_tr_b16 v[54:55], v2 offset:34784
    v_fma_f32 v98, v98, s84, v16
    v_mfma_f32_16x16x32_bf16 a[72:75], v[56:59], v[84:87], a[72:75]
    s_add_u32 s70, s70, 1
    v_exp_f32 v68, v68
    v_mfma_f32_16x16x32_bf16 a[76:79], v[60:63], v[84:87], a[76:79]
    v_exp_f32 v69, v69
    v_mfma_f32_16x16x32_bf16 a[136:139], v[56:59], v[88:91], a[136:139]
    v_exp_f32_e64 v70, v70
    v_mfma_f32_16x16x32_bf16 a[140:143], v[60:63], v[88:91], a[140:143]
    buffer_load_dwordx4 v26, s[12:15], s69 offen nt lds
    v_mfma_f32_16x16x32_bf16 a[200:203], v[56:59], v[92:95], a[200:203]
    v_exp_f32 v71, v71
    v_mfma_f32_16x16x32_bf16 a[204:207], v[60:63], v[92:95], a[204:207]
    s_waitcnt lgkmcnt(8)
    ds_read_b64_tr_b16 v[56:57], v2 offset:33472
    v_add_f32 v13, v13, v68
    v_mfma_f32_16x16x32_bf16 a[48:51], v[32:35], v[80:83], a[48:51]
    ds_read_b64_tr_b16 v[58:59], v2 offset:34496
    v_add_f32 v13, v13, v69
    v_mfma_f32_16x16x32_bf16 a[52:55], v[36:39], v[80:83], a[52:55]
    ds_read_b64_tr_b16 v[60:61], v2 offset:33504
    v_cvt_pk_bf16_f32 v68, v68, v69
    v_mfma_f32_16x16x32_bf16 a[112:115], v[32:35], v[84:87], a[112:115]
    ds_read_b64_tr_b16 v[62:63], v2 offset:34528
    v_add_f32 v13, v13, v70
    v_mfma_f32_16x16x32_bf16 a[116:119], v[36:39], v[84:87], a[116:119]
    s_waitcnt vmcnt(7)
    v_add_f32_e64 v13, v13, v71
    v_cvt_pk_bf16_f32 v69, v70, v71
    v_mfma_f32_16x16x32_bf16 a[176:179], v[32:35], v[88:91], a[176:179]
    s_barrier
    v_mfma_f32_16x16x32_bf16 a[180:183], v[36:39], v[88:91], a[180:183]
    s_waitcnt lgkmcnt(8)
    v_exp_f32_e64 v72, v72
    v_mfma_f32_16x16x32_bf16 a[16:19], v[40:43], v[80:83], a[16:19]
    v_exp_f32_e64 v73, v73
    v_mfma_f32_16x16x32_bf16 a[20:23], v[44:47], v[80:83], a[20:23]
    v_exp_f32_e64 v74, v74
    v_mfma_f32_16x16x32_bf16 a[80:83], v[40:43], v[84:87], a[80:83]
    v_exp_f32_e64 v75, v75
    v_mfma_f32_16x16x32_bf16 a[84:87], v[44:47], v[84:87], a[84:87]
    ds_read_b128 v[32:35], v1 offset:49920
    v_add_f32_e64 v14, v14, v72
    v_mfma_f32_16x16x32_bf16 a[144:147], v[40:43], v[88:91], a[144:147]
    ds_read_b128 v[36:39], v1 offset:49984
    v_add_f32_e64 v14, v14, v73
    v_mfma_f32_16x16x32_bf16 a[148:151], v[44:47], v[88:91], a[148:151]
    v_cvt_pk_bf16_f32 v72, v72, v73
    v_add_f32_e64 v14, v14, v74
    v_mfma_f32_16x16x32_bf16 a[208:211], v[40:43], v[92:95], a[208:211]
    ds_read_b128 v[40:43], v1 offset:50048
    v_add_f32 v14, v14, v75
    v_mfma_f32_16x16x32_bf16 a[212:215], v[44:47], v[92:95], a[212:215]
    s_waitcnt lgkmcnt(7)
    ds_read_b128 v[44:47], v1 offset:50112
    v_cvt_pk_bf16_f32 v73, v74, v75
    v_mfma_f32_16x16x32_bf16 a[56:59], v[48:51], v[80:83], a[56:59]
    buffer_load_dwordx4 v26, s[12:15], s69 offen offset:1024 nt lds
    v_mfma_f32_16x16x32_bf16 a[60:63], v[52:55], v[80:83], a[60:63]
    s_bitcmp1_b64 s[62:63], s70
    v_fma_f32 v99, v99, s84, v16
    v_fma_f32 v100, v100, s84, v17
    v_mfma_f32_16x16x32_bf16 a[120:123], v[48:51], v[84:87], a[120:123]
    s_cselect_b64 s[12:13], s[58:59], s[60:61]
    v_exp_f32 v96, v96
    v_mfma_f32_16x16x32_bf16 a[124:127], v[52:55], v[84:87], a[124:127]
    s_cselect_b32 s69, s67, s68
    v_exp_f32_e64 v97, v97
    v_mfma_f32_16x16x32_bf16 a[184:187], v[48:51], v[88:91], a[184:187]
    s_cselect_b32 s87, 8192, 0
    v_exp_f32 v98, v98
    v_mfma_f32_16x16x32_bf16 a[188:191], v[52:55], v[88:91], a[188:191]
    s_waitcnt lgkmcnt(4)
    v_exp_f32_e64 v99, v99
    v_mfma_f32_16x16x32_bf16 a[24:27], v[56:59], v[80:83], a[24:27]
    s_add_u32 s67, s67, s87
    ds_read_b128 v[48:51], v1 offset:50176
    v_add_f32 v12, v12, v96
    v_mfma_f32_16x16x32_bf16 a[28:31], v[60:63], v[80:83], a[28:31]
    s_xor_b32 s87, s87, 8192
    ds_read_b128 v[52:55], v1 offset:50240
    v_add_f32 v12, v12, v97
    v_mfma_f32_16x16x32_bf16 a[88:91], v[56:59], v[84:87], a[88:91]
    s_add_u32 s68, s68, s87
    v_cvt_pk_bf16_f32 v66, v96, v97
    v_add_f32 v12, v12, v98
    v_mfma_f32_16x16x32_bf16 a[92:95], v[60:63], v[84:87], a[92:95]
    s_and_b32 s87, s70, 15
    v_add_f32_e64 v12, v12, v99
    v_cvt_pk_bf16_f32 v67, v98, v99
    v_mfma_f32_16x16x32_bf16 a[152:155], v[56:59], v[88:91], a[152:155]
    s_mul_i32 s87, s87, 8320
    v_fma_f32 v101, v101, s84, v17
    v_fma_f32 v102, v102, s84, v17
    v_mfma_f32_16x16x32_bf16 a[156:159], v[60:63], v[88:91], a[156:159]
    s_add_u32 m0, s87, s71
    v_fma_f32 v103, v103, s84, v17
    v_fma_f32 v104, v104, s84, v18
    v_mfma_f32_16x16x32_bf16 a[216:219], v[56:59], v[92:95], a[216:219]
    s_cmp_ge_u32 s70, 76
    v_exp_f32 v100, v100
    v_mfma_f32_16x16x32_bf16 a[220:223], v[60:63], v[92:95], a[220:223]
    s_waitcnt lgkmcnt(4)
    v_exp_f32 v101, v101
    v_mfma_f32_16x16x32_bf16 v[92:95], v[32:35], v[216:219], 0
    s_cselect_b32 s14, 0, s14
    v_exp_f32 v102, v102
    v_mfma_f32_16x16x32_bf16 v[92:95], v[36:39], a[224:227], v[92:95]
    s_add_u32 s70, s70, 1
    v_exp_f32 v103, v103
    v_mfma_f32_16x16x32_bf16 v[80:83], v[32:35], v[120:123], 0
    buffer_load_dwordx4 v26, s[12:15], s69 offen nt lds
    v_mfma_f32_16x16x32_bf16 v[80:83], v[36:39], v[124:127], v[80:83]
    ds_read_b128 v[56:59], v1 offset:50304
    v_add_f32 v13, v13, v100
    v_mfma_f32_16x16x32_bf16 v[84:87], v[32:35], v[152:155], 0
    ds_read_b128 v[60:63], v1 offset:50368
    v_add_f32 v13, v13, v101
    v_mfma_f32_16x16x32_bf16 v[84:87], v[36:39], v[156:159], v[84:87]
    v_cvt_pk_bf16_f32 v70, v100, v101
    v_add_f32_e64 v13, v13, v102
    v_mfma_f32_16x16x32_bf16 v[88:91], v[32:35], v[184:187], 0
    ds_read_b128 v[32:35], v1 offset:50944
    v_add_f32 v13, v13, v103
    v_mfma_f32_16x16x32_bf16 v[88:91], v[36:39], v[188:191], v[88:91]
    s_waitcnt lgkmcnt(5)
    ds_read_b128 v[36:39], v1 offset:51008
    v_cvt_pk_bf16_f32 v71, v102, v103
    v_mfma_f32_16x16x32_bf16 v[92:95], v[40:43], v[220:223], v[92:95]
    v_fma_f32 v105, v105, s84, v18
    v_fma_f32 v106, v106, s84, v18
    v_mfma_f32_16x16x32_bf16 v[92:95], v[44:47], a[228:231], v[92:95]
    v_fma_f32 v107, v107, s84, v18
    v_add_u32 v2, s72, v2
    v_mfma_f32_16x16x32_bf16 v[80:83], v[40:43], v[128:131], v[80:83]
    v_exp_f32 v104, v104
    v_mfma_f32_16x16x32_bf16 v[80:83], v[44:47], v[132:135], v[80:83]
    v_exp_f32 v105, v105
    v_mfma_f32_16x16x32_bf16 v[84:87], v[40:43], v[160:163], v[84:87]
    v_exp_f32 v106, v106
    v_mfma_f32_16x16x32_bf16 v[84:87], v[44:47], v[164:167], v[84:87]
    v_exp_f32_e64 v107, v107
    v_mfma_f32_16x16x32_bf16 v[88:91], v[40:43], v[192:195], v[88:91]
    ds_read_b128 v[40:43], v1 offset:51072
    v_add_f32_e64 v14, v14, v104
    v_mfma_f32_16x16x32_bf16 v[88:91], v[44:47], v[196:199], v[88:91]
    s_waitcnt lgkmcnt(5)
    ds_read_b128 v[44:47], v1 offset:51136
    v_add_f32 v14, v14, v105
    v_mfma_f32_16x16x32_bf16 v[92:95], v[48:51], v[224:227], v[92:95]
    v_cvt_pk_bf16_f32 v74, v104, v105
    v_add_f32_e64 v14, v14, v106
    v_mfma_f32_16x16x32_bf16 v[92:95], v[52:55], a[232:235], v[92:95]
    buffer_load_dwordx4 v26, s[12:15], s69 offen offset:1024 nt lds
    v_mfma_f32_16x16x32_bf16 v[80:83], v[48:51], v[136:139], v[80:83]
    s_bitcmp1_b64 s[62:63], s70
    v_add_f32_e64 v14, v14, v107
    v_cvt_pk_bf16_f32 v75, v106, v107
    v_mfma_f32_16x16x32_bf16 v[80:83], v[52:55], v[140:143], v[80:83]
    s_cselect_b64 s[12:13], s[58:59], s[60:61]
    s_cselect_b32 s69, s67, s68
    s_cselect_b32 s87, 8192, 0
    v_mfma_f32_16x16x32_bf16 v[84:87], v[48:51], v[168:171], v[84:87]
    s_add_u32 s67, s67, s87
    s_xor_b32 s87, s87, 8192
    s_add_u32 s68, s68, s87
    v_mfma_f32_16x16x32_bf16 v[84:87], v[52:55], v[172:175], v[84:87]
    s_and_b32 s87, s70, 15
    s_mul_i32 s87, s87, 8320
    s_add_u32 m0, s87, s71
    v_mfma_f32_16x16x32_bf16 v[88:91], v[48:51], v[200:203], v[88:91]
    s_cmp_ge_u32 s70, 76
    ds_read_b128 v[48:51], v1 offset:51200
    s_cselect_b32 s14, 0, s14
    v_mfma_f32_16x16x32_bf16 v[88:91], v[52:55], v[204:207], v[88:91]
    s_waitcnt lgkmcnt(5)
    ds_read_b128 v[52:55], v1 offset:51264
    s_add_u32 s70, s70, 1
    v_mfma_f32_16x16x32_bf16 v[92:95], v[56:59], v[228:231], v[92:95]
    v_mfma_f32_16x16x32_bf16 v[92:95], v[60:63], a[236:239], v[92:95]
    v_mfma_f32_16x16x32_bf16 v[80:83], v[56:59], v[144:147], v[80:83]
    v_mfma_f32_16x16x32_bf16 v[80:83], v[60:63], v[148:151], v[80:83]
    v_mfma_f32_16x16x32_bf16 v[84:87], v[56:59], v[176:179], v[84:87]
    v_mfma_f32_16x16x32_bf16 v[84:87], v[60:63], v[180:183], v[84:87]
    v_mfma_f32_16x16x32_bf16 v[88:91], v[56:59], v[208:211], v[88:91]
    ds_read_b128 v[56:59], v1 offset:51328
    v_mfma_f32_16x16x32_bf16 v[88:91], v[60:63], v[212:215], v[88:91]
    ds_read_b128 v[60:63], v1 offset:51392
    s_waitcnt vmcnt(6) lgkmcnt(6)
    v_mfma_f32_16x16x32_bf16 v[108:111], v[32:35], v[120:123], 0
    s_barrier
    v_mfma_f32_16x16x32_bf16 v[108:111], v[36:39], v[124:127], v[108:111]
    buffer_load_dwordx4 v26, s[12:15], s69 offen nt lds
    v_mfma_f32_16x16x32_bf16 v[112:115], v[32:35], v[152:155], 0
    s_add_u32 s73, s73, 1
    v_add_u32 v1, s72, v1
    v_mfma_f32_16x16x32_bf16 v[112:115], v[36:39], v[156:159], v[112:115]
    v_mfma_f32_16x16x32_bf16 v[116:119], v[32:35], v[184:187], 0
    ds_read_b64_tr_b16 v[32:33], v2 offset:256
    v_mfma_f32_16x16x32_bf16 v[116:119], v[36:39], v[188:191], v[116:119]
    s_waitcnt lgkmcnt(5)
    ds_read_b64_tr_b16 v[34:35], v2 offset:1280
    v_mfma_f32_16x16x32_bf16 v[108:111], v[40:43], v[128:131], v[108:111]
    ds_read_b64_tr_b16 v[36:37], v2 offset:288
    v_mfma_f32_16x16x32_bf16 v[108:111], v[44:47], v[132:135], v[108:111]
    ds_read_b64_tr_b16 v[38:39], v2 offset:1312
    v_mfma_f32_16x16x32_bf16 v[112:115], v[40:43], v[160:163], v[112:115]
    ds_read_b64 v[78:79], v8 offset:8192
    v_mfma_f32_16x16x32_bf16 v[112:115], v[44:47], v[164:167], v[112:115]
    v_mfma_f32_16x16x32_bf16 v[116:119], v[40:43], v[192:195], v[116:119]
    ds_read_b64_tr_b16 v[40:41], v2 offset:0
    v_mfma_f32_16x16x32_bf16 v[116:119], v[44:47], v[196:199], v[116:119]
    s_waitcnt lgkmcnt(8)
    ds_read_b64_tr_b16 v[42:43], v2 offset:1024
    v_mfma_f32_16x16x32_bf16 v[108:111], v[48:51], v[136:139], v[108:111]
    ds_read_b64_tr_b16 v[44:45], v2 offset:32
    v_mfma_f32_16x16x32_bf16 v[108:111], v[52:55], v[140:143], v[108:111]
    ds_read_b64_tr_b16 v[46:47], v2 offset:1056
    v_mfma_f32_16x16x32_bf16 v[112:115], v[48:51], v[168:171], v[112:115]
    v_mfma_f32_16x16x32_bf16 v[112:115], v[52:55], v[172:175], v[112:115]
    v_mfma_f32_16x16x32_bf16 v[116:119], v[48:51], v[200:203], v[116:119]
    v_mfma_f32_16x16x32_bf16 v[116:119], v[52:55], v[204:207], v[116:119]
    s_waitcnt lgkmcnt(9)
    v_mfma_f32_16x16x32_bf16 v[108:111], v[56:59], v[144:147], v[108:111]
    buffer_load_dwordx4 v26, s[12:15], s69 offen offset:1024 nt lds
    v_mfma_f32_16x16x32_bf16 v[108:111], v[60:63], v[148:151], v[108:111]
    s_sub_u32 s72, 0, s72
    v_mfma_f32_16x16x32_bf16 v[112:115], v[56:59], v[176:179], v[112:115]
    v_mfma_f32_16x16x32_bf16 v[112:115], v[60:63], v[180:183], v[112:115]
    v_mfma_f32_16x16x32_bf16 v[116:119], v[56:59], v[208:211], v[116:119]
    v_mfma_f32_16x16x32_bf16 v[116:119], v[60:63], v[212:215], v[116:119]
    s_cmp_lt_u32 s73, 7
    s_cbranch_scc1 L_attn0
    s_waitcnt lgkmcnt(5)
    v_mfma_f32_16x16x32_bf16 a[32:35], v[32:35], v[64:67], a[32:35]
    s_lshl_b32 s83, s76, 7
    ds_read_b64_tr_b16 v[48:49], v2 offset:320
    s_add_u32 s83, s83, s88
    v_mfma_f32_16x16x32_bf16 a[36:39], v[36:39], v[64:67], a[36:39]
    s_add_u32 s76, s76, 1
    ds_read_b64_tr_b16 v[50:51], v2 offset:1344
    s_cmp_ge_u32 s76, 7
    s_cselect_b32 s76, 0, s76
    v_mfma_f32_16x16x32_bf16 a[96:99], v[32:35], v[68:71], a[96:99]
    s_add_u32 m0, s74, 0
    ds_read_b64_tr_b16 v[52:53], v2 offset:352
    v_fma_f32 v92, v92, s84, v19
    v_fma_f32 v93, v93, s84, v19
    v_fma_f32 v94, v94, s84, v19
    v_mfma_f32_16x16x32_bf16 a[100:103], v[36:39], v[68:71], a[100:103]
    ds_read_b64_tr_b16 v[54:55], v2 offset:1376
    v_fma_f32 v95, v95, s84, v19
    v_fma_f32 v80, v80, s84, v16
    v_fma_f32 v81, v81, s84, v16
    v_mfma_f32_16x16x32_bf16 a[160:163], v[32:35], v[72:75], a[160:163]
    ds_read_b64_tr_b16 v[56:57], v2 offset:64
    v_fma_f32 v82, v82, s84, v16
    v_fma_f32 v83, v83, s84, v16
    v_fma_f32 v108, v108, s84, v16
    v_mfma_f32_16x16x32_bf16 a[164:167], v[36:39], v[72:75], a[164:167]
    s_waitcnt lgkmcnt(5)
    ds_read_b64_tr_b16 v[58:59], v2 offset:1088
    v_exp_f32_e64 v92, v92
    v_fma_f32 v109, v109, s84, v16
    v_mfma_f32_16x16x32_bf16 a[0:3], v[40:43], v[64:67], a[0:3]
    buffer_load_dwordx4 v24, s[24:27], s83 offen lds
    v_mfma_f32_16x16x32_bf16 a[4:7], v[44:47], v[64:67], a[4:7]
    s_add_u32 s83, s83, 27648
    ds_read_b64_tr_b16 v[60:61], v2 offset:96
    v_exp_f32_e64 v93, v93
    v_fma_f32 v110, v110, s84, v16
    v_mfma_f32_16x16x32_bf16 a[64:67], v[40:43], v[68:71], a[64:67]
    ds_read_b64_tr_b16 v[62:63], v2 offset:1120
    v_exp_f32_e64 v94, v94
    v_fma_f32 v111, v111, s84, v16
    v_mfma_f32_16x16x32_bf16 a[68:71], v[44:47], v[68:71], a[68:71]
    ds_read_b64_tr_b16 v[32:33], v2 offset:384
    v_exp_f32 v95, v95
    v_add_f32 v15, v15, v92
    v_mfma_f32_16x16x32_bf16 a[128:131], v[40:43], v[72:75], a[128:131]
    ds_read_b64_tr_b16 v[34:35], v2 offset:1408
    v_exp_f32 v80, v80
    v_add_f32 v15, v15, v93
    v_mfma_f32_16x16x32_bf16 a[132:135], v[44:47], v[72:75], a[132:135]
    buffer_load_dwordx4 v24, s[24:27], s83 offen offset:1024 lds
    v_mfma_f32_16x16x32_bf16 a[192:195], v[40:43], v[76:79], a[192:195]
    s_add_u32 s83, s83, 27648
    ds_read_b64_tr_b16 v[36:37], v2 offset:416
    v_exp_f32_e64 v81, v81
    v_cvt_pk_bf16_f32 v92, v92, v93
    v_mfma_f32_16x16x32_bf16 a[196:199], v[44:47], v[76:79], a[196:199]
    s_waitcnt lgkmcnt(7)
    ds_read_b64_tr_b16 v[38:39], v2 offset:1440
    v_exp_f32 v82, v82
    v_add_f32_e64 v15, v15, v94
    v_mfma_f32_16x16x32_bf16 a[40:43], v[48:51], v[64:67], a[40:43]
    ds_read_b64_tr_b16 v[40:41], v2 offset:128
    v_exp_f32 v83, v83
    v_add_f32 v15, v15, v95
    v_mfma_f32_16x16x32_bf16 a[44:47], v[52:55], v[64:67], a[44:47]
    ds_read_b64_tr_b16 v[42:43], v2 offset:1152
    v_cvt_pk_bf16_f32 v93, v94, v95
    v_mov_b32_e64 v23, v15
    v_fma_f32 v84, v84, s84, v17
    v_mfma_f32_16x16x32_bf16 a[104:107], v[48:51], v[68:71], a[104:107]
    ds_write_b64 v7, v[92:93] offset:8200
    v_mfma_f32_16x16x32_bf16 a[108:111], v[52:55], v[68:71], a[108:111]
    buffer_load_dwordx4 v24, s[24:27], s83 offen offset:2048 lds
    v_mfma_f32_16x16x32_bf16 a[168:171], v[48:51], v[72:75], a[168:171]
    s_add_u32 s83, s83, 27648
    ds_read_b64_tr_b16 v[44:45], v2 offset:160
    v_permlane16_swap_b32 v15, v23
    v_add_f32 v15, v15, v23
    v_mov_b32 v23, v15
    v_mfma_f32_16x16x32_bf16 a[172:175], v[52:55], v[72:75], a[172:175]
    s_waitcnt lgkmcnt(8)
    ds_read_b64_tr_b16 v[46:47], v2 offset:1184
    v_permlane32_swap_b32 v15, v23
    v_add_f32 v15, v15, v23
    v_fma_f32 v85, v85, s84, v17
    v_mfma_f32_16x16x32_bf16 a[8:11], v[56:59], v[64:67], a[8:11]
    ds_write_b32 v7, v15 offset:0
    v_mfma_f32_16x16x32_bf16 a[12:15], v[60:63], v[64:67], a[12:15]
    ds_read_b64_tr_b16 v[48:49], v2 offset:448
    v_fma_f32 v86, v86, s84, v17
    v_fma_f32 v87, v87, s84, v17
    v_add_f32_e64 v12, v12, v80
    v_mfma_f32_16x16x32_bf16 a[72:75], v[56:59], v[68:71], a[72:75]
    ds_read_b64_tr_b16 v[50:51], v2 offset:1472
    v_exp_f32 v108, v108
    v_add_f32 v12, v12, v81
    v_mfma_f32_16x16x32_bf16 a[76:79], v[60:63], v[68:71], a[76:79]
    ds_read_b64_tr_b16 v[52:53], v2 offset:480
    v_exp_f32_e64 v109, v109
    v_cvt_pk_bf16_f32 v80, v80, v81
    v_mfma_f32_16x16x32_bf16 a[136:139], v[56:59], v[72:75], a[136:139]
    ds_read_b64_tr_b16 v[54:55], v2 offset:1504
    v_exp_f32 v110, v110
    v_add_f32 v12, v12, v82
    v_mfma_f32_16x16x32_bf16 a[140:143], v[60:63], v[72:75], a[140:143]
    v_exp_f32 v111, v111
    v_add_f32 v12, v12, v83
    v_cvt_pk_bf16_f32 v81, v82, v83
    v_mfma_f32_16x16x32_bf16 a[200:203], v[56:59], v[76:79], a[200:203]
    buffer_load_dwordx4 v24, s[24:27], s83 offen offset:3072 lds
    v_mfma_f32_16x16x32_bf16 a[204:207], v[60:63], v[76:79], a[204:207]
    s_waitcnt lgkmcnt(10)
    ds_read_b64_tr_b16 v[56:57], v2 offset:192
    v_exp_f32 v84, v84
    v_add_f32_e64 v12, v12, v108
    v_mfma_f32_16x16x32_bf16 a[48:51], v[32:35], v[64:67], a[48:51]
    s_add_u32 s83, s83, 31744
    ds_read_b64_tr_b16 v[58:59], v2 offset:1216
    v_exp_f32 v85, v85
    v_add_f32 v12, v12, v109
    v_mfma_f32_16x16x32_bf16 a[52:55], v[36:39], v[64:67], a[52:55]
    s_add_u32 m0, s74, 16512
    ds_read_b64_tr_b16 v[60:61], v2 offset:224
    v_exp_f32_e64 v86, v86
    v_cvt_pk_bf16_f32 v82, v108, v109
    v_mfma_f32_16x16x32_bf16 a[112:115], v[32:35], v[68:71], a[112:115]
    ds_read_b64_tr_b16 v[62:63], v2 offset:1248
    v_exp_f32 v87, v87
    v_add_f32 v12, v12, v110
    v_mfma_f32_16x16x32_bf16 a[116:119], v[36:39], v[68:71], a[116:119]
    s_waitcnt vmcnt(8) lgkmcnt(8)
    v_add_f32 v12, v12, v111
    v_cvt_pk_bf16_f32 v83, v110, v111
    v_fma_f32 v112, v112, s84, v17
    v_fma_f32 v113, v113, s84, v17
    v_mfma_f32_16x16x32_bf16 a[176:179], v[32:35], v[72:75], a[176:179]
    s_barrier
    v_mfma_f32_16x16x32_bf16 a[180:183], v[36:39], v[72:75], a[180:183]
    ds_read_b64 v[94:95], v8 offset:8200
    v_fma_f32 v114, v114, s84, v17
    v_fma_f32 v115, v115, s84, v17
    v_add_f32 v13, v13, v84
    v_mfma_f32_16x16x32_bf16 a[16:19], v[40:43], v[64:67], a[16:19]
    buffer_load_dwordx4 v24, s[24:27], s83 offen lds
    v_mfma_f32_16x16x32_bf16 a[20:23], v[44:47], v[64:67], a[20:23]
    s_add_u32 s83, s83, 27648
    ds_read_b32 v23, v8 offset:0
    v_add_f32_e64 v13, v13, v85
    v_cvt_pk_bf16_f32 v84, v84, v85
    v_add_f32 v13, v13, v86
    v_mfma_f32_16x16x32_bf16 a[80:83], v[40:43], v[68:71], a[80:83]
    ds_read_b64_tr_b16 v[32:33], v2 offset:16640
    v_add_f32 v13, v13, v87
    v_cvt_pk_bf16_f32 v85, v86, v87
    v_fma_f32 v88, v88, s84, v18
    v_mfma_f32_16x16x32_bf16 a[84:87], v[44:47], v[68:71], a[84:87]
    ds_read_b64_tr_b16 v[34:35], v2 offset:17664
    v_fma_f32 v89, v89, s84, v18
    v_fma_f32 v90, v90, s84, v18
    v_fma_f32 v91, v91, s84, v18
    v_mfma_f32_16x16x32_bf16 a[144:147], v[40:43], v[72:75], a[144:147]
    ds_read_b64_tr_b16 v[36:37], v2 offset:16672
    v_exp_f32_e64 v112, v112
    v_fma_f32 v116, v116, s84, v18
    v_mfma_f32_16x16x32_bf16 a[148:151], v[44:47], v[72:75], a[148:151]
    ds_read_b64_tr_b16 v[38:39], v2 offset:17696
    v_exp_f32_e64 v113, v113
    v_fma_f32 v117, v117, s84, v18
    v_mfma_f32_16x16x32_bf16 a[208:211], v[40:43], v[76:79], a[208:211]
    ds_read_b64_tr_b16 v[40:41], v2 offset:16704
    v_exp_f32 v114, v114
    v_fma_f32 v118, v118, s84, v18
    v_mfma_f32_16x16x32_bf16 a[212:215], v[44:47], v[76:79], a[212:215]
    s_waitcnt lgkmcnt(11)
    ds_read_b64_tr_b16 v[42:43], v2 offset:17728
    v_exp_f32_e64 v115, v115
    v_fma_f32 v119, v119, s84, v18
    v_mfma_f32_16x16x32_bf16 a[56:59], v[48:51], v[64:67], a[56:59]
    buffer_load_dwordx4 v24, s[24:27], s83 offen offset:1024 lds
    v_mfma_f32_16x16x32_bf16 a[60:63], v[52:55], v[64:67], a[60:63]
    s_add_u32 s83, s83, 27648
    ds_read_b64_tr_b16 v[44:45], v2 offset:16736
    v_exp_f32 v88, v88
    v_add_f32 v13, v13, v112
    v_mfma_f32_16x16x32_bf16 a[120:123], v[48:51], v[68:71], a[120:123]
    ds_read_b64_tr_b16 v[46:47], v2 offset:17760
    v_exp_f32 v89, v89
    v_add_f32 v13, v13, v113
    v_mfma_f32_16x16x32_bf16 a[124:127], v[52:55], v[68:71], a[124:127]
    v_exp_f32 v90, v90
    v_exp_f32 v91, v91
    v_mfma_f32_16x16x32_bf16 a[184:187], v[48:51], v[72:75], a[184:187]
    ds_read_b64_tr_b16 v[48:49], v2 offset:16768
    v_cvt_pk_bf16_f32 v86, v112, v113
    v_add_f32 v13, v13, v114
    v_add_f32_e64 v13, v13, v115
    v_mfma_f32_16x16x32_bf16 a[188:191], v[52:55], v[72:75], a[188:191]
    s_waitcnt lgkmcnt(11)
    ds_read_b64_tr_b16 v[50:51], v2 offset:17792
    v_cvt_pk_bf16_f32 v87, v114, v115
    v_exp_f32_e64 v116, v116
    v_mfma_f32_16x16x32_bf16 a[24:27], v[56:59], v[64:67], a[24:27]
    ds_read_b64_tr_b16 v[52:53], v2 offset:16800
    v_exp_f32 v117, v117
    v_add_f32 v14, v14, v88
    v_mfma_f32_16x16x32_bf16 a[28:31], v[60:63], v[64:67], a[28:31]
    v_exp_f32_e64 v118, v118
    v_mfma_f32_16x16x32_bf16 a[88:91], v[56:59], v[68:71], a[88:91]
    v_exp_f32 v119, v119
    v_mfma_f32_16x16x32_bf16 a[92:95], v[60:63], v[68:71], a[92:95]
    ds_read_b64_tr_b16 v[54:55], v2 offset:17824
    v_add_f32 v14, v14, v89
    v_mfma_f32_16x16x32_bf16 a[152:155], v[56:59], v[72:75], a[152:155]
    v_cvt_pk_bf16_f32 v88, v88, v89
    v_add_f32_e64 v14, v14, v90
    v_mfma_f32_16x16x32_bf16 a[156:159], v[60:63], v[72:75], a[156:159]
    v_add_f32_e64 v14, v14, v91
    v_cvt_pk_bf16_f32 v89, v90, v91
    v_mfma_f32_16x16x32_bf16 a[216:219], v[56:59], v[76:79], a[216:219]
    buffer_load_dwordx4 v24, s[24:27], s83 offen offset:2048 lds
    v_mfma_f32_16x16x32_bf16 a[220:223], v[60:63], v[76:79], a[220:223]
    s_waitcnt lgkmcnt(8)
    ds_read_b64_tr_b16 v[56:57], v2 offset:16832
    v_add_f32 v14, v14, v116
    v_mfma_f32_16x16x32_bf16 a[0:3], v[32:35], v[80:83], a[0:3]
    s_add_u32 s83, s83, 27648
    ds_read_b64_tr_b16 v[58:59], v2 offset:17856
    v_add_f32_e64 v14, v14, v117
    v_mfma_f32_16x16x32_bf16 a[4:7], v[36:39], v[80:83], a[4:7]
    ds_read_b64_tr_b16 v[60:61], v2 offset:16864
    v_cvt_pk_bf16_f32 v90, v116, v117
    v_mfma_f32_16x16x32_bf16 a[64:67], v[32:35], v[84:87], a[64:67]
    ds_read_b64_tr_b16 v[62:63], v2 offset:17888
    v_add_f32 v14, v14, v118
    v_mfma_f32_16x16x32_bf16 a[68:71], v[36:39], v[84:87], a[68:71]
    v_add_f32_e64 v14, v14, v119
    v_cvt_pk_bf16_f32 v91, v118, v119
    s_nop 1
    v_mfma_f32_16x16x32_bf16 a[128:131], v[32:35], v[88:91], a[128:131]
    buffer_load_dwordx4 v24, s[24:27], s83 offen offset:3072 lds
    v_mfma_f32_16x16x32_bf16 a[132:135], v[36:39], v[88:91], a[132:135]
    buffer_load_dword v1, v11, s[32:35], 0 offen sc1
    v_mfma_f32_16x16x32_bf16 a[192:195], v[32:35], v[92:95], a[192:195]
    s_lshl_b32 s83, s76, 7
    ds_read_b64_tr_b16 v[32:33], v2 offset:16896
    s_add_u32 s83, s83, s88
    v_mfma_f32_16x16x32_bf16 a[196:199], v[36:39], v[92:95], a[196:199]
    s_waitcnt lgkmcnt(9)
    ds_read_b64_tr_b16 v[34:35], v2 offset:17920
    s_add_u32 s76, s76, 1
    v_mfma_f32_16x16x32_bf16 a[8:11], v[40:43], v[80:83], a[8:11]
    s_cmp_ge_u32 s76, 7
    s_cselect_b32 s76, 0, s76
    ds_read_b64_tr_b16 v[36:37], v2 offset:16928
    s_add_u32 m0, s74, 33024
    v_mfma_f32_16x16x32_bf16 a[12:15], v[44:47], v[80:83], a[12:15]
    buffer_load_dwordx4 v24, s[24:27], s83 offen lds
    v_mfma_f32_16x16x32_bf16 a[72:75], v[40:43], v[84:87], a[72:75]
    s_add_u32 s83, s83, 27648
    ds_read_b64_tr_b16 v[38:39], v2 offset:17952
    v_add_f32_e64 v15, v15, v23
    v_mfma_f32_16x16x32_bf16 a[76:79], v[44:47], v[84:87], a[76:79]
    buffer_load_dwordx4 v24, s[24:27], s83 offen offset:1024 lds
    v_mfma_f32_16x16x32_bf16 a[136:139], v[40:43], v[88:91], a[136:139]
    s_add_u32 s83, s83, 27648
    v_rcp_f32_e64 v239, v15
    v_mfma_f32_16x16x32_bf16 a[140:143], v[44:47], v[88:91], a[140:143]
    buffer_load_dwordx4 v24, s[24:27], s83 offen offset:2048 lds
    v_mfma_f32_16x16x32_bf16 a[200:203], v[40:43], v[92:95], a[200:203]
    s_add_u32 s83, s83, 27648
    ds_read_b64_tr_b16 v[40:41], v2 offset:16960
    v_mov_b32 v20, v12
    v_mfma_f32_16x16x32_bf16 a[204:207], v[44:47], v[92:95], a[204:207]
    s_waitcnt lgkmcnt(9)
    ds_read_b64_tr_b16 v[42:43], v2 offset:17984
    v_mov_b32 v21, v13
    v_mfma_f32_16x16x32_bf16 a[16:19], v[48:51], v[80:83], a[16:19]
    ds_read_b64_tr_b16 v[44:45], v2 offset:16992
    v_mov_b32 v22, v14
    v_mfma_f32_16x16x32_bf16 a[20:23], v[52:55], v[80:83], a[20:23]
    ds_read_b64_tr_b16 v[46:47], v2 offset:18016
    v_permlane16_swap_b32 v12, v20
    v_mfma_f32_16x16x32_bf16 a[80:83], v[48:51], v[84:87], a[80:83]
    v_permlane16_swap_b32 v13, v21
    v_permlane16_swap_b32 v14, v22
    v_mfma_f32_16x16x32_bf16 a[84:87], v[52:55], v[84:87], a[84:87]
    v_add_f32 v12, v12, v20
    v_add_f32 v13, v13, v21
    v_mfma_f32_16x16x32_bf16 a[144:147], v[48:51], v[88:91], a[144:147]
    v_add_f32 v14, v14, v22
    v_mov_b32 v20, v12
    v_mfma_f32_16x16x32_bf16 a[148:151], v[52:55], v[88:91], a[148:151]
    v_mov_b32 v21, v13
    v_mov_b32_e64 v22, v14
    v_mfma_f32_16x16x32_bf16 a[208:211], v[48:51], v[92:95], a[208:211]
    ds_read_b64_tr_b16 v[48:49], v2 offset:17024
    v_permlane32_swap_b32 v12, v20
    v_mfma_f32_16x16x32_bf16 a[212:215], v[52:55], v[92:95], a[212:215]
    s_waitcnt lgkmcnt(9)
    ds_read_b64_tr_b16 v[50:51], v2 offset:18048
    v_permlane32_swap_b32 v13, v21
    v_mfma_f32_16x16x32_bf16 a[24:27], v[56:59], v[80:83], a[24:27]
    ds_read_b64_tr_b16 v[52:53], v2 offset:17056
    v_permlane32_swap_b32 v14, v22
    v_mfma_f32_16x16x32_bf16 a[28:31], v[60:63], v[80:83], a[28:31]
    ds_read_b64_tr_b16 v[54:55], v2 offset:18080
    v_add_f32 v12, v12, v20
    v_mfma_f32_16x16x32_bf16 a[88:91], v[56:59], v[84:87], a[88:91]
    v_add_f32 v13, v13, v21
    v_add_f32_e64 v14, v14, v22
    v_mfma_f32_16x16x32_bf16 a[92:95], v[60:63], v[84:87], a[92:95]
    v_rcp_f32 v236, v12
    v_mfma_f32_16x16x32_bf16 a[152:155], v[56:59], v[88:91], a[152:155]
    v_rcp_f32 v237, v13
    v_mfma_f32_16x16x32_bf16 a[156:159], v[60:63], v[88:91], a[156:159]
    v_rcp_f32_e64 v238, v14
    v_mfma_f32_16x16x32_bf16 a[216:219], v[56:59], v[92:95], a[216:219]
    ds_read_b64_tr_b16 v[56:57], v2 offset:17088
    v_add_f32_e64 v20, v12, v13
    v_mfma_f32_16x16x32_bf16 a[220:223], v[60:63], v[92:95], a[220:223]
    s_waitcnt lgkmcnt(9)
    ds_read_b64_tr_b16 v[58:59], v2 offset:18112
    v_add_f32 v21, v14, v15
    v_mfma_f32_16x16x32_bf16 a[32:35], v[32:35], v[80:83], a[32:35]
    ds_read_b64_tr_b16 v[60:61], v2 offset:17120
    v_add_f32_e64 v20, v20, v21
    v_mfma_f32_16x16x32_bf16 a[36:39], v[36:39], v[80:83], a[36:39]
    ds_read_b64_tr_b16 v[62:63], v2 offset:18144
    v_cmp_ngt_f32 vcc, 0x5d800000, v20
    v_mfma_f32_16x16x32_bf16 a[96:99], v[32:35], v[84:87], a[96:99]
    s_or_b32 s85, vcc_lo, vcc_hi
    s_andn2_b32 s85, s85, s90
    v_mov_b32_e64 v20, s85
    v_mfma_f32_16x16x32_bf16 a[100:103], v[36:39], v[84:87], a[100:103]
    ds_write_b32 v7, v20 offset:8192
    v_mfma_f32_16x16x32_bf16 a[160:163], v[32:35], v[88:91], a[160:163]
    buffer_load_dwordx4 v24, s[24:27], s83 offen offset:3072 lds
    v_mfma_f32_16x16x32_bf16 a[164:167], v[36:39], v[88:91], a[164:167]
    s_waitcnt lgkmcnt(9)
    s_add_u32 s83, s83, 31744
    s_add_u32 m0, s74, 49536
    v_mfma_f32_16x16x32_bf16 a[40:43], v[40:43], v[80:83], a[40:43]
    buffer_load_dwordx4 v24, s[24:27], s83 offen lds
    v_mfma_f32_16x16x32_bf16 a[44:47], v[44:47], v[80:83], a[44:47]
    s_add_u32 s83, s83, 27648
    s_waitcnt vmcnt(6) lgkmcnt(1)
    s_barrier
    v_mfma_f32_16x16x32_bf16 a[104:107], v[40:43], v[84:87], a[104:107]
    buffer_load_dwordx4 v24, s[24:27], s83 offen offset:1024 lds
    v_mfma_f32_16x16x32_bf16 a[108:111], v[44:47], v[84:87], a[108:111]
    s_add_u32 s83, s83, 27648
    ds_read_b64_tr_b16 v[32:33], v0 offset:0
    s_lshr_b32 s86, s3, 1
    v_mfma_f32_16x16x32_bf16 a[168:171], v[40:43], v[88:91], a[168:171]
    buffer_load_dwordx4 v24, s[24:27], s83 offen offset:2048 lds
    v_mfma_f32_16x16x32_bf16 a[172:175], v[44:47], v[88:91], a[172:175]
    ds_read_b64_tr_b16 v[34:35], v0 offset:512
    s_add_u32 s83, s83, 27648
    v_mfma_f32_16x16x32_bf16 a[48:51], v[48:51], v[80:83], a[48:51]
    buffer_load_dwordx4 v24, s[24:27], s83 offen offset:3072 lds
    v_mfma_f32_16x16x32_bf16 a[52:55], v[52:55], v[80:83], a[52:55]
    s_lshl_b32 s83, s76, 7
    ds_read_b64_tr_b16 v[36:37], v0 offset:1024
    s_add_u32 s83, s83, s88
    v_mfma_f32_16x16x32_bf16 a[112:115], v[48:51], v[84:87], a[112:115]
    s_add_u32 s76, s76, 1
    ds_read_b64_tr_b16 v[38:39], v0 offset:1536
    s_cmp_ge_u32 s76, 7
    s_cselect_b32 s76, 0, s76
    v_mfma_f32_16x16x32_bf16 a[116:119], v[52:55], v[84:87], a[116:119]
    s_add_u32 m0, s74, 66560
    s_cmp_eq_u32 s86, s89
    s_cselect_b32 s94, 99840, 0
    v_add_u32_e64 v18, s94, v26
    v_mfma_f32_16x16x32_bf16 a[176:179], v[48:51], v[88:91], a[176:179]
    buffer_load_dwordx4 v24, s[24:27], s83 offen lds
    v_mfma_f32_16x16x32_bf16 a[180:183], v[52:55], v[88:91], a[180:183]
    s_add_u32 s83, s83, 27648
    v_add_u32 v16, 0, v18
    v_mfma_f32_16x16x32_bf16 a[56:59], v[56:59], v[80:83], a[56:59]
    buffer_load_dwordx4 v24, s[24:27], s83 offen offset:1024 lds
    v_mfma_f32_16x16x32_bf16 a[60:63], v[60:63], v[80:83], a[60:63]
    s_add_u32 s83, s83, 27648
    v_add_u32 v17, 6144, v18
    s_xor_b32 s86, s37, 1
    v_mfma_f32_16x16x32_bf16 a[120:123], v[56:59], v[84:87], a[120:123]
    buffer_load_dwordx4 v24, s[24:27], s83 offen offset:2048 lds
    v_mfma_f32_16x16x32_bf16 a[124:127], v[60:63], v[84:87], a[124:127]
    s_add_u32 s83, s83, 27648
    s_mul_i32 s46, s86, 57344
    s_add_u32 s46, s46, 1835008
    v_mfma_f32_16x16x32_bf16 a[184:187], v[56:59], v[88:91], a[184:187]
    buffer_load_dwordx4 v24, s[24:27], s83 offen offset:3072 lds
    v_mfma_f32_16x16x32_bf16 a[188:191], v[60:63], v[88:91], a[188:191]
    s_add_u32 s83, s83, 31744
    s_add_u32 m0, s74, 83072
    s_lshl_b32 s48, s86, 8
    buffer_load_dwordx4 v24, s[24:27], s83 offen lds
    s_add_u32 s83, s83, 27648
    buffer_load_dwordx4 v24, s[24:27], s83 offen offset:1024 lds
    s_add_u32 s83, s83, 27648
    buffer_load_dwordx4 v24, s[24:27], s83 offen offset:2048 lds
    s_add_u32 s83, s83, 27648
    buffer_load_dwordx4 v24, s[24:27], s83 offen offset:3072 lds
    s_add_u32 s48, s48, 2752544
    v_add_u32 v4, 99840, v26
    s_mov_b32 s73, 3
    s_nop 5
    s_cmp_lt_u32 s3, 2
    s_cbranch_scc1 L_cb0
    s_branch L_cb2
L_odd:
    s_waitcnt vmcnt(9)
    s_barrier
    ds_read_b64_tr_b16 v[32:33], v9 offset:64
    ds_read_b64_tr_b16 v[34:35], v9 offset:1088
    ds_read_b64_tr_b16 v[36:37], v9 offset:72
    ds_read_b64_tr_b16 v[38:39], v9 offset:1096
    ds_read_b128 a[236:239], v14 offset:0
    ds_read_b128 a[224:227], v12 offset:0
    ds_read_b64_tr_b16 v[40:41], v9 offset:192
    ds_read_b64_tr_b16 v[42:43], v9 offset:1216
    ds_read_b64_tr_b16 v[44:45], v9 offset:200
    ds_read_b64_tr_b16 v[46:47], v9 offset:1224
    ds_read_b128 a[228:231], v12 offset:2048
    ds_read_b128 a[232:235], v12 offset:4096
    ds_read_b128 a[240:243], v13 offset:0
    ds_read_b128 a[244:247], v13 offset:2048
    ds_read_b128 a[248:251], v13 offset:4096
    ds_read_b128 a[252:255], v15 offset:0
    s_waitcnt lgkmcnt(11)
    v_mfma_f32_16x16x32_bf16 v[216:219], v[32:35], a[236:239], 0
    s_mov_b32 m0, s66
    ds_read_b64_tr_b16 v[48:49], v9 offset:320
    s_add_u32 s65, s64, 0
    v_mfma_f32_16x16x32_bf16 v[96:99], v[36:39], a[236:239], 0
    s_waitcnt lgkmcnt(11)
    ds_read_b64_tr_b16 v[50:51], v9 offset:1344
    v_mfma_f32_16x16x32_bf16 v[124:127], v[32:35], a[224:227], 0
    buffer_load_dwordx4 v4, s[20:23], s65 offen lds
    v_mfma_f32_16x16x32_bf16 v[100:103], v[36:39], a[224:227], 0
    s_waitcnt lgkmcnt(8)
    ds_read_b64_tr_b16 v[52:53], v9 offset:328
    v_mov_b32 v237, 0x80000000
    v_cmp_gt_u32 vcc, 16, v0
    v_lshlrev_b32 v236, 2, v0
    v_mov_b32 v5, 0
    v_cndmask_b32 v3, v237, v236, vcc
    v_cmp_eq_u32 vcc, 0, v0
    v_mfma_f32_16x16x32_bf16 v[220:223], v[40:43], a[236:239], 0
    s_add_u32 s65, s64, 31744
    ds_read_b64_tr_b16 v[54:55], v9 offset:1352
    s_or_b32 s85, s3, s90
    v_mfma_f32_16x16x32_bf16 a[0:3], v[44:47], a[236:239], 0
    buffer_load_dwordx4 v4, s[20:23], s65 offen offset:1024 lds
    v_mfma_f32_16x16x32_bf16 v[132:135], v[40:43], a[224:227], 0
    s_add_u32 s65, s64, 260096
    ds_read_b64_tr_b16 v[56:57], v9 offset:448
    s_cmp_eq_u32 s85, 0
    s_cselect_b32 s53, 0, 0x80000000
    v_cndmask_b32 v11, v237, v5, vcc
    v_mfma_f32_16x16x32_bf16 a[4:7], v[44:47], a[224:227], 0
    s_waitcnt lgkmcnt(10)
    ds_read_b64_tr_b16 v[58:59], v9 offset:1472
    s_and_b32 s89, s37, 1
    v_mfma_f32_16x16x32_bf16 v[156:159], v[32:35], a[228:231], 0
    s_lshl_b32 s95, s3, 6
    ds_read_b64_tr_b16 v[60:61], v9 offset:456
    s_add_u32 s95, s95, 2752512
    v_mfma_f32_16x16x32_bf16 v[104:107], v[36:39], a[228:231], 0
    buffer_load_dwordx4 v4, s[20:23], s65 offen offset:2048 lds
    v_mfma_f32_16x16x32_bf16 v[164:167], v[40:43], a[228:231], 0
    s_add_u32 s65, s64, 291840
    ds_read_b64_tr_b16 v[62:63], v9 offset:1480
    s_lshr_b32 s85, s37, 1
    v_mfma_f32_16x16x32_bf16 a[8:11], v[44:47], a[228:231], 0
    s_waitcnt lgkmcnt(12)
    s_lshl2_add_u32 s95, s85, s95
    s_lshl_b32 s85, s89, 8
    v_mfma_f32_16x16x32_bf16 v[188:191], v[32:35], a[232:235], 0
    s_add_u32 s95, s95, s85
    ds_read_b64_tr_b16 v[32:33], v9 offset:0
    s_mov_b32 s62, 0xccccf0cc
    v_mfma_f32_16x16x32_bf16 v[240:243], v[36:39], a[232:235], 0
    s_waitcnt lgkmcnt(9)
    s_barrier
    v_mfma_f32_16x16x32_bf16 v[196:199], v[40:43], a[232:235], 0
    buffer_load_dwordx4 v4, s[20:23], s65 offen offset:3072 lds
    v_mfma_f32_16x16x32_bf16 a[12:15], v[44:47], a[232:235], 0
    s_waitcnt lgkmcnt(5)
    ds_read_b64_tr_b16 v[34:35], v9 offset:1024
    s_add_u32 m0, s57, 0
    v_mfma_f32_16x16x32_bf16 v[224:227], v[48:51], a[236:239], 0
    s_add_u32 s65, s56, 0
    ds_read_b64_tr_b16 v[36:37], v9 offset:8
    s_mov_b32 s63, 0xcccccccc
    v_mfma_f32_16x16x32_bf16 a[16:19], v[52:55], a[236:239], 0
    buffer_load_dwordx4 v25, s[8:11], s65 offen lds
    v_mfma_f32_16x16x32_bf16 v[140:143], v[48:51], a[224:227], 0
    s_add_u32 m0, s57, 4096
    ds_read_b64_tr_b16 v[38:39], v9 offset:1032
    s_add_u32 s65, s56, 28672
    v_mfma_f32_16x16x32_bf16 a[20:23], v[52:55], a[224:227], 0
    s_mov_b32 s70, 16
    ds_read_b64_tr_b16 v[40:41], v9 offset:128
    s_add_u32 s67, s81, 32768
    v_mfma_f32_16x16x32_bf16 v[172:175], v[48:51], a[228:231], 0
    s_add_u32 s68, s81, 0
    ds_read_b64_tr_b16 v[42:43], v9 offset:1152
    s_and_b32 s85, s37, 14
    v_mfma_f32_16x16x32_bf16 v[16:19], v[52:55], a[228:231], 0
    buffer_load_dwordx4 v25, s[8:11], s65 offen lds
    v_mfma_f32_16x16x32_bf16 v[204:207], v[48:51], a[232:235], 0
    s_add_u32 m0, s57, 8192
    ds_read_b64_tr_b16 v[44:45], v9 offset:136
    s_add_u32 s65, s56, 57344
    v_mfma_f32_16x16x32_bf16 v[20:23], v[52:55], a[232:235], 0
    s_waitcnt lgkmcnt(7)
    ds_read_b64_tr_b16 v[46:47], v9 offset:1160
    s_mul_i32 s85, s85, 229376
    v_mfma_f32_16x16x32_bf16 v[228:231], v[56:59], a[236:239], 0
    s_add_u32 s24, s48, s85
    s_addc_u32 s25, s49, 0
    ds_read_b64_tr_b16 v[48:49], v9 offset:256
    s_and_b32 s25, s25, 0xffff
    v_mfma_f32_16x16x32_bf16 v[232:235], v[60:63], a[236:239], 0
    buffer_load_dwordx4 v25, s[8:11], s65 offen lds
    v_mfma_f32_16x16x32_bf16 v[148:151], v[56:59], a[224:227], 0
    s_add_u32 m0, s57, 12288
    ds_read_b64_tr_b16 v[50:51], v9 offset:1280
    s_add_u32 s65, s56, 86016
    v_mfma_f32_16x16x32_bf16 v[28:31], v[60:63], a[224:227], 0
    s_mov_b32 s26, 458752
    ds_read_b64_tr_b16 v[52:53], v9 offset:264
    s_mov_b32 s27, 0x20000
    v_mfma_f32_16x16x32_bf16 v[180:183], v[56:59], a[228:231], 0
    s_mul_i32 s88, s89, 229376
    ds_read_b64_tr_b16 v[54:55], v9 offset:1288
    s_mul_i32 s74, s3, 4128
    v_mfma_f32_16x16x32_bf16 v[244:247], v[60:63], a[228:231], 0
    buffer_load_dwordx4 v25, s[8:11], s65 offen lds
    v_mfma_f32_16x16x32_bf16 v[212:215], v[56:59], a[232:235], 0
    s_add_u32 m0, s57, 16384
    ds_read_b64_tr_b16 v[56:57], v9 offset:384
    s_add_u32 s65, s56, 114688
    v_mfma_f32_16x16x32_bf16 v[248:251], v[60:63], a[232:235], 0
    s_waitcnt lgkmcnt(9)
    ds_read_b64_tr_b16 v[58:59], v9 offset:1408
    s_mov_b32 s84, 0x3db8aa3b
    v_mfma_f32_16x16x32_bf16 v[120:123], v[32:35], a[224:227], 0
    ds_read_b64_tr_b16 v[60:61], v9 offset:392
    v_bfe_u32 v236, v0, 2, 3
    v_mfma_f32_16x16x32_bf16 v[252:255], v[36:39], a[224:227], 0
    buffer_load_dwordx4 v25, s[8:11], s65 offen lds
    v_mfma_f32_16x16x32_bf16 v[152:155], v[32:35], a[228:231], 0
    s_add_u32 m0, s57, 20480
    ds_read_b64_tr_b16 v[62:63], v9 offset:1416
    v_mul_u32_u24 v2, 2080, v236
    v_mfma_f32_16x16x32_bf16 v[64:67], v[36:39], a[228:231], 0
    s_add_u32 s65, s56, 143360
    s_waitcnt vmcnt(13)
    s_barrier
    v_mfma_f32_16x16x32_bf16 v[184:187], v[32:35], a[232:235], 0
    ds_read_b64_tr_b16 v[32:33], v9 offset:2112
    v_lshrrev_b32 v236, 5, v0
    v_lshl_add_u32 v2, v236, 9, v2
    v_and_b32 v239, 3, v0
    v_lshl_add_u32 v2, v239, 3, v2
    v_mfma_f32_16x16x32_bf16 v[68:71], v[36:39], a[232:235], 0
    s_waitcnt lgkmcnt(9)
    ds_read_b64_tr_b16 v[34:35], v9 offset:3136
    s_mul_i32 s85, s3, 7168
    v_mfma_f32_16x16x32_bf16 v[128:131], v[40:43], a[224:227], 0
    buffer_load_dwordx4 v25, s[8:11], s65 offen lds
    v_mfma_f32_16x16x32_bf16 v[72:75], v[44:47], a[224:227], 0
    s_add_u32 m0, s57, 24576
    ds_read_b64_tr_b16 v[36:37], v9 offset:2120
    s_add_u32 s65, s56, 172032
    v_mfma_f32_16x16x32_bf16 v[160:163], v[40:43], a[228:231], 0
    s_add_u32 s85, s85, s88
    ds_read_b64_tr_b16 v[38:39], v9 offset:3144
    v_lshl_add_u32 v10, v0, 7, s85
    v_mfma_f32_16x16x32_bf16 v[76:79], v[44:47], a[228:231], 0
    buffer_load_dwordx4 v25, s[8:11], s65 offen lds
    v_mfma_f32_16x16x32_bf16 v[192:195], v[40:43], a[232:235], 0
    s_add_u32 s56, s56, 128
    ds_read_b64_tr_b16 v[40:41], v9 offset:2240
    v_and_b32_e64 v238, 7, v0
    v_mfma_f32_16x16x32_bf16 v[80:83], v[44:47], a[232:235], 0
    s_waitcnt lgkmcnt(9)
    ds_read_b64_tr_b16 v[42:43], v9 offset:3264
    v_mul_u32_u24 v1, 2080, v238
    v_bfe_u32 v236, v0, 3, 1
    v_lshl_add_u32 v1, v236, 9, v1
    v_lshrrev_b32_e64 v237, 4, v0
    v_lshl_add_u32 v1, v237, 4, v1
    v_add_u32 v1, 66560, v1
    v_lshrrev_b32_e64 v236, 3, v0
    v_mfma_f32_16x16x32_bf16 v[136:139], v[48:51], a[224:227], 0
    s_add_u32 s69, s81, 16384
    ds_read_b64_tr_b16 v[44:45], v9 offset:2248
    v_mul_u32_u24 v24, 3584, v236
    v_mfma_f32_16x16x32_bf16 v[84:87], v[52:55], a[224:227], 0
    s_add_u32 s83, s83, 524288
    ds_read_b64_tr_b16 v[46:47], v9 offset:3272
    v_lshl_add_u32 v24, v238, 4, v24
    v_mfma_f32_16x16x32_bf16 v[168:171], v[48:51], a[228:231], 0
    s_min_u32 s83, s83, 3145728
    s_add_u32 m0, s66, 16512
    s_add_u32 s65, s64, 65536
    v_mfma_f32_16x16x32_bf16 v[88:91], v[52:55], a[228:231], 0
    buffer_load_dwordx4 v4, s[20:23], s65 offen lds
    v_mfma_f32_16x16x32_bf16 v[200:203], v[48:51], a[232:235], 0
    s_add_u32 s65, s64, 97280
    ds_read_b64_tr_b16 v[48:49], v9 offset:2368
    s_lshl_b32 s85, s3, 12
    v_mfma_f32_16x16x32_bf16 v[92:95], v[52:55], a[232:235], 0
    s_waitcnt lgkmcnt(9)
    ds_read_b64_tr_b16 v[50:51], v9 offset:3392
    s_add_u32 s85, s85, 133120
    v_add_u32_e64 v7, s85, v26
    v_mfma_f32_16x16x32_bf16 v[144:147], v[56:59], a[224:227], 0
    buffer_load_dwordx4 v4, s[20:23], s65 offen offset:1024 lds
    v_mfma_f32_16x16x32_bf16 v[108:111], v[60:63], a[224:227], 0
    s_add_u32 s65, s64, 325632
    ds_read_b64_tr_b16 v[52:53], v9 offset:2376
    s_xor_b32 s86, s3, 1
    v_mfma_f32_16x16x32_bf16 v[176:179], v[56:59], a[228:231], 0
    s_lshl_b32 s86, s86, 12
    ds_read_b64_tr_b16 v[54:55], v9 offset:3400
    s_add_u32 s86, s86, 133120
    v_mfma_f32_16x16x32_bf16 v[112:115], v[60:63], a[228:231], 0
    buffer_load_dwordx4 v4, s[20:23], s65 offen offset:2048 lds
    v_mfma_f32_16x16x32_bf16 v[208:211], v[56:59], a[232:235], 0
    s_add_u32 s65, s64, 357376
    ds_read_b64_tr_b16 v[56:57], v9 offset:2496
    v_add_u32 v8, s86, v26
    v_mfma_f32_16x16x32_bf16 v[116:119], v[60:63], a[232:235], 0
    s_waitcnt lgkmcnt(9)
    ds_read_b64_tr_b16 v[58:59], v9 offset:3520
    v_bfe_u32 v236, v0, 2, 2
    v_mfma_f32_16x16x32_bf16 v[216:219], v[32:35], a[252:255], v[216:219]
    ds_read_b64_tr_b16 v[60:61], v9 offset:2504
    v_mul_u32_u24 v0, 4128, v236
    v_lshl_add_u32 v0, v237, 7, v0
    v_lshl_add_u32 v0, v239, 3, v0
    v_mfma_f32_16x16x32_bf16 v[96:99], v[36:39], a[252:255], v[96:99]
    buffer_load_dwordx4 v4, s[20:23], s65 offen offset:3072 lds
    v_mfma_f32_16x16x32_bf16 v[124:127], v[32:35], a[240:243], v[124:127]
    s_add_u32 m0, s71, 116480
    ds_read_b64_tr_b16 v[62:63], v9 offset:3528
    s_lshl_b32 s85, s3, 5
    v_mfma_f32_16x16x32_bf16 v[100:103], v[36:39], a[240:243], v[100:103]
    v_add_u32_e64 v0, s85, v0
    s_lshr_b32 s75, s37, 1
    v_mfma_f32_16x16x32_bf16 v[156:159], v[32:35], a[244:247], v[156:159]
    s_add_u32 s75, s75, 1
    s_cmp_ge_u32 s75, 7
    s_cselect_b32 s85, 7, 0
    s_sub_u32 s75, s75, s85
    v_mfma_f32_16x16x32_bf16 v[104:107], v[36:39], a[244:247], v[104:107]
    buffer_load_dwordx4 v26, s[12:15], s69 offen nt lds
    v_mfma_f32_16x16x32_bf16 v[188:191], v[32:35], a[248:251], v[188:191]
    s_mul_i32 s80, s3, 28672
    ds_read_b64_tr_b16 v[32:33], v9 offset:2048
    s_lshr_b32 s85, s37, 1
    v_mfma_f32_16x16x32_bf16 v[240:243], v[36:39], a[248:251], v[240:243]
    s_waitcnt lgkmcnt(9)
    ds_read_b64_tr_b16 v[34:35], v9 offset:3072
    s_mul_i32 s85, s85, 3584
    v_mfma_f32_16x16x32_bf16 v[220:223], v[40:43], a[252:255], v[220:223]
    buffer_load_dwordx4 v26, s[12:15], s69 offen offset:1024 nt lds
    v_mfma_f32_16x16x32_bf16 a[0:3], v[44:47], a[252:255], a[0:3]
    buffer_load_dword v6, v27, s[20:23], s83 offen
    v_mfma_f32_16x16x32_bf16 v[132:135], v[40:43], a[240:243], v[132:135]
    s_add_u32 s64, s64, 524288
    ds_read_b64_tr_b16 v[36:37], v9 offset:2056
    s_add_u32 s66, s66, s82
    v_mfma_f32_16x16x32_bf16 a[4:7], v[44:47], a[240:243], a[4:7]
    s_sub_u32 s82, 0, s82
    ds_read_b64_tr_b16 v[38:39], v9 offset:3080
    s_add_u32 s80, s80, s85
    v_mfma_f32_16x16x32_bf16 v[164:167], v[40:43], a[244:247], v[164:167]
    s_mul_i32 s85, s89, 114688
    s_add_u32 s80, s80, s85
    s_mul_i32 s85, s3, 896
    v_mfma_f32_16x16x32_bf16 a[8:11], v[44:47], a[244:247], a[8:11]
    s_add_u32 s88, s88, s85
    s_mov_b32 s72, 66560
    s_mov_b32 s73, 2
    v_mfma_f32_16x16x32_bf16 v[196:199], v[40:43], a[248:251], v[196:199]
    s_mov_b32 s52, 400000
    ds_read_b64_tr_b16 v[40:41], v9 offset:2176
    s_mov_b32 s30, 2756608
    v_mfma_f32_16x16x32_bf16 a[12:15], v[44:47], a[248:251], a[12:15]
    s_waitcnt lgkmcnt(9)
    ds_read_b64_tr_b16 v[42:43], v9 offset:3200
    s_mov_b32 s31, 0x20000
    v_mfma_f32_16x16x32_bf16 v[224:227], v[48:51], a[252:255], v[224:227]
    s_mov_b32 s34, 16
    ds_read_b64_tr_b16 v[44:45], v9 offset:2184
    s_mov_b32 s35, 0x20000
    v_mfma_f32_16x16x32_bf16 a[16:19], v[52:55], a[252:255], a[16:19]
    s_mul_i32 s5, s39, 896
    ds_read_b64_tr_b16 v[46:47], v9 offset:3208
    s_lshr_b32 s87, s37, 1
    v_mfma_f32_16x16x32_bf16 v[140:143], v[48:51], a[240:243], v[140:143]
    s_lshl_b32 s87, s87, 7
    s_add_u32 s5, s5, s87
    s_sub_u32 s18, 401408, s5
    v_mfma_f32_16x16x32_bf16 a[20:23], v[52:55], a[240:243], a[20:23]
    s_mov_b32 s19, 0x20000
    s_lshl3_add_u32 s86, s39, s38
    s_mul_i32 s85, s86, 2756608
    v_mfma_f32_16x16x32_bf16 v[172:175], v[48:51], a[244:247], v[172:175]
    s_add_u32 s28, s50, s85
    s_addc_u32 s29, s51, 0
    s_and_b32 s29, s29, 0xffff
    s_lshl_b32 s85, s86, 4
    v_mfma_f32_16x16x32_bf16 v[16:19], v[52:55], a[244:247], v[16:19]
    s_add_u32 s32, s78, s85
    s_addc_u32 s33, s79, 0
    s_and_b32 s33, s33, 0xffff
    s_lshl_b32 s85, s37, 8
    v_mfma_f32_16x16x32_bf16 v[204:207], v[48:51], a[248:251], v[204:207]
    s_add_u32 s85, s85, 2752512
    ds_read_b64_tr_b16 v[48:49], v9 offset:2304
    v_lshrrev_b32_e64 v236, 2, v26
    v_mfma_f32_16x16x32_bf16 v[20:23], v[52:55], a[248:251], v[20:23]
    s_waitcnt lgkmcnt(9)
    ds_read_b64_tr_b16 v[50:51], v9 offset:3328
    v_or_b32 v236, s53, v236
    v_mfma_f32_16x16x32_bf16 v[228:231], v[56:59], a[252:255], v[228:231]
    ds_read_b64_tr_b16 v[52:53], v9 offset:2312
    v_mfma_f32_16x16x32_bf16 v[232:235], v[60:63], a[252:255], v[232:235]
    ds_read_b64_tr_b16 v[54:55], v9 offset:3336
    v_mfma_f32_16x16x32_bf16 v[148:151], v[56:59], a[240:243], v[148:151]
    buffer_store_dword v5, v236, s[28:31], s85 offen sc1
    v_mfma_f32_16x16x32_bf16 v[28:31], v[60:63], a[240:243], v[28:31]
    s_mul_i32 s85, s38, 401408
    s_add_u32 s85, s85, s5
    s_add_u32 s16, s76, s85
    s_addc_u32 s17, s77, 0
    v_mfma_f32_16x16x32_bf16 v[180:183], v[56:59], a[244:247], v[180:183]
    s_and_b32 s17, s17, 0xffff
    s_mov_b32 s76, s75
    s_mul_i32 s85, s38, 28672
    v_mfma_f32_16x16x32_bf16 v[244:247], v[60:63], a[244:247], v[244:247]
    v_add_u32 v10, s85, v10
    v_cmp_gt_u32 vcc, 192, v26
    v_mfma_f32_16x16x32_bf16 v[212:215], v[56:59], a[248:251], v[212:215]
    ds_read_b64_tr_b16 v[56:57], v9 offset:2432
    v_mov_b32 v5, 0x80000000
    v_mfma_f32_16x16x32_bf16 v[248:251], v[60:63], a[248:251], v[248:251]
    s_waitcnt lgkmcnt(9)
    ds_read_b64_tr_b16 v[58:59], v9 offset:3456
    s_nop 0
    v_mfma_f32_16x16x32_bf16 v[120:123], v[32:35], a[240:243], v[120:123]
    ds_read_b64_tr_b16 v[60:61], v9 offset:2440
    v_cndmask_b32 v10, v5, v10, vcc
    v_mfma_f32_16x16x32_bf16 v[252:255], v[36:39], a[240:243], v[252:255]
    ds_read_b64_tr_b16 v[62:63], v9 offset:3464
    v_add_u32 v9, s82, v9
    v_mfma_f32_16x16x32_bf16 v[152:155], v[32:35], a[244:247], v[152:155]
    v_mov_b32 v5, 1
    v_accvgpr_write_b32 a24, 0
    v_accvgpr_write_b32 a25, 0
    v_accvgpr_write_b32 a26, 0
    v_accvgpr_write_b32 a27, 0
    v_accvgpr_write_b32 a28, 0
    v_accvgpr_write_b32 a29, 0
    v_accvgpr_write_b32 a30, 0
    v_mfma_f32_16x16x32_bf16 v[64:67], v[36:39], a[244:247], v[64:67]
    v_accvgpr_write_b32 a31, 0
    v_accvgpr_write_b32 a32, 0
    v_mfma_f32_16x16x32_bf16 v[184:187], v[32:35], a[248:251], v[184:187]
    v_accvgpr_write_b32 a33, 0
    v_accvgpr_write_b32 a34, 0
    v_mfma_f32_16x16x32_bf16 v[68:71], v[36:39], a[248:251], v[68:71]
    s_waitcnt vmcnt(4) lgkmcnt(0)
    s_barrier
    v_mfma_f32_16x16x32_bf16 v[128:131], v[40:43], a[240:243], v[128:131]
    ds_read_b64_tr_b16 v[32:33], v9 offset:64
    v_accvgpr_write_b32 a35, 0
    v_mfma_f32_16x16x32_bf16 v[72:75], v[44:47], a[240:243], v[72:75]
    ds_read_b64_tr_b16 v[34:35], v9 offset:1088
    v_accvgpr_write_b32 a36, 0
    v_mfma_f32_16x16x32_bf16 v[160:163], v[40:43], a[244:247], v[160:163]
    ds_read_b64_tr_b16 v[36:37], v9 offset:2112
    v_accvgpr_write_b32 a37, 0
    v_accvgpr_write_b32 a38, 0
    v_accvgpr_write_b32 a39, 0
    v_accvgpr_write_b32 a40, 0
    v_accvgpr_write_b32 a41, 0
    v_accvgpr_write_b32 a42, 0
    v_accvgpr_write_b32 a43, 0
    v_mfma_f32_16x16x32_bf16 v[76:79], v[44:47], a[244:247], v[76:79]
    ds_read_b64_tr_b16 v[38:39], v9 offset:3136
    v_accvgpr_write_b32 a44, 0
    v_mfma_f32_16x16x32_bf16 v[192:195], v[40:43], a[248:251], v[192:195]
    ds_read_b128 a[236:239], v14 offset:0
    v_accvgpr_write_b32 a45, 0
    v_mfma_f32_16x16x32_bf16 v[80:83], v[44:47], a[248:251], v[80:83]
    ds_read_b128 a[252:255], v15 offset:0
    v_accvgpr_write_b32 a46, 0
    v_mfma_f32_16x16x32_bf16 v[136:139], v[48:51], a[240:243], v[136:139]
    ds_read_b64_tr_b16 v[40:41], v9 offset:72
    v_accvgpr_write_b32 a47, 0
    v_accvgpr_write_b32 a48, 0
    v_accvgpr_write_b32 a49, 0
    v_accvgpr_write_b32 a50, 0
    v_accvgpr_write_b32 a51, 0
    v_accvgpr_write_b32 a52, 0
    v_accvgpr_write_b32 a53, 0
    v_mfma_f32_16x16x32_bf16 v[84:87], v[52:55], a[240:243], v[84:87]
    ds_read_b64_tr_b16 v[42:43], v9 offset:1096
    v_accvgpr_write_b32 a54, 0
    v_mfma_f32_16x16x32_bf16 v[144:147], v[56:59], a[240:243], v[144:147]
    ds_read_b64_tr_b16 v[44:45], v9 offset:2120
    v_accvgpr_write_b32 a55, 0
    v_mfma_f32_16x16x32_bf16 v[108:111], v[60:63], a[240:243], v[108:111]
    ds_read_b128 a[224:227], v12 offset:0
    v_accvgpr_write_b32 a56, 0
    v_accvgpr_write_b32 a57, 0
    v_accvgpr_write_b32 a58, 0
    v_accvgpr_write_b32 a59, 0
    v_accvgpr_write_b32 a60, 0
    v_accvgpr_write_b32 a61, 0
    v_accvgpr_write_b32 a62, 0
    v_mfma_f32_16x16x32_bf16 v[168:171], v[48:51], a[244:247], v[168:171]
    ds_read_b128 a[240:243], v13 offset:0
    v_accvgpr_write_b32 a63, 0
    v_mfma_f32_16x16x32_bf16 v[88:91], v[52:55], a[244:247], v[88:91]
    ds_read_b64_tr_b16 v[46:47], v9 offset:3144
    v_accvgpr_write_b32 a64, 0
    v_mfma_f32_16x16x32_bf16 v[176:179], v[56:59], a[244:247], v[176:179]
    v_accvgpr_write_b32 a65, 0
    v_accvgpr_write_b32 a66, 0
    v_mfma_f32_16x16x32_bf16 v[112:115], v[60:63], a[244:247], v[112:115]
    ds_read_b128 a[228:231], v12 offset:2048
    v_accvgpr_write_b32 a67, 0
    v_mfma_f32_16x16x32_bf16 v[200:203], v[48:51], a[248:251], v[200:203]
    ds_read_b128 a[244:247], v13 offset:2048
    v_accvgpr_write_b32 a68, 0
    v_mfma_f32_16x16x32_bf16 v[92:95], v[52:55], a[248:251], v[92:95]
    v_accvgpr_write_b32 a69, 0
    v_accvgpr_write_b32 a70, 0
    v_mfma_f32_16x16x32_bf16 v[208:211], v[56:59], a[248:251], v[208:211]
    v_accvgpr_write_b32 a71, 0
    v_accvgpr_write_b32 a72, 0
    v_mfma_f32_16x16x32_bf16 v[116:119], v[60:63], a[248:251], v[116:119]
    ds_read_b128 a[232:235], v12 offset:4096
    v_accvgpr_write_b32 a73, 0
    ds_read_b128 a[248:251], v13 offset:4096
    v_accvgpr_write_b32 a74, 0
    v_accvgpr_write_b32 a75, 0
    v_accvgpr_write_b32 a76, 0
    v_accvgpr_write_b32 a77, 0
    v_accvgpr_write_b32 a78, 0
    v_accvgpr_write_b32 a79, 0
    v_accvgpr_write_b32 a80, 0
    v_accvgpr_write_b32 a81, 0
    v_accvgpr_write_b32 a82, 0
    v_accvgpr_write_b32 a83, 0
    v_accvgpr_write_b32 a84, 0
    v_accvgpr_write_b32 a85, 0
    v_accvgpr_write_b32 a86, 0
    v_accvgpr_write_b32 a87, 0
    v_accvgpr_write_b32 a88, 0
    v_accvgpr_write_b32 a89, 0
    v_accvgpr_write_b32 a90, 0
    v_accvgpr_write_b32 a91, 0
    v_accvgpr_write_b32 a92, 0
    v_accvgpr_write_b32 a93, 0
    v_accvgpr_write_b32 a94, 0
    v_accvgpr_write_b32 a95, 0
    v_accvgpr_write_b32 a96, 0
    v_accvgpr_write_b32 a97, 0
    v_accvgpr_write_b32 a98, 0
    v_accvgpr_write_b32 a99, 0
    v_accvgpr_write_b32 a100, 0
    v_accvgpr_write_b32 a101, 0
    v_accvgpr_write_b32 a102, 0
    v_accvgpr_write_b32 a103, 0
    v_accvgpr_write_b32 a104, 0
    v_accvgpr_write_b32 a105, 0
    v_accvgpr_write_b32 a106, 0
    v_accvgpr_write_b32 a107, 0
    v_accvgpr_write_b32 a108, 0
    v_accvgpr_write_b32 a109, 0
    v_accvgpr_write_b32 a110, 0
    v_accvgpr_write_b32 a111, 0
    v_accvgpr_write_b32 a112, 0
    v_accvgpr_write_b32 a113, 0
    v_accvgpr_write_b32 a114, 0
    v_accvgpr_write_b32 a115, 0
    v_accvgpr_write_b32 a116, 0
    v_accvgpr_write_b32 a117, 0
    v_accvgpr_write_b32 a118, 0
    v_accvgpr_write_b32 a119, 0
    v_accvgpr_write_b32 a120, 0
    v_accvgpr_write_b32 a121, 0
    v_accvgpr_write_b32 a122, 0
    v_accvgpr_write_b32 a123, 0
    s_waitcnt lgkmcnt(10)
    v_mfma_f32_16x16x32_bf16 v[216:219], v[32:35], a[236:239], v[216:219]
    s_mov_b32 m0, s66
    ds_read_b64_tr_b16 v[48:49], v9 offset:192
    s_add_u32 s65, s64, 0
    v_mfma_f32_16x16x32_bf16 v[216:219], v[36:39], a[252:255], v[216:219]
    s_waitcnt lgkmcnt(6)
    ds_read_b64_tr_b16 v[50:51], v9 offset:1216
    v_mfma_f32_16x16x32_bf16 v[124:127], v[32:35], a[224:227], v[124:127]
    buffer_load_dwordx4 v4, s[20:23], s65 offen lds
    v_mfma_f32_16x16x32_bf16 v[124:127], v[36:39], a[240:243], v[124:127]
    s_waitcnt lgkmcnt(6)
    ds_read_b64_tr_b16 v[52:53], v9 offset:2240
    v_accvgpr_write_b32 a124, 0
    v_accvgpr_write_b32 a125, 0
    v_accvgpr_write_b32 a126, 0
    v_accvgpr_write_b32 a127, 0
    v_accvgpr_write_b32 a128, 0
    v_accvgpr_write_b32 a129, 0
    v_accvgpr_write_b32 a130, 0
    v_mfma_f32_16x16x32_bf16 v[96:99], v[40:43], a[236:239], v[96:99]
    s_add_u32 s65, s64, 31744
    ds_read_b64_tr_b16 v[54:55], v9 offset:3264
    v_mfma_f32_16x16x32_bf16 v[96:99], v[44:47], a[252:255], v[96:99]
    buffer_load_dwordx4 v4, s[20:23], s65 offen offset:1024 lds
    v_mfma_f32_16x16x32_bf16 v[100:103], v[40:43], a[224:227], v[100:103]
    s_add_u32 s65, s64, 260096
    ds_read_b64_tr_b16 v[56:57], v9 offset:200
    v_mfma_f32_16x16x32_bf16 v[100:103], v[44:47], a[240:243], v[100:103]
    s_waitcnt lgkmcnt(7)
    ds_read_b64_tr_b16 v[58:59], v9 offset:1224
    v_mfma_f32_16x16x32_bf16 v[156:159], v[32:35], a[228:231], v[156:159]
    ds_read_b64_tr_b16 v[60:61], v9 offset:2248
    v_mfma_f32_16x16x32_bf16 v[156:159], v[36:39], a[244:247], v[156:159]
    buffer_load_dwordx4 v4, s[20:23], s65 offen offset:2048 lds
    v_mfma_f32_16x16x32_bf16 v[104:107], v[40:43], a[228:231], v[104:107]
    s_add_u32 s65, s64, 291840
    ds_read_b64_tr_b16 v[62:63], v9 offset:3272
    v_accvgpr_write_b32 a131, 0
    v_mfma_f32_16x16x32_bf16 v[104:107], v[44:47], a[244:247], v[104:107]
    s_waitcnt lgkmcnt(8)
    v_accvgpr_write_b32 a132, 0
    v_accvgpr_write_b32 a133, 0
    v_mfma_f32_16x16x32_bf16 v[188:191], v[32:35], a[232:235], v[188:191]
    ds_read_b64_tr_b16 v[32:33], v9 offset:320
    v_accvgpr_write_b32 a134, 0
    v_mfma_f32_16x16x32_bf16 v[188:191], v[36:39], a[248:251], v[188:191]
    s_barrier
    v_mfma_f32_16x16x32_bf16 v[240:243], v[40:43], a[232:235], v[240:243]
    buffer_load_dwordx4 v4, s[20:23], s65 offen offset:3072 lds
    v_mfma_f32_16x16x32_bf16 v[240:243], v[44:47], a[248:251], v[240:243]
    s_waitcnt lgkmcnt(5)
    ds_read_b64_tr_b16 v[34:35], v9 offset:1344
    v_accvgpr_write_b32 a135, 0
    v_mfma_f32_16x16x32_bf16 v[220:223], v[48:51], a[236:239], v[220:223]
    s_add_u32 m0, s57, 0
    ds_read_b64_tr_b16 v[36:37], v9 offset:2368
    v_accvgpr_write_b32 a136, 0
    v_accvgpr_write_b32 a137, 0
    v_accvgpr_write_b32 a138, 0
    v_accvgpr_write_b32 a139, 0
    v_accvgpr_write_b32 a140, 0
    v_accvgpr_write_b32 a141, 0
    v_accvgpr_write_b32 a142, 0
    v_mfma_f32_16x16x32_bf16 v[220:223], v[52:55], a[252:255], v[220:223]
    s_add_u32 s65, s56, 0
    ds_read_b64_tr_b16 v[38:39], v9 offset:3392
    v_accvgpr_write_b32 a143, 0
    v_mfma_f32_16x16x32_bf16 v[132:135], v[48:51], a[224:227], v[132:135]
    buffer_load_dwordx4 v25, s[8:11], s65 offen lds
    v_mfma_f32_16x16x32_bf16 v[132:135], v[52:55], a[240:243], v[132:135]
    s_add_u32 m0, s57, 4096
    ds_read_b64_tr_b16 v[40:41], v9 offset:328
    v_accvgpr_write_b32 a144, 0
    v_mfma_f32_16x16x32_bf16 v[164:167], v[48:51], a[228:231], v[164:167]
    s_add_u32 s65, s56, 28672
    ds_read_b64_tr_b16 v[42:43], v9 offset:1352
    v_mfma_f32_16x16x32_bf16 v[164:167], v[52:55], a[244:247], v[164:167]
    buffer_load_dwordx4 v25, s[8:11], s65 offen lds
    v_mfma_f32_16x16x32_bf16 v[196:199], v[48:51], a[232:235], v[196:199]
    s_add_u32 m0, s57, 8192
    ds_read_b64_tr_b16 v[44:45], v9 offset:2376
    s_add_u32 s65, s56, 57344
    v_mfma_f32_16x16x32_bf16 v[196:199], v[52:55], a[248:251], v[196:199]
    s_waitcnt lgkmcnt(7)
    ds_read_b64_tr_b16 v[46:47], v9 offset:3400
    v_accvgpr_write_b32 a145, 0
    v_accvgpr_write_b32 a146, 0
    v_accvgpr_write_b32 a147, 0
    v_accvgpr_write_b32 a148, 0
    v_accvgpr_write_b32 a149, 0
    v_accvgpr_write_b32 a150, 0
    v_accvgpr_write_b32 a151, 0
    v_mfma_f32_16x16x32_bf16 a[0:3], v[56:59], a[236:239], a[0:3]
    ds_read_b64_tr_b16 v[48:49], v9 offset:448
    v_mfma_f32_16x16x32_bf16 a[0:3], v[60:63], a[252:255], a[0:3]
    buffer_load_dwordx4 v25, s[8:11], s65 offen lds
    v_mfma_f32_16x16x32_bf16 a[4:7], v[56:59], a[224:227], a[4:7]
    s_add_u32 m0, s57, 12288
    ds_read_b64_tr_b16 v[50:51], v9 offset:1472
    s_add_u32 s65, s56, 86016
    v_mfma_f32_16x16x32_bf16 a[4:7], v[60:63], a[240:243], a[4:7]
    ds_read_b64_tr_b16 v[52:53], v9 offset:2496
    v_mfma_f32_16x16x32_bf16 a[8:11], v[56:59], a[228:231], a[8:11]
    ds_read_b64_tr_b16 v[54:55], v9 offset:3520
    v_mfma_f32_16x16x32_bf16 a[8:11], v[60:63], a[244:247], a[8:11]
    buffer_load_dwordx4 v25, s[8:11], s65 offen lds
    v_mfma_f32_16x16x32_bf16 a[12:15], v[56:59], a[232:235], a[12:15]
    s_add_u32 m0, s57, 16384
    ds_read_b64_tr_b16 v[56:57], v9 offset:456
    v_accvgpr_write_b32 a152, 0
    v_accvgpr_write_b32 a153, 0
    v_accvgpr_write_b32 a154, 0
    v_accvgpr_write_b32 a155, 0
    v_accvgpr_write_b32 a156, 0
    v_accvgpr_write_b32 a157, 0
    v_accvgpr_write_b32 a158, 0
    v_mfma_f32_16x16x32_bf16 a[12:15], v[60:63], a[248:251], a[12:15]
    s_waitcnt lgkmcnt(9)
    ds_read_b64_tr_b16 v[58:59], v9 offset:1480
    s_add_u32 s65, s56, 114688
    v_mfma_f32_16x16x32_bf16 v[224:227], v[32:35], a[236:239], v[224:227]
    ds_read_b64_tr_b16 v[60:61], v9 offset:2504
    v_mfma_f32_16x16x32_bf16 v[224:227], v[36:39], a[252:255], v[224:227]
    buffer_load_dwordx4 v25, s[8:11], s65 offen lds
    v_mfma_f32_16x16x32_bf16 v[140:143], v[32:35], a[224:227], v[140:143]
    s_add_u32 m0, s57, 20480
    ds_read_b64_tr_b16 v[62:63], v9 offset:3528
    s_add_u32 s65, s56, 143360
    v_mfma_f32_16x16x32_bf16 v[140:143], v[36:39], a[240:243], v[140:143]
    v_mfma_f32_16x16x32_bf16 v[172:175], v[32:35], a[228:231], v[172:175]
    v_mfma_f32_16x16x32_bf16 v[172:175], v[36:39], a[244:247], v[172:175]
    buffer_load_dwordx4 v25, s[8:11], s65 offen lds
    v_mfma_f32_16x16x32_bf16 v[204:207], v[32:35], a[232:235], v[204:207]
    s_add_u32 m0, s57, 24576
    ds_read_b64_tr_b16 v[32:33], v9 offset:0
    v_accvgpr_write_b32 a159, 0
    v_mfma_f32_16x16x32_bf16 v[204:207], v[36:39], a[248:251], v[204:207]
    s_waitcnt lgkmcnt(9)
    ds_read_b64_tr_b16 v[34:35], v9 offset:1024
    v_accvgpr_write_b32 a160, 0
    v_mfma_f32_16x16x32_bf16 a[16:19], v[40:43], a[236:239], a[16:19]
    s_add_u32 s65, s56, 172032
    ds_read_b64_tr_b16 v[36:37], v9 offset:2048
    v_accvgpr_write_b32 a161, 0
    v_mfma_f32_16x16x32_bf16 a[16:19], v[44:47], a[252:255], a[16:19]
    buffer_load_dwordx4 v25, s[8:11], s65 offen lds
    v_mfma_f32_16x16x32_bf16 a[20:23], v[40:43], a[224:227], a[20:23]
    s_add_u32 s56, s56, 128
    ds_read_b64_tr_b16 v[38:39], v9 offset:3072
    v_accvgpr_write_b32 a162, 0
    v_mfma_f32_16x16x32_bf16 a[20:23], v[44:47], a[240:243], a[20:23]
    s_add_u32 s69, s81, 24576
    v_accvgpr_write_b32 a163, 0
    v_accvgpr_write_b32 a164, 0
    v_mfma_f32_16x16x32_bf16 v[16:19], v[40:43], a[228:231], v[16:19]
    s_add_u32 s83, s83, 524288
    v_accvgpr_write_b32 a165, 0
    v_accvgpr_write_b32 a166, 0
    v_accvgpr_write_b32 a167, 0
    v_accvgpr_write_b32 a168, 0
    v_accvgpr_write_b32 a169, 0
    v_accvgpr_write_b32 a170, 0
    v_accvgpr_write_b32 a171, 0
    v_accvgpr_write_b32 a172, 0
    v_mfma_f32_16x16x32_bf16 v[16:19], v[44:47], a[244:247], v[16:19]
    s_min_u32 s83, s83, 3145728
    s_add_u32 m0, s66, 16512
    s_add_u32 s65, s64, 65536
    v_mfma_f32_16x16x32_bf16 v[20:23], v[40:43], a[232:235], v[20:23]
    buffer_load_dwordx4 v4, s[20:23], s65 offen lds
    v_mfma_f32_16x16x32_bf16 v[20:23], v[44:47], a[248:251], v[20:23]
    s_waitcnt lgkmcnt(8)
    ds_read_b64_tr_b16 v[40:41], v9 offset:8
    s_add_u32 s65, s64, 97280
    v_mfma_f32_16x16x32_bf16 v[228:231], v[48:51], a[236:239], v[228:231]
    ds_read_b64_tr_b16 v[42:43], v9 offset:1032
    v_mfma_f32_16x16x32_bf16 v[228:231], v[52:55], a[252:255], v[228:231]
    buffer_load_dwordx4 v4, s[20:23], s65 offen offset:1024 lds
    v_mfma_f32_16x16x32_bf16 v[148:151], v[48:51], a[224:227], v[148:151]
    s_add_u32 s65, s64, 325632
    ds_read_b64_tr_b16 v[44:45], v9 offset:2056
    v_mfma_f32_16x16x32_bf16 v[148:151], v[52:55], a[240:243], v[148:151]
    ds_read_b64_tr_b16 v[46:47], v9 offset:3080
    v_accvgpr_write_b32 a173, 0
    v_accvgpr_write_b32 a174, 0
    v_accvgpr_write_b32 a175, 0
    v_accvgpr_write_b32 a176, 0
    v_accvgpr_write_b32 a177, 0
    v_accvgpr_write_b32 a178, 0
    v_accvgpr_write_b32 a179, 0
    v_mfma_f32_16x16x32_bf16 v[180:183], v[48:51], a[228:231], v[180:183]
    v_mfma_f32_16x16x32_bf16 v[180:183], v[52:55], a[244:247], v[180:183]
    buffer_load_dwordx4 v4, s[20:23], s65 offen offset:2048 lds
    v_mfma_f32_16x16x32_bf16 v[212:215], v[48:51], a[232:235], v[212:215]
    s_add_u32 s65, s64, 357376
    ds_read_b64_tr_b16 v[48:49], v9 offset:128
    v_mfma_f32_16x16x32_bf16 v[212:215], v[52:55], a[248:251], v[212:215]
    s_waitcnt lgkmcnt(9)
    ds_read_b64_tr_b16 v[50:51], v9 offset:1152
    v_mfma_f32_16x16x32_bf16 v[232:235], v[56:59], a[236:239], v[232:235]
    ds_read_b64_tr_b16 v[52:53], v9 offset:2176
    v_mfma_f32_16x16x32_bf16 v[232:235], v[60:63], a[252:255], v[232:235]
    buffer_load_dwordx4 v4, s[20:23], s65 offen offset:3072 lds
    v_mfma_f32_16x16x32_bf16 v[28:31], v[56:59], a[224:227], v[28:31]
    s_add_u32 m0, s71, 124800
    ds_read_b64_tr_b16 v[54:55], v9 offset:3200
    v_accvgpr_write_b32 a180, 0
    v_accvgpr_write_b32 a181, 0
    v_accvgpr_write_b32 a182, 0
    v_accvgpr_write_b32 a183, 0
    v_accvgpr_write_b32 a184, 0
    v_accvgpr_write_b32 a185, 0
    v_accvgpr_write_b32 a186, 0
    v_mfma_f32_16x16x32_bf16 v[28:31], v[60:63], a[240:243], v[28:31]
    v_mfma_f32_16x16x32_bf16 v[244:247], v[56:59], a[228:231], v[244:247]
    v_mfma_f32_16x16x32_bf16 v[244:247], v[60:63], a[244:247], v[244:247]
    buffer_load_dwordx4 v26, s[12:15], s69 offen nt lds
    v_mfma_f32_16x16x32_bf16 v[248:251], v[56:59], a[232:235], v[248:251]
    ds_read_b64_tr_b16 v[56:57], v9 offset:136
    v_mfma_f32_16x16x32_bf16 v[248:251], v[60:63], a[248:251], v[248:251]
    s_waitcnt lgkmcnt(9)
    ds_read_b64_tr_b16 v[58:59], v9 offset:1160
    v_mfma_f32_16x16x32_bf16 v[120:123], v[32:35], a[224:227], v[120:123]
    buffer_load_dwordx4 v26, s[12:15], s69 offen offset:1024 nt lds
    v_mfma_f32_16x16x32_bf16 v[120:123], v[36:39], a[240:243], v[120:123]
    buffer_load_dword v6, v27, s[20:23], s83 offen
    v_mfma_f32_16x16x32_bf16 v[152:155], v[32:35], a[228:231], v[152:155]
    ds_read_b64_tr_b16 v[60:61], v9 offset:2184
    v_accvgpr_write_b32 a187, 0
    v_mfma_f32_16x16x32_bf16 v[152:155], v[36:39], a[244:247], v[152:155]
    buffer_load_dword v6, v10, s[24:27], 0 offen
    v_mfma_f32_16x16x32_bf16 v[184:187], v[32:35], a[232:235], v[184:187]
    ds_read_b64_tr_b16 v[62:63], v9 offset:3208
    v_add_u32 v10, 1536, v10
    v_mfma_f32_16x16x32_bf16 v[184:187], v[36:39], a[248:251], v[184:187]
    s_waitcnt lgkmcnt(8)
    ds_read_b64_tr_b16 v[32:33], v9 offset:256
    s_add_u32 s64, s64, 524288
    v_mfma_f32_16x16x32_bf16 v[252:255], v[40:43], a[224:227], v[252:255]
    s_add_u32 s66, s66, s82
    ds_read_b64_tr_b16 v[34:35], v9 offset:1280
    s_sub_u32 s82, 0, s82
    v_mfma_f32_16x16x32_bf16 v[252:255], v[44:47], a[240:243], v[252:255]
    ds_read_b64_tr_b16 v[36:37], v9 offset:2304
    v_accvgpr_write_b32 a188, 0
    v_mfma_f32_16x16x32_bf16 v[64:67], v[40:43], a[228:231], v[64:67]
    ds_read_b64_tr_b16 v[38:39], v9 offset:3328
    v_accvgpr_write_b32 a189, 0
    v_accvgpr_write_b32 a190, 0
    v_accvgpr_write_b32 a191, 0
    v_accvgpr_write_b32 a192, 0
    v_accvgpr_write_b32 a193, 0
    v_accvgpr_write_b32 a194, 0
    v_accvgpr_write_b32 a195, 0
    v_mfma_f32_16x16x32_bf16 v[64:67], v[44:47], a[244:247], v[64:67]
    v_accvgpr_write_b32 a196, 0
    v_accvgpr_write_b32 a197, 0
    v_mfma_f32_16x16x32_bf16 v[68:71], v[40:43], a[232:235], v[68:71]
    ds_read_b64_tr_b16 v[40:41], v9 offset:264
    v_accvgpr_write_b32 a198, 0
    v_mfma_f32_16x16x32_bf16 v[68:71], v[44:47], a[248:251], v[68:71]
    s_waitcnt lgkmcnt(9)
    ds_read_b64_tr_b16 v[42:43], v9 offset:1288
    v_accvgpr_write_b32 a199, 0
    v_mfma_f32_16x16x32_bf16 v[128:131], v[48:51], a[224:227], v[128:131]
    ds_read_b64_tr_b16 v[44:45], v9 offset:2312
    v_accvgpr_write_b32 a200, 0
    v_mfma_f32_16x16x32_bf16 v[128:131], v[52:55], a[240:243], v[128:131]
    ds_read_b64_tr_b16 v[46:47], v9 offset:3336
    v_mfma_f32_16x16x32_bf16 v[160:163], v[48:51], a[228:231], v[160:163]
    v_mfma_f32_16x16x32_bf16 v[160:163], v[52:55], a[244:247], v[160:163]
    v_accvgpr_write_b32 a201, 0
    v_accvgpr_write_b32 a202, 0
    v_accvgpr_write_b32 a203, 0
    v_accvgpr_write_b32 a204, 0
    v_accvgpr_write_b32 a205, 0
    v_accvgpr_write_b32 a206, 0
    v_accvgpr_write_b32 a207, 0
    v_mfma_f32_16x16x32_bf16 v[192:195], v[48:51], a[232:235], v[192:195]
    ds_read_b64_tr_b16 v[48:49], v9 offset:384
    v_mfma_f32_16x16x32_bf16 v[192:195], v[52:55], a[248:251], v[192:195]
    s_waitcnt lgkmcnt(9)
    ds_read_b64_tr_b16 v[50:51], v9 offset:1408
    v_mfma_f32_16x16x32_bf16 v[72:75], v[56:59], a[224:227], v[72:75]
    ds_read_b64_tr_b16 v[52:53], v9 offset:2432
    v_mfma_f32_16x16x32_bf16 v[72:75], v[60:63], a[240:243], v[72:75]
    ds_read_b64_tr_b16 v[54:55], v9 offset:3456
    v_mfma_f32_16x16x32_bf16 v[76:79], v[56:59], a[228:231], v[76:79]
    v_mfma_f32_16x16x32_bf16 v[76:79], v[60:63], a[244:247], v[76:79]
    v_mfma_f32_16x16x32_bf16 v[80:83], v[56:59], a[232:235], v[80:83]
    ds_read_b64_tr_b16 v[56:57], v9 offset:392
    v_accvgpr_write_b32 a208, 0
    v_accvgpr_write_b32 a209, 0
    v_accvgpr_write_b32 a210, 0
    v_accvgpr_write_b32 a211, 0
    v_accvgpr_write_b32 a212, 0
    v_accvgpr_write_b32 a213, 0
    v_accvgpr_write_b32 a214, 0
    v_mfma_f32_16x16x32_bf16 v[80:83], v[60:63], a[248:251], v[80:83]
    s_waitcnt lgkmcnt(9)
    ds_read_b64_tr_b16 v[58:59], v9 offset:1416
    v_mfma_f32_16x16x32_bf16 v[136:139], v[32:35], a[224:227], v[136:139]
    ds_read_b64_tr_b16 v[60:61], v9 offset:2440
    v_mfma_f32_16x16x32_bf16 v[136:139], v[36:39], a[240:243], v[136:139]
    ds_read_b64_tr_b16 v[62:63], v9 offset:3464
    v_add_u32 v9, s82, v9
    v_mfma_f32_16x16x32_bf16 v[168:171], v[32:35], a[228:231], v[168:171]
    v_mfma_f32_16x16x32_bf16 v[168:171], v[36:39], a[244:247], v[168:171]
    v_mfma_f32_16x16x32_bf16 v[200:203], v[32:35], a[232:235], v[200:203]
    v_mfma_f32_16x16x32_bf16 v[200:203], v[36:39], a[248:251], v[200:203]
    s_waitcnt vmcnt(4) lgkmcnt(0)
    s_barrier
    v_mfma_f32_16x16x32_bf16 v[84:87], v[40:43], a[224:227], v[84:87]
    ds_read_b64_tr_b16 v[32:33], v9 offset:64
    v_accvgpr_write_b32 a215, 0
    v_mfma_f32_16x16x32_bf16 v[84:87], v[44:47], a[240:243], v[84:87]
    ds_read_b64_tr_b16 v[34:35], v9 offset:1088
    v_accvgpr_write_b32 a216, 0
    v_mfma_f32_16x16x32_bf16 v[88:91], v[40:43], a[228:231], v[88:91]
    ds_read_b64_tr_b16 v[36:37], v9 offset:2112
    v_accvgpr_write_b32 a217, 0
    v_mfma_f32_16x16x32_bf16 v[88:91], v[44:47], a[244:247], v[88:91]
    ds_read_b64_tr_b16 v[38:39], v9 offset:3136
    v_accvgpr_write_b32 a218, 0
    v_mfma_f32_16x16x32_bf16 v[92:95], v[40:43], a[232:235], v[92:95]
    ds_read_b128 a[236:239], v14 offset:0
    v_accvgpr_write_b32 a219, 0
    v_mfma_f32_16x16x32_bf16 v[92:95], v[44:47], a[248:251], v[92:95]
    ds_read_b128 a[252:255], v15 offset:0
    v_accvgpr_write_b32 a220, 0
    v_mfma_f32_16x16x32_bf16 v[144:147], v[48:51], a[224:227], v[144:147]
    ds_read_b64_tr_b16 v[40:41], v9 offset:72
    v_accvgpr_write_b32 a221, 0
    v_accvgpr_write_b32 a222, 0
    v_mfma_f32_16x16x32_bf16 v[144:147], v[52:55], a[240:243], v[144:147]
    ds_read_b64_tr_b16 v[42:43], v9 offset:1096
    v_mfma_f32_16x16x32_bf16 v[108:111], v[56:59], a[224:227], v[108:111]
    ds_read_b64_tr_b16 v[44:45], v9 offset:2120
    v_mfma_f32_16x16x32_bf16 v[108:111], v[60:63], a[240:243], v[108:111]
    ds_read_b128 a[224:227], v12 offset:0
    v_mfma_f32_16x16x32_bf16 v[176:179], v[48:51], a[228:231], v[176:179]
    ds_read_b128 a[240:243], v13 offset:0
    v_mfma_f32_16x16x32_bf16 v[176:179], v[52:55], a[244:247], v[176:179]
    ds_read_b64_tr_b16 v[46:47], v9 offset:3144
    v_mfma_f32_16x16x32_bf16 v[112:115], v[56:59], a[228:231], v[112:115]
    v_mfma_f32_16x16x32_bf16 v[112:115], v[60:63], a[244:247], v[112:115]
    ds_read_b128 a[228:231], v12 offset:2048
    v_mfma_f32_16x16x32_bf16 v[208:211], v[48:51], a[232:235], v[208:211]
    ds_read_b128 a[244:247], v13 offset:2048
    v_mfma_f32_16x16x32_bf16 v[208:211], v[52:55], a[248:251], v[208:211]
    v_mfma_f32_16x16x32_bf16 v[116:119], v[56:59], a[232:235], v[116:119]
    v_mfma_f32_16x16x32_bf16 v[116:119], v[60:63], a[248:251], v[116:119]
    ds_read_b128 a[232:235], v12 offset:4096
    ds_read_b128 a[248:251], v13 offset:4096
L_q1:
    s_waitcnt lgkmcnt(10)
    v_mfma_f32_16x16x32_bf16 v[216:219], v[32:35], a[236:239], v[216:219]
    s_mov_b32 m0, s66
    ds_read_b64_tr_b16 v[48:49], v9 offset:192
    s_add_u32 s65, s64, 0
    v_mfma_f32_16x16x32_bf16 v[216:219], v[36:39], a[252:255], v[216:219]
    s_waitcnt lgkmcnt(6)
    ds_read_b64_tr_b16 v[50:51], v9 offset:1216
    v_mfma_f32_16x16x32_bf16 v[124:127], v[32:35], a[224:227], v[124:127]
    buffer_load_dwordx4 v4, s[20:23], s65 offen lds
    v_mfma_f32_16x16x32_bf16 v[124:127], v[36:39], a[240:243], v[124:127]
    s_waitcnt lgkmcnt(6)
    ds_read_b64_tr_b16 v[52:53], v9 offset:2240
    s_add_u32 s65, s64, 31744
    v_mfma_f32_16x16x32_bf16 v[96:99], v[40:43], a[236:239], v[96:99]
    ds_read_b64_tr_b16 v[54:55], v9 offset:3264
    v_mfma_f32_16x16x32_bf16 v[96:99], v[44:47], a[252:255], v[96:99]
    buffer_load_dwordx4 v4, s[20:23], s65 offen offset:1024 lds
    v_mfma_f32_16x16x32_bf16 v[100:103], v[40:43], a[224:227], v[100:103]
    s_add_u32 s65, s64, 260096
    ds_read_b64_tr_b16 v[56:57], v9 offset:200
    v_mfma_f32_16x16x32_bf16 v[100:103], v[44:47], a[240:243], v[100:103]
    s_waitcnt lgkmcnt(7)
    ds_read_b64_tr_b16 v[58:59], v9 offset:1224
    v_mfma_f32_16x16x32_bf16 v[156:159], v[32:35], a[228:231], v[156:159]
    ds_read_b64_tr_b16 v[60:61], v9 offset:2248
    v_mfma_f32_16x16x32_bf16 v[156:159], v[36:39], a[244:247], v[156:159]
    buffer_load_dwordx4 v4, s[20:23], s65 offen offset:2048 lds
    v_mfma_f32_16x16x32_bf16 v[104:107], v[40:43], a[228:231], v[104:107]
    s_add_u32 s65, s64, 291840
    ds_read_b64_tr_b16 v[62:63], v9 offset:3272
    v_mfma_f32_16x16x32_bf16 v[104:107], v[44:47], a[244:247], v[104:107]
    s_waitcnt lgkmcnt(8)
    v_mfma_f32_16x16x32_bf16 v[188:191], v[32:35], a[232:235], v[188:191]
    ds_read_b64_tr_b16 v[32:33], v9 offset:320
    v_mfma_f32_16x16x32_bf16 v[188:191], v[36:39], a[248:251], v[188:191]
    s_barrier
    v_mfma_f32_16x16x32_bf16 v[240:243], v[40:43], a[232:235], v[240:243]
    buffer_load_dwordx4 v4, s[20:23], s65 offen offset:3072 lds
    v_mfma_f32_16x16x32_bf16 v[240:243], v[44:47], a[248:251], v[240:243]
    s_waitcnt lgkmcnt(5)
    ds_read_b64_tr_b16 v[34:35], v9 offset:1344
    s_add_u32 m0, s57, 0
    v_mfma_f32_16x16x32_bf16 v[220:223], v[48:51], a[236:239], v[220:223]
    s_add_u32 s65, s56, 0
    ds_read_b64_tr_b16 v[36:37], v9 offset:2368
    v_mfma_f32_16x16x32_bf16 v[220:223], v[52:55], a[252:255], v[220:223]
    buffer_load_dwordx4 v25, s[8:11], s65 offen lds
    v_mfma_f32_16x16x32_bf16 v[132:135], v[48:51], a[224:227], v[132:135]
    s_add_u32 m0, s57, 4096
    ds_read_b64_tr_b16 v[38:39], v9 offset:3392
    s_add_u32 s65, s56, 28672
    v_mfma_f32_16x16x32_bf16 v[132:135], v[52:55], a[240:243], v[132:135]
    ds_read_b64_tr_b16 v[40:41], v9 offset:328
    v_mfma_f32_16x16x32_bf16 v[164:167], v[48:51], a[228:231], v[164:167]
    ds_read_b64_tr_b16 v[42:43], v9 offset:1352
    v_mfma_f32_16x16x32_bf16 v[164:167], v[52:55], a[244:247], v[164:167]
    buffer_load_dwordx4 v25, s[8:11], s65 offen lds
    v_mfma_f32_16x16x32_bf16 v[196:199], v[48:51], a[232:235], v[196:199]
    s_add_u32 m0, s57, 8192
    ds_read_b64_tr_b16 v[44:45], v9 offset:2376
    s_add_u32 s65, s56, 57344
    v_mfma_f32_16x16x32_bf16 v[196:199], v[52:55], a[248:251], v[196:199]
    s_waitcnt lgkmcnt(7)
    ds_read_b64_tr_b16 v[46:47], v9 offset:3400
    v_mfma_f32_16x16x32_bf16 a[0:3], v[56:59], a[236:239], a[0:3]
    ds_read_b64_tr_b16 v[48:49], v9 offset:448
    v_mfma_f32_16x16x32_bf16 a[0:3], v[60:63], a[252:255], a[0:3]
    buffer_load_dwordx4 v25, s[8:11], s65 offen lds
    v_mfma_f32_16x16x32_bf16 a[4:7], v[56:59], a[224:227], a[4:7]
    s_add_u32 m0, s57, 12288
    ds_read_b64_tr_b16 v[50:51], v9 offset:1472
    s_add_u32 s65, s56, 86016
    v_mfma_f32_16x16x32_bf16 a[4:7], v[60:63], a[240:243], a[4:7]
    ds_read_b64_tr_b16 v[52:53], v9 offset:2496
    v_mfma_f32_16x16x32_bf16 a[8:11], v[56:59], a[228:231], a[8:11]
    ds_read_b64_tr_b16 v[54:55], v9 offset:3520
    v_mfma_f32_16x16x32_bf16 a[8:11], v[60:63], a[244:247], a[8:11]
    buffer_load_dwordx4 v25, s[8:11], s65 offen lds
    v_mfma_f32_16x16x32_bf16 a[12:15], v[56:59], a[232:235], a[12:15]
    s_add_u32 m0, s57, 16384
    ds_read_b64_tr_b16 v[56:57], v9 offset:456
    s_add_u32 s65, s56, 114688
    v_mfma_f32_16x16x32_bf16 a[12:15], v[60:63], a[248:251], a[12:15]
    s_waitcnt lgkmcnt(9)
    ds_read_b64_tr_b16 v[58:59], v9 offset:1480
    v_mfma_f32_16x16x32_bf16 v[224:227], v[32:35], a[236:239], v[224:227]
    ds_read_b64_tr_b16 v[60:61], v9 offset:2504
    v_mfma_f32_16x16x32_bf16 v[224:227], v[36:39], a[252:255], v[224:227]
    buffer_load_dwordx4 v25, s[8:11], s65 offen lds
    v_mfma_f32_16x16x32_bf16 v[140:143], v[32:35], a[224:227], v[140:143]
    s_add_u32 m0, s57, 20480
    ds_read_b64_tr_b16 v[62:63], v9 offset:3528
    s_add_u32 s65, s56, 143360
    v_mfma_f32_16x16x32_bf16 v[140:143], v[36:39], a[240:243], v[140:143]
    v_mfma_f32_16x16x32_bf16 v[172:175], v[32:35], a[228:231], v[172:175]
    v_mfma_f32_16x16x32_bf16 v[172:175], v[36:39], a[244:247], v[172:175]
    buffer_load_dwordx4 v25, s[8:11], s65 offen lds
    v_mfma_f32_16x16x32_bf16 v[204:207], v[32:35], a[232:235], v[204:207]
    s_add_u32 m0, s57, 24576
    ds_read_b64_tr_b16 v[32:33], v9 offset:0
    s_add_u32 s65, s56, 172032
    v_mfma_f32_16x16x32_bf16 v[204:207], v[36:39], a[248:251], v[204:207]
    s_waitcnt lgkmcnt(9)
    ds_read_b64_tr_b16 v[34:35], v9 offset:1024
    v_mfma_f32_16x16x32_bf16 a[16:19], v[40:43], a[236:239], a[16:19]
    ds_read_b64_tr_b16 v[36:37], v9 offset:2048
    v_mfma_f32_16x16x32_bf16 a[16:19], v[44:47], a[252:255], a[16:19]
    buffer_load_dwordx4 v25, s[8:11], s65 offen lds
    v_mfma_f32_16x16x32_bf16 a[20:23], v[40:43], a[224:227], a[20:23]
    s_add_u32 s56, s56, 128
    ds_read_b64_tr_b16 v[38:39], v9 offset:3072
    s_bitcmp1_b64 s[62:63], s70
    v_mfma_f32_16x16x32_bf16 a[20:23], v[44:47], a[240:243], a[20:23]
    s_cselect_b64 s[12:13], s[58:59], s[60:61]
    s_cselect_b32 s69, s67, s68
    s_cselect_b32 s87, 8192, 0
    v_mfma_f32_16x16x32_bf16 v[16:19], v[40:43], a[228:231], v[16:19]
    s_add_u32 s67, s67, s87
    s_xor_b32 s87, s87, 8192
    s_add_u32 s68, s68, s87
    v_mfma_f32_16x16x32_bf16 v[16:19], v[44:47], a[244:247], v[16:19]
    s_and_b32 s87, s70, 15
    s_mul_i32 s87, s87, 8320
    s_add_u32 s83, s83, 524288
    v_mfma_f32_16x16x32_bf16 v[20:23], v[40:43], a[232:235], v[20:23]
    s_min_u32 s83, s83, 3145728
    ds_read_b64_tr_b16 v[40:41], v9 offset:8
    s_add_u32 s73, s73, 1
    v_mfma_f32_16x16x32_bf16 v[20:23], v[44:47], a[248:251], v[20:23]
    s_waitcnt lgkmcnt(9)
    ds_read_b64_tr_b16 v[42:43], v9 offset:1032
    s_add_u32 m0, s66, 16512
    v_mfma_f32_16x16x32_bf16 v[228:231], v[48:51], a[236:239], v[228:231]
    s_add_u32 s65, s64, 65536
    ds_read_b64_tr_b16 v[44:45], v9 offset:2056
    v_mfma_f32_16x16x32_bf16 v[228:231], v[52:55], a[252:255], v[228:231]
    buffer_load_dwordx4 v4, s[20:23], s65 offen lds
    v_mfma_f32_16x16x32_bf16 v[148:151], v[48:51], a[224:227], v[148:151]
    s_add_u32 s65, s64, 97280
    ds_read_b64_tr_b16 v[46:47], v9 offset:3080
    v_mfma_f32_16x16x32_bf16 v[148:151], v[52:55], a[240:243], v[148:151]
    buffer_load_dwordx4 v4, s[20:23], s65 offen offset:1024 lds
    v_mfma_f32_16x16x32_bf16 v[180:183], v[48:51], a[228:231], v[180:183]
    s_add_u32 s65, s64, 325632
    v_mfma_f32_16x16x32_bf16 v[180:183], v[52:55], a[244:247], v[180:183]
    buffer_load_dwordx4 v4, s[20:23], s65 offen offset:2048 lds
    v_mfma_f32_16x16x32_bf16 v[212:215], v[48:51], a[232:235], v[212:215]
    s_add_u32 s65, s64, 357376
    ds_read_b64_tr_b16 v[48:49], v9 offset:128
    v_mfma_f32_16x16x32_bf16 v[212:215], v[52:55], a[248:251], v[212:215]
    s_waitcnt lgkmcnt(9)
    ds_read_b64_tr_b16 v[50:51], v9 offset:1152
    v_mfma_f32_16x16x32_bf16 v[232:235], v[56:59], a[236:239], v[232:235]
    ds_read_b64_tr_b16 v[52:53], v9 offset:2176
    v_mfma_f32_16x16x32_bf16 v[232:235], v[60:63], a[252:255], v[232:235]
    buffer_load_dwordx4 v4, s[20:23], s65 offen offset:3072 lds
    v_mfma_f32_16x16x32_bf16 v[28:31], v[56:59], a[224:227], v[28:31]
    s_add_u32 m0, s87, s71
    ds_read_b64_tr_b16 v[54:55], v9 offset:3200
    s_add_u32 s70, s70, 1
    v_mfma_f32_16x16x32_bf16 v[28:31], v[60:63], a[240:243], v[28:31]
    v_mfma_f32_16x16x32_bf16 v[244:247], v[56:59], a[228:231], v[244:247]
    v_mfma_f32_16x16x32_bf16 v[244:247], v[60:63], a[244:247], v[244:247]
    buffer_load_dwordx4 v26, s[12:15], s69 offen nt lds
    v_mfma_f32_16x16x32_bf16 v[248:251], v[56:59], a[232:235], v[248:251]
    ds_read_b64_tr_b16 v[56:57], v9 offset:136
    v_mfma_f32_16x16x32_bf16 v[248:251], v[60:63], a[248:251], v[248:251]
    s_waitcnt lgkmcnt(9)
    ds_read_b64_tr_b16 v[58:59], v9 offset:1160
    v_mfma_f32_16x16x32_bf16 v[120:123], v[32:35], a[224:227], v[120:123]
    buffer_load_dwordx4 v26, s[12:15], s69 offen offset:1024 nt lds
    v_mfma_f32_16x16x32_bf16 v[120:123], v[36:39], a[240:243], v[120:123]
    buffer_load_dword v6, v27, s[20:23], s83 offen
    v_mfma_f32_16x16x32_bf16 v[152:155], v[32:35], a[228:231], v[152:155]
    ds_read_b64_tr_b16 v[60:61], v9 offset:2184
    v_mfma_f32_16x16x32_bf16 v[152:155], v[36:39], a[244:247], v[152:155]
    buffer_load_dword v6, v10, s[24:27], 0 offen
    v_mfma_f32_16x16x32_bf16 v[184:187], v[32:35], a[232:235], v[184:187]
    ds_read_b64_tr_b16 v[62:63], v9 offset:3208
    v_add_u32 v10, 1536, v10
    v_mfma_f32_16x16x32_bf16 v[184:187], v[36:39], a[248:251], v[184:187]
    s_waitcnt lgkmcnt(8)
    ds_read_b64_tr_b16 v[32:33], v9 offset:256
    s_add_u32 s64, s64, 524288
    v_mfma_f32_16x16x32_bf16 v[252:255], v[40:43], a[224:227], v[252:255]
    s_add_u32 s66, s66, s82
    ds_read_b64_tr_b16 v[34:35], v9 offset:1280
    s_sub_u32 s82, 0, s82
    v_mfma_f32_16x16x32_bf16 v[252:255], v[44:47], a[240:243], v[252:255]
    ds_read_b64_tr_b16 v[36:37], v9 offset:2304
    v_mfma_f32_16x16x32_bf16 v[64:67], v[40:43], a[228:231], v[64:67]
    ds_read_b64_tr_b16 v[38:39], v9 offset:3328
    v_mfma_f32_16x16x32_bf16 v[64:67], v[44:47], a[244:247], v[64:67]
    v_mfma_f32_16x16x32_bf16 v[68:71], v[40:43], a[232:235], v[68:71]
    ds_read_b64_tr_b16 v[40:41], v9 offset:264
    v_mfma_f32_16x16x32_bf16 v[68:71], v[44:47], a[248:251], v[68:71]
    s_waitcnt lgkmcnt(9)
    ds_read_b64_tr_b16 v[42:43], v9 offset:1288
    v_mfma_f32_16x16x32_bf16 v[128:131], v[48:51], a[224:227], v[128:131]
    ds_read_b64_tr_b16 v[44:45], v9 offset:2312
    v_mfma_f32_16x16x32_bf16 v[128:131], v[52:55], a[240:243], v[128:131]
    ds_read_b64_tr_b16 v[46:47], v9 offset:3336
    v_mfma_f32_16x16x32_bf16 v[160:163], v[48:51], a[228:231], v[160:163]
    v_mfma_f32_16x16x32_bf16 v[160:163], v[52:55], a[244:247], v[160:163]
    v_mfma_f32_16x16x32_bf16 v[192:195], v[48:51], a[232:235], v[192:195]
    ds_read_b64_tr_b16 v[48:49], v9 offset:384
    v_mfma_f32_16x16x32_bf16 v[192:195], v[52:55], a[248:251], v[192:195]
    s_waitcnt lgkmcnt(9)
    ds_read_b64_tr_b16 v[50:51], v9 offset:1408
    v_mfma_f32_16x16x32_bf16 v[72:75], v[56:59], a[224:227], v[72:75]
    ds_read_b64_tr_b16 v[52:53], v9 offset:2432
    v_mfma_f32_16x16x32_bf16 v[72:75], v[60:63], a[240:243], v[72:75]
    ds_read_b64_tr_b16 v[54:55], v9 offset:3456
    v_mfma_f32_16x16x32_bf16 v[76:79], v[56:59], a[228:231], v[76:79]
    v_mfma_f32_16x16x32_bf16 v[76:79], v[60:63], a[244:247], v[76:79]
    v_mfma_f32_16x16x32_bf16 v[80:83], v[56:59], a[232:235], v[80:83]
    ds_read_b64_tr_b16 v[56:57], v9 offset:392
    v_mfma_f32_16x16x32_bf16 v[80:83], v[60:63], a[248:251], v[80:83]
    s_waitcnt lgkmcnt(9)
    ds_read_b64_tr_b16 v[58:59], v9 offset:1416
    v_mfma_f32_16x16x32_bf16 v[136:139], v[32:35], a[224:227], v[136:139]
    ds_read_b64_tr_b16 v[60:61], v9 offset:2440
    v_mfma_f32_16x16x32_bf16 v[136:139], v[36:39], a[240:243], v[136:139]
    ds_read_b64_tr_b16 v[62:63], v9 offset:3464
    v_add_u32_e64 v9, s82, v9
    v_mfma_f32_16x16x32_bf16 v[168:171], v[32:35], a[228:231], v[168:171]
    v_mfma_f32_16x16x32_bf16 v[168:171], v[36:39], a[244:247], v[168:171]
    v_mfma_f32_16x16x32_bf16 v[200:203], v[32:35], a[232:235], v[200:203]
    v_mfma_f32_16x16x32_bf16 v[200:203], v[36:39], a[248:251], v[200:203]
    s_waitcnt vmcnt(4) lgkmcnt(0)
    s_barrier
    v_mfma_f32_16x16x32_bf16 v[84:87], v[40:43], a[224:227], v[84:87]
    ds_read_b64_tr_b16 v[32:33], v9 offset:64
    v_mfma_f32_16x16x32_bf16 v[84:87], v[44:47], a[240:243], v[84:87]
    ds_read_b64_tr_b16 v[34:35], v9 offset:1088
    v_mfma_f32_16x16x32_bf16 v[88:91], v[40:43], a[228:231], v[88:91]
    ds_read_b64_tr_b16 v[36:37], v9 offset:2112
    v_mfma_f32_16x16x32_bf16 v[88:91], v[44:47], a[244:247], v[88:91]
    ds_read_b64_tr_b16 v[38:39], v9 offset:3136
    v_mfma_f32_16x16x32_bf16 v[92:95], v[40:43], a[232:235], v[92:95]
    ds_read_b128 a[236:239], v14 offset:0
    v_mfma_f32_16x16x32_bf16 v[92:95], v[44:47], a[248:251], v[92:95]
    ds_read_b128 a[252:255], v15 offset:0
    v_mfma_f32_16x16x32_bf16 v[144:147], v[48:51], a[224:227], v[144:147]
    ds_read_b64_tr_b16 v[40:41], v9 offset:72
    v_mfma_f32_16x16x32_bf16 v[144:147], v[52:55], a[240:243], v[144:147]
    ds_read_b64_tr_b16 v[42:43], v9 offset:1096
    v_mfma_f32_16x16x32_bf16 v[108:111], v[56:59], a[224:227], v[108:111]
    ds_read_b64_tr_b16 v[44:45], v9 offset:2120
    v_mfma_f32_16x16x32_bf16 v[108:111], v[60:63], a[240:243], v[108:111]
    ds_read_b128 a[224:227], v12 offset:0
    v_mfma_f32_16x16x32_bf16 v[176:179], v[48:51], a[228:231], v[176:179]
    ds_read_b128 a[240:243], v13 offset:0
    v_mfma_f32_16x16x32_bf16 v[176:179], v[52:55], a[244:247], v[176:179]
    ds_read_b64_tr_b16 v[46:47], v9 offset:3144
    v_mfma_f32_16x16x32_bf16 v[112:115], v[56:59], a[228:231], v[112:115]
    v_mfma_f32_16x16x32_bf16 v[112:115], v[60:63], a[244:247], v[112:115]
    ds_read_b128 a[228:231], v12 offset:2048
    v_mfma_f32_16x16x32_bf16 v[208:211], v[48:51], a[232:235], v[208:211]
    ds_read_b128 a[244:247], v13 offset:2048
    v_mfma_f32_16x16x32_bf16 v[208:211], v[52:55], a[248:251], v[208:211]
    v_mfma_f32_16x16x32_bf16 v[116:119], v[56:59], a[232:235], v[116:119]
    v_mfma_f32_16x16x32_bf16 v[116:119], v[60:63], a[248:251], v[116:119]
    ds_read_b128 a[232:235], v12 offset:4096
    ds_read_b128 a[248:251], v13 offset:4096
    s_cmp_lt_u32 s73, 6
    s_cbranch_scc1 L_q1
    s_waitcnt lgkmcnt(10)
    v_mfma_f32_16x16x32_bf16 v[216:219], v[32:35], a[236:239], v[216:219]
    s_mov_b32 s70, 29
    ds_read_b64_tr_b16 v[48:49], v9 offset:192
    v_readfirstlane_b32 s85, v10
    v_mfma_f32_16x16x32_bf16 v[216:219], v[36:39], a[252:255], v[216:219]
    s_waitcnt lgkmcnt(6)
    ds_read_b64_tr_b16 v[50:51], v9 offset:1216
    v_mov_b32 v12, 0
    v_mfma_f32_16x16x32_bf16 v[124:127], v[32:35], a[224:227], v[124:127]
    s_sub_u32 s85, s85, 7680
    ds_read_b64_tr_b16 v[52:53], v9 offset:2240
    v_lshl_add_u32 v10, v26, 3, s85
    v_mfma_f32_16x16x32_bf16 v[124:127], v[36:39], a[240:243], v[124:127]
    s_waitcnt lgkmcnt(7)
    ds_read_b64_tr_b16 v[54:55], v9 offset:3264
    v_cvt_pk_bf16_f32 v216, v216, v217
    v_mfma_f32_16x16x32_bf16 v[96:99], v[40:43], a[236:239], v[96:99]
    buffer_load_dword v6, v10, s[24:27], 0 offen
    v_mfma_f32_16x16x32_bf16 v[96:99], v[44:47], a[252:255], v[96:99]
    s_add_u32 s67, s81, 81920
    ds_read_b64_tr_b16 v[56:57], v9 offset:200
    v_accvgpr_read_b32 v25, a223
    v_mfma_f32_16x16x32_bf16 v[100:103], v[40:43], a[224:227], v[100:103]
    s_add_u32 s68, s81, 57344
    ds_read_b64_tr_b16 v[58:59], v9 offset:1224
    v_cvt_pk_bf16_f32 v217, v218, v219
    v_mfma_f32_16x16x32_bf16 v[100:103], v[44:47], a[240:243], v[100:103]
    s_waitcnt lgkmcnt(8)
    ds_read_b64_tr_b16 v[60:61], v9 offset:2248
    v_cvt_pk_bf16_f32 v124, v124, v125
    v_mfma_f32_16x16x32_bf16 v[156:159], v[32:35], a[228:231], v[156:159]
    s_mov_b32 s73, 0
    ds_read_b64_tr_b16 v[62:63], v9 offset:3272
    v_cvt_pk_bf16_f32 v125, v126, v127
    v_mfma_f32_16x16x32_bf16 v[156:159], v[36:39], a[244:247], v[156:159]
    s_lshl_b32 s86, s3, 10
    v_mov_b32 v13, 0
    v_mov_b32_e64 v14, 0
    v_mfma_f32_16x16x32_bf16 v[104:107], v[40:43], a[228:231], v[104:107]
    s_add_u32 s86, s86, 149504
    v_mov_b32 v15, 0
    v_mfma_f32_16x16x32_bf16 v[104:107], v[44:47], a[244:247], v[104:107]
    s_waitcnt lgkmcnt(8)
    v_mfma_f32_16x16x32_bf16 v[188:191], v[32:35], a[232:235], v[188:191]
    ds_read_b64_tr_b16 v[32:33], v9 offset:320
    v_cvt_pk_bf16_f32 v156, v156, v157
    v_mfma_f32_16x16x32_bf16 v[188:191], v[36:39], a[248:251], v[188:191]
    s_barrier
    v_mfma_f32_16x16x32_bf16 v[240:243], v[40:43], a[232:235], v[240:243]
    global_load_dword v6, v25, s[54:55]
    v_mfma_f32_16x16x32_bf16 v[240:243], v[44:47], a[248:251], v[240:243]
    s_waitcnt lgkmcnt(5)
    ds_read_b64_tr_b16 v[34:35], v9 offset:1344
    v_cvt_pk_bf16_f32 v157, v158, v159
    v_mfma_f32_16x16x32_bf16 v[220:223], v[48:51], a[236:239], v[220:223]
    ds_read_b64_tr_b16 v[36:37], v9 offset:2368
    v_cvt_pk_bf16_f32 v188, v188, v189
    v_mfma_f32_16x16x32_bf16 v[220:223], v[52:55], a[252:255], v[220:223]
    ds_read_b64_tr_b16 v[38:39], v9 offset:3392
    v_cvt_pk_bf16_f32 v189, v190, v191
    v_mfma_f32_16x16x32_bf16 v[132:135], v[48:51], a[224:227], v[132:135]
    ds_read_b64_tr_b16 v[40:41], v9 offset:328
    v_accvgpr_write_b32 a223, 0
    v_mfma_f32_16x16x32_bf16 v[132:135], v[52:55], a[240:243], v[132:135]
    ds_read_b64_tr_b16 v[42:43], v9 offset:1352
    v_lshrrev_b32 v27, 1, v26
    v_mfma_f32_16x16x32_bf16 v[164:167], v[48:51], a[228:231], v[164:167]
    s_mov_b64 s[12:13], s[60:61]
    ds_read_b64_tr_b16 v[44:45], v9 offset:2376
    v_cvt_pk_bf16_f32 v218, v96, v97
    v_mfma_f32_16x16x32_bf16 v[164:167], v[52:55], a[244:247], v[164:167]
    s_add_u32 s69, s81, 16384
    ds_read_b64_tr_b16 v[46:47], v9 offset:3400
    v_cvt_pk_bf16_f32 v219, v98, v99
    v_mfma_f32_16x16x32_bf16 v[196:199], v[48:51], a[232:235], v[196:199]
    ds_write_b128 v7, v[216:219] offset:0
    v_mfma_f32_16x16x32_bf16 v[196:199], v[52:55], a[248:251], v[196:199]
    s_waitcnt lgkmcnt(9)
    ds_read_b64_tr_b16 v[48:49], v9 offset:448
    v_cvt_pk_bf16_f32 v126, v100, v101
    v_mfma_f32_16x16x32_bf16 a[0:3], v[56:59], a[236:239], a[0:3]
    s_add_u32 m0, s71, 33280
    ds_read_b64_tr_b16 v[50:51], v9 offset:1472
    v_cvt_pk_bf16_f32 v127, v102, v103
    v_mfma_f32_16x16x32_bf16 a[0:3], v[60:63], a[252:255], a[0:3]
    buffer_load_dwordx4 v26, s[12:15], s69 offen nt lds
    v_mfma_f32_16x16x32_bf16 a[4:7], v[56:59], a[224:227], a[4:7]
    ds_read_b64_tr_b16 v[52:53], v9 offset:2496
    v_cvt_pk_bf16_f32 v158, v104, v105
    v_mfma_f32_16x16x32_bf16 a[4:7], v[60:63], a[240:243], a[4:7]
    ds_read_b64_tr_b16 v[54:55], v9 offset:3520
    v_cvt_pk_bf16_f32 v159, v106, v107
    v_mfma_f32_16x16x32_bf16 a[8:11], v[56:59], a[228:231], a[8:11]
    v_cvt_pk_bf16_f32 v190, v240, v241
    v_cvt_pk_bf16_f32 v191, v242, v243
    v_mfma_f32_16x16x32_bf16 a[8:11], v[60:63], a[244:247], a[8:11]
    v_cvt_pk_bf16_f32 v220, v220, v221
    v_cvt_pk_bf16_f32 v221, v222, v223
    v_mfma_f32_16x16x32_bf16 a[12:15], v[56:59], a[232:235], a[12:15]
    ds_read_b64_tr_b16 v[56:57], v9 offset:456
    v_cvt_pk_bf16_f32 v132, v132, v133
    v_mfma_f32_16x16x32_bf16 a[12:15], v[60:63], a[248:251], a[12:15]
    s_waitcnt lgkmcnt(10)
    ds_read_b64_tr_b16 v[58:59], v9 offset:1480
    v_cvt_pk_bf16_f32 v133, v134, v135
    v_mfma_f32_16x16x32_bf16 v[224:227], v[32:35], a[236:239], v[224:227]
    ds_read_b64_tr_b16 v[60:61], v9 offset:2504
    v_cvt_pk_bf16_f32 v164, v164, v165
    v_mfma_f32_16x16x32_bf16 v[224:227], v[36:39], a[252:255], v[224:227]
    ds_read_b64_tr_b16 v[62:63], v9 offset:3528
    v_cvt_pk_bf16_f32 v165, v166, v167
    v_mfma_f32_16x16x32_bf16 v[140:143], v[32:35], a[224:227], v[140:143]
    v_cvt_pk_bf16_f32 v196, v196, v197
    v_cvt_pk_bf16_f32 v197, v198, v199
    v_mfma_f32_16x16x32_bf16 v[140:143], v[36:39], a[240:243], v[140:143]
    v_accvgpr_read_b32 v236, a0
    v_accvgpr_read_b32 v237, a1
    v_mfma_f32_16x16x32_bf16 v[172:175], v[32:35], a[228:231], v[172:175]
    buffer_load_dwordx4 v26, s[12:15], s69 offen offset:1024 nt lds
    v_mfma_f32_16x16x32_bf16 v[172:175], v[36:39], a[244:247], v[172:175]
    s_add_u32 s69, s81, 24576
    v_accvgpr_read_b32 v238, a2
    v_accvgpr_read_b32 v239, a3
    v_mfma_f32_16x16x32_bf16 v[204:207], v[32:35], a[232:235], v[204:207]
    s_add_u32 m0, s71, 41600
    ds_read_b64_tr_b16 v[32:33], v9 offset:0
    v_cvt_pk_bf16_f32 v222, v236, v237
    v_mfma_f32_16x16x32_bf16 v[204:207], v[36:39], a[248:251], v[204:207]
    s_waitcnt lgkmcnt(10)
    ds_read_b64_tr_b16 v[34:35], v9 offset:1024
    v_cvt_pk_bf16_f32 v223, v238, v239
    v_mfma_f32_16x16x32_bf16 a[16:19], v[40:43], a[236:239], a[16:19]
    ds_write_b128 v7, v[220:223] offset:1024
    v_mfma_f32_16x16x32_bf16 a[16:19], v[44:47], a[252:255], a[16:19]
    ds_read_b64_tr_b16 v[36:37], v9 offset:2048
    v_accvgpr_read_b32 v236, a4
    v_mfma_f32_16x16x32_bf16 a[20:23], v[40:43], a[224:227], a[20:23]
    ds_read_b64_tr_b16 v[38:39], v9 offset:3072
    v_accvgpr_read_b32 v237, a5
    v_mfma_f32_16x16x32_bf16 a[20:23], v[44:47], a[240:243], a[20:23]
    v_accvgpr_read_b32 v238, a6
    v_accvgpr_read_b32 v239, a7
    v_mfma_f32_16x16x32_bf16 v[16:19], v[40:43], a[228:231], v[16:19]
    v_cvt_pk_bf16_f32 v134, v236, v237
    v_cvt_pk_bf16_f32 v135, v238, v239
    v_mfma_f32_16x16x32_bf16 v[16:19], v[44:47], a[244:247], v[16:19]
    v_accvgpr_read_b32 v236, a8
    v_accvgpr_read_b32 v237, a9
    v_mfma_f32_16x16x32_bf16 v[20:23], v[40:43], a[232:235], v[20:23]
    ds_read_b64_tr_b16 v[40:41], v9 offset:8
    v_accvgpr_read_b32 v238, a10
    v_mfma_f32_16x16x32_bf16 v[20:23], v[44:47], a[248:251], v[20:23]
    s_waitcnt lgkmcnt(10)
    ds_read_b64_tr_b16 v[42:43], v9 offset:1032
    v_accvgpr_read_b32 v239, a11
    v_mfma_f32_16x16x32_bf16 v[228:231], v[48:51], a[236:239], v[228:231]
    ds_read_b64_tr_b16 v[44:45], v9 offset:2056
    v_cvt_pk_bf16_f32 v166, v236, v237
    v_mfma_f32_16x16x32_bf16 v[228:231], v[52:55], a[252:255], v[228:231]
    ds_read_b64_tr_b16 v[46:47], v9 offset:3080
    v_cvt_pk_bf16_f32 v167, v238, v239
    v_mfma_f32_16x16x32_bf16 v[148:151], v[48:51], a[224:227], v[148:151]
    v_accvgpr_read_b32 v236, a12
    v_accvgpr_read_b32 v237, a13
    v_mfma_f32_16x16x32_bf16 v[148:151], v[52:55], a[240:243], v[148:151]
    v_accvgpr_read_b32 v238, a14
    v_accvgpr_read_b32 v239, a15
    v_mfma_f32_16x16x32_bf16 v[180:183], v[48:51], a[228:231], v[180:183]
    v_cvt_pk_bf16_f32 v198, v236, v237
    v_cvt_pk_bf16_f32 v199, v238, v239
    v_mfma_f32_16x16x32_bf16 v[180:183], v[52:55], a[244:247], v[180:183]
    buffer_load_dwordx4 v26, s[12:15], s69 offen nt lds
    v_mfma_f32_16x16x32_bf16 v[212:215], v[48:51], a[232:235], v[212:215]
    ds_read_b64_tr_b16 v[48:49], v9 offset:128
    v_cvt_pk_bf16_f32 v224, v224, v225
    v_mfma_f32_16x16x32_bf16 v[212:215], v[52:55], a[248:251], v[212:215]
    s_waitcnt lgkmcnt(10)
    ds_read_b64_tr_b16 v[50:51], v9 offset:1152
    v_cvt_pk_bf16_f32 v225, v226, v227
    v_mfma_f32_16x16x32_bf16 v[232:235], v[56:59], a[236:239], v[232:235]
    ds_read_b64_tr_b16 v[52:53], v9 offset:2176
    v_cvt_pk_bf16_f32 v140, v140, v141
    v_mfma_f32_16x16x32_bf16 v[232:235], v[60:63], a[252:255], v[232:235]
    ds_read_b64_tr_b16 v[54:55], v9 offset:3200
    v_cvt_pk_bf16_f32 v141, v142, v143
    v_mfma_f32_16x16x32_bf16 v[28:31], v[56:59], a[224:227], v[28:31]
    v_cvt_pk_bf16_f32 v172, v172, v173
    v_cvt_pk_bf16_f32 v173, v174, v175
    v_mfma_f32_16x16x32_bf16 v[28:31], v[60:63], a[240:243], v[28:31]
    v_cvt_pk_bf16_f32 v204, v204, v205
    v_cvt_pk_bf16_f32 v205, v206, v207
    v_mfma_f32_16x16x32_bf16 v[244:247], v[56:59], a[228:231], v[244:247]
    buffer_load_dwordx4 v26, s[12:15], s69 offen offset:1024 nt lds
    v_mfma_f32_16x16x32_bf16 v[244:247], v[60:63], a[244:247], v[244:247]
    s_mov_b64 s[12:13], s[58:59]
    v_accvgpr_read_b32 v236, a16
    v_accvgpr_read_b32 v237, a17
    v_mfma_f32_16x16x32_bf16 v[248:251], v[56:59], a[232:235], v[248:251]
    s_add_u32 s69, s81, 49152
    ds_read_b64_tr_b16 v[56:57], v9 offset:136
    v_accvgpr_read_b32 v238, a18
    v_mfma_f32_16x16x32_bf16 v[248:251], v[60:63], a[248:251], v[248:251]
    s_waitcnt lgkmcnt(9)
    ds_read_b64_tr_b16 v[58:59], v9 offset:1160
    v_accvgpr_read_b32 v239, a19
    v_mfma_f32_16x16x32_bf16 v[120:123], v[32:35], a[224:227], v[120:123]
    s_add_u32 m0, s71, 49920
    ds_read_b64_tr_b16 v[60:61], v9 offset:2184
    v_cvt_pk_bf16_f32 v226, v236, v237
    v_mfma_f32_16x16x32_bf16 v[120:123], v[36:39], a[240:243], v[120:123]
    ds_read_b64_tr_b16 v[62:63], v9 offset:3208
    v_cvt_pk_bf16_f32 v227, v238, v239
    v_mfma_f32_16x16x32_bf16 v[152:155], v[32:35], a[228:231], v[152:155]
    ds_write_b128 v7, v[224:227] offset:2048
    v_mfma_f32_16x16x32_bf16 v[152:155], v[36:39], a[244:247], v[152:155]
    v_accvgpr_read_b32 v236, a20
    v_accvgpr_read_b32 v237, a21
    v_mfma_f32_16x16x32_bf16 v[184:187], v[32:35], a[232:235], v[184:187]
    ds_read_b64_tr_b16 v[32:33], v9 offset:256
    v_accvgpr_read_b32 v238, a22
    v_mfma_f32_16x16x32_bf16 v[184:187], v[36:39], a[248:251], v[184:187]
    s_waitcnt lgkmcnt(10)
    ds_read_b64_tr_b16 v[34:35], v9 offset:1280
    v_accvgpr_read_b32 v239, a23
    v_mfma_f32_16x16x32_bf16 v[252:255], v[40:43], a[224:227], v[252:255]
    ds_read_b64_tr_b16 v[36:37], v9 offset:2304
    v_cvt_pk_bf16_f32 v142, v236, v237
    v_mfma_f32_16x16x32_bf16 v[252:255], v[44:47], a[240:243], v[252:255]
    ds_read_b64_tr_b16 v[38:39], v9 offset:3328
    v_cvt_pk_bf16_f32 v143, v238, v239
    v_mfma_f32_16x16x32_bf16 v[64:67], v[40:43], a[228:231], v[64:67]
    v_cvt_pk_bf16_f32 v174, v16, v17
    v_cvt_pk_bf16_f32 v175, v18, v19
    v_mfma_f32_16x16x32_bf16 v[64:67], v[44:47], a[244:247], v[64:67]
    v_cvt_pk_bf16_f32 v206, v20, v21
    v_cvt_pk_bf16_f32 v207, v22, v23
    v_mfma_f32_16x16x32_bf16 v[68:71], v[40:43], a[232:235], v[68:71]
    ds_read_b64_tr_b16 v[40:41], v9 offset:264
    v_cvt_pk_bf16_f32 v228, v228, v229
    v_mfma_f32_16x16x32_bf16 v[68:71], v[44:47], a[248:251], v[68:71]
    s_waitcnt lgkmcnt(10)
    ds_read_b64_tr_b16 v[42:43], v9 offset:1288
    v_cvt_pk_bf16_f32 v229, v230, v231
    v_mfma_f32_16x16x32_bf16 v[128:131], v[48:51], a[224:227], v[128:131]
    ds_read_b64_tr_b16 v[44:45], v9 offset:2312
    v_cvt_pk_bf16_f32 v148, v148, v149
    v_mfma_f32_16x16x32_bf16 v[128:131], v[52:55], a[240:243], v[128:131]
    ds_read_b64_tr_b16 v[46:47], v9 offset:3336
    v_cvt_pk_bf16_f32 v149, v150, v151
    v_mfma_f32_16x16x32_bf16 v[160:163], v[48:51], a[228:231], v[160:163]
    v_cvt_pk_bf16_f32 v180, v180, v181
    v_cvt_pk_bf16_f32 v181, v182, v183
    v_mfma_f32_16x16x32_bf16 v[160:163], v[52:55], a[244:247], v[160:163]
    v_cvt_pk_bf16_f32 v212, v212, v213
    v_cvt_pk_bf16_f32 v213, v214, v215
    v_mfma_f32_16x16x32_bf16 v[192:195], v[48:51], a[232:235], v[192:195]
    buffer_load_dwordx4 v26, s[12:15], s69 offen nt lds
    v_mfma_f32_16x16x32_bf16 v[192:195], v[52:55], a[248:251], v[192:195]
    s_waitcnt lgkmcnt(9)
    ds_read_b64_tr_b16 v[48:49], v9 offset:384
    v_cvt_pk_bf16_f32 v230, v232, v233
    v_mfma_f32_16x16x32_bf16 v[72:75], v[56:59], a[224:227], v[72:75]
    ds_read_b64_tr_b16 v[50:51], v9 offset:1408
    v_cvt_pk_bf16_f32 v231, v234, v235
    v_mfma_f32_16x16x32_bf16 v[72:75], v[60:63], a[240:243], v[72:75]
    ds_write_b128 v7, v[228:231] offset:3072
    v_mfma_f32_16x16x32_bf16 v[76:79], v[56:59], a[228:231], v[76:79]
    ds_read_b64_tr_b16 v[52:53], v9 offset:2432
    v_cvt_pk_bf16_f32 v150, v28, v29
    v_mfma_f32_16x16x32_bf16 v[76:79], v[60:63], a[244:247], v[76:79]
    ds_read_b64_tr_b16 v[54:55], v9 offset:3456
    v_cvt_pk_bf16_f32 v151, v30, v31
    v_mfma_f32_16x16x32_bf16 v[80:83], v[56:59], a[232:235], v[80:83]
    ds_read_b64_tr_b16 v[56:57], v9 offset:392
    v_cvt_pk_bf16_f32 v182, v244, v245
    v_mfma_f32_16x16x32_bf16 v[80:83], v[60:63], a[248:251], v[80:83]
    s_waitcnt lgkmcnt(10)
    ds_read_b64_tr_b16 v[58:59], v9 offset:1416
    v_cvt_pk_bf16_f32 v183, v246, v247
    v_mfma_f32_16x16x32_bf16 v[136:139], v[32:35], a[224:227], v[136:139]
    ds_read_b64_tr_b16 v[60:61], v9 offset:2440
    v_cvt_pk_bf16_f32 v214, v248, v249
    v_mfma_f32_16x16x32_bf16 v[136:139], v[36:39], a[240:243], v[136:139]
    ds_read_b64_tr_b16 v[62:63], v9 offset:3464
    v_cvt_pk_bf16_f32 v215, v250, v251
    v_mfma_f32_16x16x32_bf16 v[168:171], v[32:35], a[228:231], v[168:171]
    buffer_load_dwordx4 v26, s[12:15], s69 offen offset:1024 nt lds
    v_mfma_f32_16x16x32_bf16 v[168:171], v[36:39], a[244:247], v[168:171]
    s_add_u32 s69, s81, 57344
    v_cvt_pk_bf16_f32 v120, v120, v121
    v_cvt_pk_bf16_f32 v121, v122, v123
    v_mfma_f32_16x16x32_bf16 v[200:203], v[32:35], a[232:235], v[200:203]
    s_add_u32 m0, s71, 58240
    ds_read_b128 v[32:35], v1 offset:33344
    v_cvt_pk_bf16_f32 v152, v152, v153
    v_mfma_f32_16x16x32_bf16 v[200:203], v[36:39], a[248:251], v[200:203]
    s_waitcnt lgkmcnt(10)
    ds_read_b128 v[36:39], v1 offset:33472
    v_cvt_pk_bf16_f32 v153, v154, v155
    v_mfma_f32_16x16x32_bf16 v[84:87], v[40:43], a[224:227], v[84:87]
    v_cvt_pk_bf16_f32 v184, v184, v185
    v_cvt_pk_bf16_f32 v185, v186, v187
    v_mfma_f32_16x16x32_bf16 v[84:87], v[44:47], a[240:243], v[84:87]
    v_cvt_pk_bf16_f32 v122, v252, v253
    v_cvt_pk_bf16_f32 v123, v254, v255
    v_mfma_f32_16x16x32_bf16 v[88:91], v[40:43], a[228:231], v[88:91]
    v_cvt_pk_bf16_f32 v154, v64, v65
    v_cvt_pk_bf16_f32 v155, v66, v67
    v_mfma_f32_16x16x32_bf16 v[88:91], v[44:47], a[244:247], v[88:91]
    v_cvt_pk_bf16_f32 v186, v68, v69
    v_cvt_pk_bf16_f32 v187, v70, v71
    v_mfma_f32_16x16x32_bf16 v[92:95], v[40:43], a[232:235], v[92:95]
    buffer_load_dwordx4 v26, s[12:15], s69 offen nt lds
    v_mfma_f32_16x16x32_bf16 v[92:95], v[44:47], a[248:251], v[92:95]
    s_waitcnt lgkmcnt(6)
    ds_read_b128 v[40:43], v1 offset:33600
    v_cvt_pk_bf16_f32 v128, v128, v129
    v_mfma_f32_16x16x32_bf16 v[144:147], v[48:51], a[224:227], v[144:147]
    ds_read_b128 v[44:47], v1 offset:33728
    v_cvt_pk_bf16_f32 v129, v130, v131
    v_mfma_f32_16x16x32_bf16 v[144:147], v[52:55], a[240:243], v[144:147]
    v_cvt_pk_bf16_f32 v160, v160, v161
    v_cvt_pk_bf16_f32 v161, v162, v163
    v_mfma_f32_16x16x32_bf16 v[176:179], v[48:51], a[228:231], v[176:179]
    v_cvt_pk_bf16_f32 v192, v192, v193
    v_cvt_pk_bf16_f32 v193, v194, v195
    v_mfma_f32_16x16x32_bf16 v[176:179], v[52:55], a[244:247], v[176:179]
    buffer_load_dwordx4 v26, s[12:15], s69 offen offset:1024 nt lds
    v_mfma_f32_16x16x32_bf16 v[208:211], v[48:51], a[232:235], v[208:211]
    v_cvt_pk_bf16_f32 v130, v72, v73
    v_cvt_pk_bf16_f32 v131, v74, v75
    v_mfma_f32_16x16x32_bf16 v[208:211], v[52:55], a[248:251], v[208:211]
    s_waitcnt lgkmcnt(4)
    v_cvt_pk_bf16_f32 v162, v76, v77
    v_cvt_pk_bf16_f32 v163, v78, v79
    v_mfma_f32_16x16x32_bf16 v[108:111], v[56:59], a[224:227], v[108:111]
    v_cvt_pk_bf16_f32 v194, v80, v81
    v_cvt_pk_bf16_f32 v195, v82, v83
    v_mfma_f32_16x16x32_bf16 v[108:111], v[60:63], a[240:243], v[108:111]
    v_cvt_pk_bf16_f32 v136, v136, v137
    v_cvt_pk_bf16_f32 v137, v138, v139
    v_mfma_f32_16x16x32_bf16 v[112:115], v[56:59], a[228:231], v[112:115]
    v_cvt_pk_bf16_f32 v168, v168, v169
    v_cvt_pk_bf16_f32 v169, v170, v171
    v_mfma_f32_16x16x32_bf16 v[112:115], v[60:63], a[244:247], v[112:115]
    v_cvt_pk_bf16_f32 v200, v200, v201
    v_cvt_pk_bf16_f32 v201, v202, v203
    v_mfma_f32_16x16x32_bf16 v[116:119], v[56:59], a[232:235], v[116:119]
    v_cvt_pk_bf16_f32 v138, v84, v85
    v_cvt_pk_bf16_f32 v139, v86, v87
    v_mfma_f32_16x16x32_bf16 v[116:119], v[60:63], a[248:251], v[116:119]
    s_waitcnt lgkmcnt(3)
    v_cvt_pk_bf16_f32 v170, v88, v89
    v_cvt_pk_bf16_f32 v171, v90, v91
    v_mfma_f32_16x16x32_bf16 v[96:99], v[32:35], v[124:127], 0
    s_waitcnt lgkmcnt(2)
    v_cvt_pk_bf16_f32 v202, v92, v93
    v_cvt_pk_bf16_f32 v203, v94, v95
    v_mfma_f32_16x16x32_bf16 v[96:99], v[36:39], v[132:135], v[96:99]
    s_barrier
    v_mfma_f32_16x16x32_bf16 v[100:103], v[32:35], v[156:159], 0
    s_mov_b64 s[12:13], s[60:61]
    ds_read_b128 a[224:227], v8 offset:0
    v_cvt_pk_bf16_f32 v144, v144, v145
    v_mfma_f32_16x16x32_bf16 v[100:103], v[36:39], v[164:167], v[100:103]
    s_add_u32 s69, s81, 32768
    ds_read_b128 a[228:231], v8 offset:1024
    v_cvt_pk_bf16_f32 v145, v146, v147
    v_mfma_f32_16x16x32_bf16 v[104:107], v[32:35], v[188:191], 0
    s_add_u32 m0, s71, 66560
    ds_read_b128 v[48:51], v1 offset:33280
    v_cvt_pk_bf16_f32 v176, v176, v177
    v_mfma_f32_16x16x32_bf16 v[104:107], v[36:39], v[196:199], v[104:107]
    ds_read_b128 v[52:55], v1 offset:33408
    v_cvt_pk_bf16_f32 v177, v178, v179
    v_mfma_f32_16x16x32_bf16 v[240:243], v[32:35], v[216:219], 0
    ds_read_b128 a[232:235], v8 offset:2048
    v_cvt_pk_bf16_f32 v208, v208, v209
    v_mfma_f32_16x16x32_bf16 v[240:243], v[36:39], v[220:223], v[240:243]
    s_waitcnt lgkmcnt(5)
    ds_read_b128 a[236:239], v8 offset:3072
    v_cvt_pk_bf16_f32 v209, v210, v211
    v_mfma_f32_16x16x32_bf16 v[96:99], v[40:43], v[140:143], v[96:99]
    ds_read_b128 v[56:59], v1 offset:33536
    v_cvt_pk_bf16_f32 v146, v108, v109
    v_mfma_f32_16x16x32_bf16 v[96:99], v[44:47], v[148:151], v[96:99]
    ds_read_b128 v[60:63], v1 offset:33664
    v_cvt_pk_bf16_f32 v147, v110, v111
    v_mfma_f32_16x16x32_bf16 v[100:103], v[40:43], v[172:175], v[100:103]
    ds_read_b128 v[32:35], v1 offset:34368
    v_cvt_pk_bf16_f32 v178, v112, v113
    v_mfma_f32_16x16x32_bf16 v[100:103], v[44:47], v[180:183], v[100:103]
    ds_read_b128 v[36:39], v1 offset:34496
    v_cvt_pk_bf16_f32 v179, v114, v115
    v_mfma_f32_16x16x32_bf16 v[104:107], v[40:43], v[204:207], v[104:107]
    v_cvt_pk_bf16_f32 v210, v116, v117
    v_cvt_pk_bf16_f32 v211, v118, v119
    v_mfma_f32_16x16x32_bf16 v[104:107], v[44:47], v[212:215], v[104:107]
    v_add_u32 v7, s86, v26
    v_xor_b32 v8, 1024, v7
    v_mfma_f32_16x16x32_bf16 v[240:243], v[40:43], v[224:227], v[240:243]
    ds_read_b128 v[40:43], v1 offset:34624
    v_accvgpr_write_b32 a0, 0
    v_mfma_f32_16x16x32_bf16 v[240:243], v[44:47], v[228:231], v[240:243]
    s_waitcnt lgkmcnt(7)
    ds_read_b128 v[44:47], v1 offset:34752
    v_accvgpr_write_b32 a1, 0
    v_mfma_f32_16x16x32_bf16 v[96:99], v[48:51], v[120:123], v[96:99]
    buffer_load_dwordx4 v26, s[12:15], s69 offen nt lds
    v_mfma_f32_16x16x32_bf16 v[96:99], v[52:55], v[128:131], v[96:99]
    v_accvgpr_write_b32 a2, 0
    v_accvgpr_write_b32 a3, 0
    v_mfma_f32_16x16x32_bf16 v[100:103], v[48:51], v[152:155], v[100:103]
    v_accvgpr_write_b32 a4, 0
    v_accvgpr_write_b32 a5, 0
    v_mfma_f32_16x16x32_bf16 v[100:103], v[52:55], v[160:163], v[100:103]
    v_accvgpr_write_b32 a6, 0
    v_accvgpr_write_b32 a7, 0
    v_mfma_f32_16x16x32_bf16 v[104:107], v[48:51], v[184:187], v[104:107]
    v_accvgpr_write_b32 a8, 0
    v_accvgpr_write_b32 a9, 0
    v_mfma_f32_16x16x32_bf16 v[104:107], v[52:55], v[192:195], v[104:107]
    v_accvgpr_write_b32 a10, 0
    v_accvgpr_write_b32 a11, 0
    v_mfma_f32_16x16x32_bf16 v[240:243], v[48:51], a[224:227], v[240:243]
    ds_read_b128 v[48:51], v1 offset:34304
    v_accvgpr_write_b32 a12, 0
    v_mfma_f32_16x16x32_bf16 v[240:243], v[52:55], a[228:231], v[240:243]
    s_waitcnt lgkmcnt(5)
    ds_read_b128 v[52:55], v1 offset:34432
    v_accvgpr_write_b32 a13, 0
    v_mfma_f32_16x16x32_bf16 v[96:99], v[56:59], v[136:139], v[96:99]
    v_accvgpr_write_b32 a14, 0
    v_accvgpr_write_b32 a15, 0
    v_mfma_f32_16x16x32_bf16 v[96:99], v[60:63], v[144:147], v[96:99]
    v_accvgpr_write_b32 a16, 0
    v_accvgpr_write_b32 a17, 0
    v_mfma_f32_16x16x32_bf16 v[100:103], v[56:59], v[168:171], v[100:103]
    buffer_load_dwordx4 v26, s[12:15], s69 offen offset:1024 nt lds
    v_mfma_f32_16x16x32_bf16 v[100:103], v[60:63], v[176:179], v[100:103]
    s_add_u32 s69, s81, 40960
    v_accvgpr_write_b32 a18, 0
    v_accvgpr_write_b32 a19, 0
    v_mfma_f32_16x16x32_bf16 v[104:107], v[56:59], v[200:203], v[104:107]
    s_add_u32 m0, s71, 74880
    v_max3_f32 v16, v96, v97, v98
    v_accvgpr_write_b32 a20, 0
    v_mfma_f32_16x16x32_bf16 v[104:107], v[60:63], v[208:211], v[104:107]
    v_max3_f32 v17, v100, v101, v102
    v_accvgpr_write_b32 a21, 0
    v_mfma_f32_16x16x32_bf16 v[240:243], v[56:59], a[232:235], v[240:243]
    ds_read_b128 v[56:59], v1 offset:34560
    v_accvgpr_write_b32 a22, 0
    v_mfma_f32_16x16x32_bf16 v[240:243], v[60:63], a[236:239], v[240:243]
    s_waitcnt lgkmcnt(5)
    ds_read_b128 v[60:63], v1 offset:34688
    v_accvgpr_write_b32 a23, 0
    v_mfma_f32_16x16x32_bf16 v[64:67], v[32:35], v[124:127], 0
    v_max3_f32 v18, v104, v105, v106
    v_mfma_f32_16x16x32_bf16 v[64:67], v[36:39], v[132:135], v[64:67]
    v_mfma_f32_16x16x32_bf16 v[68:71], v[32:35], v[156:159], 0
    v_mfma_f32_16x16x32_bf16 v[68:71], v[36:39], v[164:167], v[68:71]
    v_mfma_f32_16x16x32_bf16 v[72:75], v[32:35], v[188:191], 0
    v_max3_f32 v19, v240, v241, v242
    v_max_f32 v16, v16, v99
    v_mfma_f32_16x16x32_bf16 v[72:75], v[36:39], v[196:199], v[72:75]
    v_max_f32 v17, v17, v103
    v_max_f32 v18, v18, v107
    v_mfma_f32_16x16x32_bf16 v[76:79], v[32:35], v[216:219], 0
    ds_read_b128 v[32:35], v1 offset:50944
    v_max_f32_e64 v19, v19, v243
    v_mfma_f32_16x16x32_bf16 v[76:79], v[36:39], v[220:223], v[76:79]
    s_waitcnt lgkmcnt(5)
    ds_read_b128 v[36:39], v1 offset:51008
    v_mov_b32 v20, v16
    v_mfma_f32_16x16x32_bf16 v[64:67], v[40:43], v[140:143], v[64:67]
    v_mov_b32 v21, v17
    v_mov_b32 v22, v18
    v_mfma_f32_16x16x32_bf16 v[64:67], v[44:47], v[148:151], v[64:67]
    v_mov_b32 v23, v19
    v_permlane16_swap_b32 v16, v20
    v_mfma_f32_16x16x32_bf16 v[68:71], v[40:43], v[172:175], v[68:71]
    v_permlane16_swap_b32 v17, v21
    v_permlane16_swap_b32 v18, v22
    v_mfma_f32_16x16x32_bf16 v[68:71], v[44:47], v[180:183], v[68:71]
    v_permlane16_swap_b32 v19, v23
    v_max_f32 v16, v16, v20
    v_mfma_f32_16x16x32_bf16 v[72:75], v[40:43], v[204:207], v[72:75]
    v_max_f32 v17, v17, v21
    v_max_f32 v18, v18, v22
    v_mfma_f32_16x16x32_bf16 v[72:75], v[44:47], v[212:215], v[72:75]
    v_max_f32 v19, v19, v23
    v_mov_b32 v20, v16
    v_mfma_f32_16x16x32_bf16 v[76:79], v[40:43], v[224:227], v[76:79]
    ds_read_b128 v[40:43], v1 offset:51072
    v_mov_b32 v21, v17
    v_mfma_f32_16x16x32_bf16 v[76:79], v[44:47], v[228:231], v[76:79]
    s_waitcnt lgkmcnt(5)
    ds_read_b128 v[44:47], v1 offset:51136
    v_mov_b32 v22, v18
    v_mfma_f32_16x16x32_bf16 v[64:67], v[48:51], v[120:123], v[64:67]
    v_mov_b32 v23, v19
    v_permlane32_swap_b32 v16, v20
    v_mfma_f32_16x16x32_bf16 v[64:67], v[52:55], v[128:131], v[64:67]
    v_permlane32_swap_b32 v17, v21
    v_permlane32_swap_b32 v18, v22
    v_mfma_f32_16x16x32_bf16 v[68:71], v[48:51], v[152:155], v[68:71]
    v_permlane32_swap_b32 v19, v23
    v_max_f32 v16, v16, v20
    v_mfma_f32_16x16x32_bf16 v[68:71], v[52:55], v[160:163], v[68:71]
    v_max_f32 v17, v17, v21
    v_max_f32 v18, v18, v22
    v_mfma_f32_16x16x32_bf16 v[72:75], v[48:51], v[184:187], v[72:75]
    v_max_f32 v19, v19, v23
    v_mul_f32 v16, -v16, s84
    v_mfma_f32_16x16x32_bf16 v[72:75], v[52:55], v[192:195], v[72:75]
    v_mul_f32 v17, -v17, s84
    v_mul_f32 v18, -v18, s84
    v_mfma_f32_16x16x32_bf16 v[76:79], v[48:51], a[224:227], v[76:79]
    ds_read_b128 v[48:51], v1 offset:51200
    v_mul_f32 v19, -v19, s84
    v_mfma_f32_16x16x32_bf16 v[76:79], v[52:55], a[228:231], v[76:79]
    s_waitcnt lgkmcnt(5)
    ds_read_b128 v[52:55], v1 offset:51264
    s_cmp_lg_u32 s90, 0
    s_cbranch_scc1 L_max1
    L_maxok1:
    v_mfma_f32_16x16x32_bf16 v[64:67], v[56:59], v[136:139], v[64:67]
    buffer_load_dwordx4 v26, s[12:15], s69 offen nt lds
    v_mfma_f32_16x16x32_bf16 v[64:67], v[60:63], v[144:147], v[64:67]
    buffer_load_dwordx4 v26, s[12:15], s69 offen offset:1024 nt lds
    v_mfma_f32_16x16x32_bf16 v[68:71], v[56:59], v[168:171], v[68:71]
    s_mov_b64 s[12:13], s[58:59]
    v_fma_f32 v96, v96, s84, v16
    v_fma_f32 v97, v97, s84, v16
    v_mfma_f32_16x16x32_bf16 v[68:71], v[60:63], v[176:179], v[68:71]
    s_add_u32 s69, s81, 65536
    v_fma_f32 v98, v98, s84, v16
    v_fma_f32 v99, v99, s84, v16
    v_mfma_f32_16x16x32_bf16 v[72:75], v[56:59], v[200:203], v[72:75]
    s_add_u32 m0, s71, 83200
    v_exp_f32_e64 v96, v96
    v_mfma_f32_16x16x32_bf16 v[72:75], v[60:63], v[208:211], v[72:75]
    buffer_load_dwordx4 v26, s[12:15], s69 offen nt lds
    v_mfma_f32_16x16x32_bf16 v[76:79], v[56:59], a[232:235], v[76:79]
    ds_read_b128 v[56:59], v1 offset:51328
    v_exp_f32_e64 v97, v97
    v_mfma_f32_16x16x32_bf16 v[76:79], v[60:63], a[236:239], v[76:79]
    s_waitcnt lgkmcnt(5)
    ds_read_b128 v[60:63], v1 offset:51392
    v_exp_f32 v98, v98
    v_mfma_f32_16x16x32_bf16 v[92:95], v[32:35], a[224:227], 0
    v_exp_f32 v99, v99
    v_add_f32 v12, v12, v96
    v_mfma_f32_16x16x32_bf16 v[92:95], v[36:39], v[216:219], v[92:95]
    v_add_f32 v12, v12, v97
    v_add_f32 v12, v12, v98
    v_fma_f32 v76, v76, s84, v19
    v_mfma_f32_16x16x32_bf16 v[80:83], v[32:35], v[120:123], 0
    v_fma_f32 v77, v77, s84, v19
    v_fma_f32 v78, v78, s84, v19
    v_fma_f32 v79, v79, s84, v19
    v_mfma_f32_16x16x32_bf16 v[80:83], v[36:39], v[124:127], v[80:83]
    v_add_f32 v12, v12, v99
    v_exp_f32 v76, v76
    v_mfma_f32_16x16x32_bf16 v[84:87], v[32:35], v[152:155], 0
    v_exp_f32_e64 v77, v77
    v_fma_f32 v100, v100, s84, v17
    v_mfma_f32_16x16x32_bf16 v[84:87], v[36:39], v[156:159], v[84:87]
    v_exp_f32_e64 v78, v78
    v_fma_f32 v101, v101, s84, v17
    v_mfma_f32_16x16x32_bf16 v[88:91], v[32:35], v[184:187], 0
    ds_read_b128 v[32:35], v1 offset:49920
    v_exp_f32 v79, v79
    v_mfma_f32_16x16x32_bf16 v[88:91], v[36:39], v[188:191], v[88:91]
    s_waitcnt lgkmcnt(5)
    ds_read_b128 v[36:39], v1 offset:49984
    v_fma_f32 v102, v102, s84, v17
    v_fma_f32 v103, v103, s84, v17
    v_mfma_f32_16x16x32_bf16 v[92:95], v[40:43], a[228:231], v[92:95]
    buffer_load_dwordx4 v26, s[12:15], s69 offen offset:1024 nt lds
    v_mfma_f32_16x16x32_bf16 v[92:95], v[44:47], v[220:223], v[92:95]
    s_add_u32 s69, s81, 73728
    v_add_f32 v15, v15, v76
    v_add_f32 v15, v15, v77
    v_cvt_pk_bf16_f32 v76, v76, v77
    v_mfma_f32_16x16x32_bf16 v[80:83], v[40:43], v[128:131], v[80:83]
    s_add_u32 m0, s71, 91520
    v_add_f32 v15, v15, v78
    v_add_f32 v15, v15, v79
    v_cvt_pk_bf16_f32 v77, v78, v79
    v_mfma_f32_16x16x32_bf16 v[80:83], v[44:47], v[132:135], v[80:83]
    ds_write_b64 v7, v[76:77] offset:8192
    v_mfma_f32_16x16x32_bf16 v[84:87], v[40:43], v[160:163], v[84:87]
    v_exp_f32 v100, v100
    v_fma_f32 v104, v104, s84, v18
    v_mfma_f32_16x16x32_bf16 v[84:87], v[44:47], v[164:167], v[84:87]
    v_exp_f32 v101, v101
    v_fma_f32 v105, v105, s84, v18
    v_mfma_f32_16x16x32_bf16 v[88:91], v[40:43], v[192:195], v[88:91]
    ds_read_b128 v[40:43], v1 offset:50048
    v_exp_f32 v102, v102
    v_mfma_f32_16x16x32_bf16 v[88:91], v[44:47], v[196:199], v[88:91]
    s_waitcnt lgkmcnt(6)
    ds_read_b128 v[44:47], v1 offset:50112
    v_exp_f32_e64 v103, v103
    v_mfma_f32_16x16x32_bf16 v[92:95], v[48:51], a[232:235], v[92:95]
    v_fma_f32 v106, v106, s84, v18
    v_fma_f32 v107, v107, s84, v18
    v_add_f32 v13, v13, v100
    v_mfma_f32_16x16x32_bf16 v[92:95], v[52:55], v[224:227], v[92:95]
    v_add_f32 v13, v13, v101
    v_add_f32 v13, v13, v102
    v_add_f32 v13, v13, v103
    v_mfma_f32_16x16x32_bf16 v[80:83], v[48:51], v[136:139], v[80:83]
    v_exp_f32 v104, v104
    v_fma_f32 v64, v64, s84, v16
    v_mfma_f32_16x16x32_bf16 v[80:83], v[52:55], v[140:143], v[80:83]
    v_exp_f32 v105, v105
    v_fma_f32 v65, v65, s84, v16
    v_mfma_f32_16x16x32_bf16 v[84:87], v[48:51], v[168:171], v[84:87]
    v_exp_f32_e64 v106, v106
    v_fma_f32 v66, v66, s84, v16
    v_mfma_f32_16x16x32_bf16 v[84:87], v[52:55], v[172:175], v[84:87]
    v_exp_f32_e64 v107, v107
    v_fma_f32 v67, v67, s84, v16
    v_mfma_f32_16x16x32_bf16 v[88:91], v[48:51], v[200:203], v[88:91]
    buffer_load_dwordx4 v26, s[12:15], s69 offen nt lds
    v_mfma_f32_16x16x32_bf16 v[88:91], v[52:55], v[204:207], v[88:91]
    s_waitcnt lgkmcnt(5)
    ds_read_b128 v[48:51], v1 offset:50176
    v_add_f32 v14, v14, v104
    v_add_f32 v14, v14, v105
    v_mfma_f32_16x16x32_bf16 v[92:95], v[56:59], a[236:239], v[92:95]
    ds_read_b128 v[52:55], v1 offset:50240
    v_add_f32 v14, v14, v106
    v_add_f32_e64 v14, v14, v107
    v_mfma_f32_16x16x32_bf16 v[92:95], v[60:63], v[228:231], v[92:95]
    v_exp_f32 v64, v64
    v_fma_f32 v68, v68, s84, v17
    v_mfma_f32_16x16x32_bf16 v[80:83], v[56:59], v[144:147], v[80:83]
    v_exp_f32 v65, v65
    v_fma_f32 v69, v69, s84, v17
    v_mfma_f32_16x16x32_bf16 v[80:83], v[60:63], v[148:151], v[80:83]
    v_exp_f32_e64 v66, v66
    v_fma_f32 v70, v70, s84, v17
    v_mfma_f32_16x16x32_bf16 v[84:87], v[56:59], v[176:179], v[84:87]
    v_exp_f32 v67, v67
    v_fma_f32 v71, v71, s84, v17
    v_mfma_f32_16x16x32_bf16 v[84:87], v[60:63], v[180:183], v[84:87]
    v_add_f32 v12, v12, v64
    v_add_f32 v12, v12, v65
    v_cvt_pk_bf16_f32 v64, v64, v65
    v_mfma_f32_16x16x32_bf16 v[88:91], v[56:59], v[208:211], v[88:91]
    ds_read_b128 v[56:59], v1 offset:50304
    v_add_f32 v12, v12, v66
    v_add_f32 v12, v12, v67
    v_mfma_f32_16x16x32_bf16 v[88:91], v[60:63], v[212:215], v[88:91]
    s_waitcnt lgkmcnt(7)
    ds_read_b128 v[60:63], v1 offset:50368
    v_cvt_pk_bf16_f32 v65, v66, v67
    v_cvt_pk_bf16_f32 v66, v96, v97
    v_mfma_f32_16x16x32_bf16 v[108:111], v[32:35], v[120:123], 0
    s_waitcnt vmcnt(57) lgkmcnt(6)
    v_cvt_pk_bf16_f32 v67, v98, v99
    v_exp_f32 v68, v68
    v_mfma_f32_16x16x32_bf16 v[108:111], v[36:39], v[124:127], v[108:111]
    s_barrier
    v_mfma_f32_16x16x32_bf16 v[112:115], v[32:35], v[152:155], 0
    v_exp_f32 v69, v69
    v_fma_f32 v72, v72, s84, v18
    v_mfma_f32_16x16x32_bf16 v[112:115], v[36:39], v[156:159], v[112:115]
    v_exp_f32_e64 v70, v70
    v_fma_f32 v73, v73, s84, v18
    v_mfma_f32_16x16x32_bf16 v[116:119], v[32:35], v[184:187], 0
    ds_read_b64_tr_b16 v[32:33], v2 offset:1024
    v_exp_f32 v71, v71
    v_mfma_f32_16x16x32_bf16 v[116:119], v[36:39], v[188:191], v[116:119]
    s_waitcnt lgkmcnt(5)
    ds_read_b64_tr_b16 v[34:35], v2 offset:0
    v_fma_f32 v74, v74, s84, v18
    v_fma_f32 v75, v75, s84, v18
    v_mfma_f32_16x16x32_bf16 v[108:111], v[40:43], v[128:131], v[108:111]
    buffer_load_dwordx4 v26, s[12:15], s69 offen offset:1024 nt lds
    v_mfma_f32_16x16x32_bf16 v[108:111], v[44:47], v[132:135], v[108:111]
    s_mov_b64 s[12:13], s[60:61]
    ds_read_b64_tr_b16 v[36:37], v2 offset:1056
    v_add_f32 v13, v13, v68
    v_add_f32_e64 v13, v13, v69
    v_mfma_f32_16x16x32_bf16 v[112:115], v[40:43], v[160:163], v[112:115]
    s_add_u32 s69, s81, 49152
    ds_read_b64_tr_b16 v[38:39], v2 offset:32
    v_cvt_pk_bf16_f32 v68, v68, v69
    v_add_f32 v13, v13, v70
    v_mfma_f32_16x16x32_bf16 v[112:115], v[44:47], v[164:167], v[112:115]
    s_add_u32 m0, s71, 99840
    ds_read_b64 v[78:79], v8 offset:8192
    v_add_f32 v13, v13, v71
    v_cvt_pk_bf16_f32 v69, v70, v71
    v_mfma_f32_16x16x32_bf16 v[116:119], v[40:43], v[192:195], v[116:119]
    ds_read_b64_tr_b16 v[40:41], v2 offset:1280
    v_cvt_pk_bf16_f32 v70, v100, v101
    v_cvt_pk_bf16_f32 v71, v102, v103
    v_mfma_f32_16x16x32_bf16 v[116:119], v[44:47], v[196:199], v[116:119]
    s_waitcnt lgkmcnt(8)
    ds_read_b64_tr_b16 v[42:43], v2 offset:256
    v_exp_f32 v72, v72
    v_mfma_f32_16x16x32_bf16 v[108:111], v[48:51], v[136:139], v[108:111]
    ds_read_b64_tr_b16 v[44:45], v2 offset:1312
    v_exp_f32_e64 v73, v73
    v_mfma_f32_16x16x32_bf16 v[108:111], v[52:55], v[140:143], v[108:111]
    ds_read_b64_tr_b16 v[46:47], v2 offset:288
    v_exp_f32 v74, v74
    v_mfma_f32_16x16x32_bf16 v[112:115], v[48:51], v[168:171], v[112:115]
    v_exp_f32 v75, v75
    v_add_f32_e64 v14, v14, v72
    v_mfma_f32_16x16x32_bf16 v[112:115], v[52:55], v[172:175], v[112:115]
    v_add_f32_e64 v14, v14, v73
    v_cvt_pk_bf16_f32 v72, v72, v73
    v_add_f32_e64 v14, v14, v74
    v_mfma_f32_16x16x32_bf16 v[116:119], v[48:51], v[200:203], v[116:119]
    v_add_f32_e64 v14, v14, v75
    v_cvt_pk_bf16_f32 v73, v74, v75
    v_cvt_pk_bf16_f32 v74, v104, v105
    v_mfma_f32_16x16x32_bf16 v[116:119], v[52:55], v[204:207], v[116:119]
    s_waitcnt lgkmcnt(9)
    v_cvt_pk_bf16_f32 v75, v106, v107
    v_subrev_u32 v1, s72, v1
    v_mfma_f32_16x16x32_bf16 v[108:111], v[56:59], v[144:147], v[108:111]
    buffer_load_dwordx4 v26, s[12:15], s69 offen nt lds
    v_mfma_f32_16x16x32_bf16 v[108:111], v[60:63], v[148:151], v[108:111]
    buffer_load_dwordx4 v26, s[12:15], s69 offen offset:1024 nt lds
    v_mfma_f32_16x16x32_bf16 v[112:115], v[56:59], v[176:179], v[112:115]
    v_or_b32 v4, s53, v11
    v_mfma_f32_16x16x32_bf16 v[112:115], v[60:63], v[180:183], v[112:115]
    v_mfma_f32_16x16x32_bf16 v[116:119], v[56:59], v[208:211], v[116:119]
    v_mfma_f32_16x16x32_bf16 v[116:119], v[60:63], v[212:215], v[116:119]
    buffer_atomic_add v5, v4, s[32:35], 0 offen
    s_nop 1
L_attn1:
    s_waitcnt lgkmcnt(5)
    v_mfma_f32_16x16x32_bf16 a[0:3], v[32:35], v[64:67], a[0:3]
    s_bitcmp1_b64 s[62:63], s70
    ds_read_b64_tr_b16 v[48:49], v2 offset:1088
    s_cselect_b64 s[12:13], s[58:59], s[60:61]
    v_mfma_f32_16x16x32_bf16 a[4:7], v[36:39], v[64:67], a[4:7]
    s_cselect_b32 s69, s67, s68
    ds_read_b64_tr_b16 v[50:51], v2 offset:64
    s_cselect_b32 s87, 8192, 0
    v_mfma_f32_16x16x32_bf16 a[64:67], v[32:35], v[68:71], a[64:67]
    s_add_u32 s67, s67, s87
    ds_read_b64_tr_b16 v[52:53], v2 offset:1120
    v_fma_f32 v92, v92, s84, v19
    v_mfma_f32_16x16x32_bf16 a[68:71], v[36:39], v[68:71], a[68:71]
    s_xor_b32 s87, s87, 8192
    ds_read_b64_tr_b16 v[54:55], v2 offset:96
    v_fma_f32 v93, v93, s84, v19
    v_mfma_f32_16x16x32_bf16 a[128:131], v[32:35], v[72:75], a[128:131]
    s_add_u32 s68, s68, s87
    ds_read_b64_tr_b16 v[56:57], v2 offset:1344
    v_fma_f32 v94, v94, s84, v19
    v_mfma_f32_16x16x32_bf16 a[132:135], v[36:39], v[72:75], a[132:135]
    s_waitcnt lgkmcnt(5)
    ds_read_b64_tr_b16 v[58:59], v2 offset:320
    v_fma_f32 v95, v95, s84, v19
    v_mfma_f32_16x16x32_bf16 a[32:35], v[40:43], v[64:67], a[32:35]
    s_and_b32 s87, s70, 15
    ds_read_b64_tr_b16 v[60:61], v2 offset:1376
    v_fma_f32 v80, v80, s84, v16
    v_mfma_f32_16x16x32_bf16 a[36:39], v[44:47], v[64:67], a[36:39]
    s_mul_i32 s87, s87, 8320
    ds_read_b64_tr_b16 v[62:63], v2 offset:352
    v_fma_f32 v81, v81, s84, v16
    v_mfma_f32_16x16x32_bf16 a[96:99], v[40:43], v[68:71], a[96:99]
    s_add_u32 m0, s87, s71
    v_exp_f32 v92, v92
    v_mfma_f32_16x16x32_bf16 a[100:103], v[44:47], v[68:71], a[100:103]
    s_add_u32 s70, s70, 1
    v_exp_f32 v93, v93
    v_mfma_f32_16x16x32_bf16 a[160:163], v[40:43], v[72:75], a[160:163]
    buffer_load_dwordx4 v26, s[12:15], s69 offen nt lds
    v_mfma_f32_16x16x32_bf16 a[164:167], v[44:47], v[72:75], a[164:167]
    v_exp_f32 v94, v94
    v_mfma_f32_16x16x32_bf16 a[192:195], v[40:43], v[76:79], a[192:195]
    v_exp_f32 v95, v95
    v_mfma_f32_16x16x32_bf16 a[196:199], v[44:47], v[76:79], a[196:199]
    s_waitcnt lgkmcnt(4)
    ds_read_b64_tr_b16 v[32:33], v2 offset:1152
    v_add_f32 v15, v15, v92
    v_mfma_f32_16x16x32_bf16 a[8:11], v[48:51], v[64:67], a[8:11]
    ds_read_b64_tr_b16 v[34:35], v2 offset:128
    v_add_f32_e64 v15, v15, v93
    v_mfma_f32_16x16x32_bf16 a[12:15], v[52:55], v[64:67], a[12:15]
    ds_read_b64_tr_b16 v[36:37], v2 offset:1184
    v_cvt_pk_bf16_f32 v92, v92, v93
    v_mfma_f32_16x16x32_bf16 a[72:75], v[48:51], v[68:71], a[72:75]
    ds_read_b64_tr_b16 v[38:39], v2 offset:160
    v_add_f32_e64 v15, v15, v94
    v_mfma_f32_16x16x32_bf16 a[76:79], v[52:55], v[68:71], a[76:79]
    ds_read_b64_tr_b16 v[40:41], v2 offset:1408
    v_add_f32 v15, v15, v95
    v_mfma_f32_16x16x32_bf16 a[136:139], v[48:51], v[72:75], a[136:139]
    ds_read_b64_tr_b16 v[42:43], v2 offset:384
    v_cvt_pk_bf16_f32 v93, v94, v95
    v_mfma_f32_16x16x32_bf16 a[140:143], v[52:55], v[72:75], a[140:143]
    s_waitcnt lgkmcnt(6)
    ds_read_b64_tr_b16 v[44:45], v2 offset:1440
    v_fma_f32 v82, v82, s84, v16
    v_mfma_f32_16x16x32_bf16 a[40:43], v[56:59], v[64:67], a[40:43]
    ds_write_b64 v7, v[92:93] offset:8200
    v_mfma_f32_16x16x32_bf16 a[44:47], v[60:63], v[64:67], a[44:47]
    ds_read_b64_tr_b16 v[46:47], v2 offset:416
    v_fma_f32 v83, v83, s84, v16
    v_mfma_f32_16x16x32_bf16 a[104:107], v[56:59], v[68:71], a[104:107]
    v_exp_f32 v80, v80
    v_mfma_f32_16x16x32_bf16 a[108:111], v[60:63], v[68:71], a[108:111]
    v_exp_f32 v81, v81
    v_mfma_f32_16x16x32_bf16 a[168:171], v[56:59], v[72:75], a[168:171]
    v_exp_f32_e64 v82, v82
    v_mfma_f32_16x16x32_bf16 a[172:175], v[60:63], v[72:75], a[172:175]
    buffer_load_dwordx4 v26, s[12:15], s69 offen offset:1024 nt lds
    v_mfma_f32_16x16x32_bf16 a[200:203], v[56:59], v[76:79], a[200:203]
    s_bitcmp1_b64 s[62:63], s70
    v_exp_f32_e64 v83, v83
    v_mfma_f32_16x16x32_bf16 a[204:207], v[60:63], v[76:79], a[204:207]
    s_waitcnt lgkmcnt(5)
    ds_read_b64_tr_b16 v[48:49], v2 offset:1216
    v_add_f32 v12, v12, v80
    v_mfma_f32_16x16x32_bf16 a[16:19], v[32:35], v[64:67], a[16:19]
    s_cselect_b64 s[12:13], s[58:59], s[60:61]
    ds_read_b64_tr_b16 v[50:51], v2 offset:192
    v_add_f32 v12, v12, v81
    v_mfma_f32_16x16x32_bf16 a[20:23], v[36:39], v[64:67], a[20:23]
    s_cselect_b32 s69, s67, s68
    ds_read_b64_tr_b16 v[52:53], v2 offset:1248
    v_cvt_pk_bf16_f32 v80, v80, v81
    v_mfma_f32_16x16x32_bf16 a[80:83], v[32:35], v[68:71], a[80:83]
    s_cselect_b32 s87, 8192, 0
    ds_read_b64_tr_b16 v[54:55], v2 offset:224
    v_add_f32_e64 v12, v12, v82
    v_mfma_f32_16x16x32_bf16 a[84:87], v[36:39], v[68:71], a[84:87]
    s_add_u32 s67, s67, s87
    ds_read_b64_tr_b16 v[56:57], v2 offset:1472
    v_add_f32 v12, v12, v83
    v_mfma_f32_16x16x32_bf16 a[144:147], v[32:35], v[72:75], a[144:147]
    s_xor_b32 s87, s87, 8192
    ds_read_b64_tr_b16 v[58:59], v2 offset:448
    v_cvt_pk_bf16_f32 v81, v82, v83
    v_mfma_f32_16x16x32_bf16 a[148:151], v[36:39], v[72:75], a[148:151]
    s_waitcnt lgkmcnt(6)
    ds_read_b64_tr_b16 v[60:61], v2 offset:1504
    v_fma_f32 v108, v108, s84, v16
    v_mfma_f32_16x16x32_bf16 a[48:51], v[40:43], v[64:67], a[48:51]
    s_add_u32 s68, s68, s87
    ds_read_b64_tr_b16 v[62:63], v2 offset:480
    v_fma_f32 v109, v109, s84, v16
    v_mfma_f32_16x16x32_bf16 a[52:55], v[44:47], v[64:67], a[52:55]
    s_and_b32 s87, s70, 15
    v_fma_f32 v110, v110, s84, v16
    v_fma_f32 v111, v111, s84, v16
    v_mfma_f32_16x16x32_bf16 a[112:115], v[40:43], v[68:71], a[112:115]
    s_mul_i32 s87, s87, 8320
    v_exp_f32 v108, v108
    v_mfma_f32_16x16x32_bf16 a[116:119], v[44:47], v[68:71], a[116:119]
    s_add_u32 m0, s87, s71
    v_exp_f32 v109, v109
    v_mfma_f32_16x16x32_bf16 a[176:179], v[40:43], v[72:75], a[176:179]
    s_add_u32 s70, s70, 1
    v_exp_f32 v110, v110
    v_mfma_f32_16x16x32_bf16 a[180:183], v[44:47], v[72:75], a[180:183]
    s_waitcnt vmcnt(8)
    v_exp_f32_e64 v111, v111
    v_mfma_f32_16x16x32_bf16 a[208:211], v[40:43], v[76:79], a[208:211]
    s_barrier
    v_mfma_f32_16x16x32_bf16 a[212:215], v[44:47], v[76:79], a[212:215]
    s_waitcnt lgkmcnt(4)
    ds_read_b128 v[32:35], v1 offset:17664
    v_add_f32 v12, v12, v108
    v_mfma_f32_16x16x32_bf16 a[24:27], v[48:51], v[64:67], a[24:27]
    buffer_load_dwordx4 v26, s[12:15], s69 offen nt lds
    v_mfma_f32_16x16x32_bf16 a[28:31], v[52:55], v[64:67], a[28:31]
    ds_read_b128 v[36:39], v1 offset:17728
    v_add_f32_e64 v12, v12, v109
    v_mfma_f32_16x16x32_bf16 a[88:91], v[48:51], v[68:71], a[88:91]
    ds_read_b128 v[40:43], v1 offset:17792
    v_cvt_pk_bf16_f32 v82, v108, v109
    v_mfma_f32_16x16x32_bf16 a[92:95], v[52:55], v[68:71], a[92:95]
    ds_read_b128 v[44:47], v1 offset:17856
    v_add_f32_e64 v12, v12, v110
    v_mfma_f32_16x16x32_bf16 a[152:155], v[48:51], v[72:75], a[152:155]
    ds_read_b128 v[48:51], v1 offset:17920
    v_add_f32 v12, v12, v111
    v_mfma_f32_16x16x32_bf16 a[156:159], v[52:55], v[72:75], a[156:159]
    s_waitcnt lgkmcnt(5)
    ds_read_b128 v[52:55], v1 offset:17984
    v_cvt_pk_bf16_f32 v83, v110, v111
    v_mfma_f32_16x16x32_bf16 a[56:59], v[56:59], v[64:67], a[56:59]
    v_fma_f32 v84, v84, s84, v17
    v_fma_f32 v85, v85, s84, v17
    v_mfma_f32_16x16x32_bf16 a[60:63], v[60:63], v[64:67], a[60:63]
    v_fma_f32 v86, v86, s84, v17
    v_fma_f32 v87, v87, s84, v17
    v_mfma_f32_16x16x32_bf16 a[120:123], v[56:59], v[68:71], a[120:123]
    v_exp_f32_e64 v84, v84
    v_mfma_f32_16x16x32_bf16 a[124:127], v[60:63], v[68:71], a[124:127]
    v_exp_f32 v85, v85
    v_mfma_f32_16x16x32_bf16 a[184:187], v[56:59], v[72:75], a[184:187]
    v_exp_f32 v86, v86
    v_mfma_f32_16x16x32_bf16 a[188:191], v[60:63], v[72:75], a[188:191]
    v_exp_f32_e64 v87, v87
    v_mfma_f32_16x16x32_bf16 a[216:219], v[56:59], v[76:79], a[216:219]
    ds_read_b128 v[56:59], v1 offset:18048
    v_add_f32_e64 v13, v13, v84
    v_mfma_f32_16x16x32_bf16 a[220:223], v[60:63], v[76:79], a[220:223]
    s_waitcnt lgkmcnt(5)
    ds_read_b128 v[60:63], v1 offset:18112
    v_add_f32 v13, v13, v85
    v_mfma_f32_16x16x32_bf16 v[76:79], v[32:35], a[224:227], 0
    v_cvt_pk_bf16_f32 v84, v84, v85
    v_add_f32_e64 v13, v13, v86
    v_mfma_f32_16x16x32_bf16 v[76:79], v[36:39], v[216:219], v[76:79]
    v_add_f32_e64 v13, v13, v87
    v_cvt_pk_bf16_f32 v85, v86, v87
    v_mfma_f32_16x16x32_bf16 v[64:67], v[32:35], v[120:123], 0
    buffer_load_dwordx4 v26, s[12:15], s69 offen offset:1024 nt lds
    v_mfma_f32_16x16x32_bf16 v[64:67], v[36:39], v[124:127], v[64:67]
    s_bitcmp1_b64 s[62:63], s70
    v_fma_f32 v112, v112, s84, v17
    v_fma_f32 v113, v113, s84, v17
    v_mfma_f32_16x16x32_bf16 v[68:71], v[32:35], v[152:155], 0
    s_cselect_b64 s[12:13], s[58:59], s[60:61]
    v_fma_f32 v114, v114, s84, v17
    v_fma_f32 v115, v115, s84, v17
    v_mfma_f32_16x16x32_bf16 v[68:71], v[36:39], v[156:159], v[68:71]
    s_cselect_b32 s69, s67, s68
    v_exp_f32 v112, v112
    v_mfma_f32_16x16x32_bf16 v[72:75], v[32:35], v[184:187], 0
    s_cselect_b32 s87, 8192, 0
    v_exp_f32 v113, v113
    v_mfma_f32_16x16x32_bf16 v[72:75], v[36:39], v[188:191], v[72:75]
    s_waitcnt lgkmcnt(4)
    v_exp_f32 v114, v114
    v_mfma_f32_16x16x32_bf16 v[76:79], v[40:43], a[228:231], v[76:79]
    s_add_u32 s67, s67, s87
    v_exp_f32_e64 v115, v115
    v_mfma_f32_16x16x32_bf16 v[76:79], v[44:47], v[220:223], v[76:79]
    s_xor_b32 s87, s87, 8192
    ds_read_b128 v[32:35], v1 offset:16640
    v_add_f32 v13, v13, v112
    v_mfma_f32_16x16x32_bf16 v[64:67], v[40:43], v[128:131], v[64:67]
    s_add_u32 s68, s68, s87
    ds_read_b128 v[36:39], v1 offset:16704
    v_add_f32 v13, v13, v113
    v_mfma_f32_16x16x32_bf16 v[64:67], v[44:47], v[132:135], v[64:67]
    s_and_b32 s87, s70, 15
    v_cvt_pk_bf16_f32 v86, v112, v113
    v_add_f32 v13, v13, v114
    v_mfma_f32_16x16x32_bf16 v[68:71], v[40:43], v[160:163], v[68:71]
    s_mul_i32 s87, s87, 8320
    v_add_f32 v13, v13, v115
    v_cvt_pk_bf16_f32 v87, v114, v115
    v_mfma_f32_16x16x32_bf16 v[68:71], v[44:47], v[164:167], v[68:71]
    s_add_u32 m0, s87, s71
    v_fma_f32 v88, v88, s84, v18
    v_fma_f32 v89, v89, s84, v18
    v_mfma_f32_16x16x32_bf16 v[72:75], v[40:43], v[192:195], v[72:75]
    s_add_u32 s70, s70, 1
    ds_read_b128 v[40:43], v1 offset:16768
    v_fma_f32 v90, v90, s84, v18
    v_mfma_f32_16x16x32_bf16 v[72:75], v[44:47], v[196:199], v[72:75]
    s_waitcnt lgkmcnt(5)
    ds_read_b128 v[44:47], v1 offset:16832
    v_fma_f32 v91, v91, s84, v18
    v_mfma_f32_16x16x32_bf16 v[76:79], v[48:51], a[232:235], v[76:79]
    v_exp_f32 v88, v88
    v_mfma_f32_16x16x32_bf16 v[76:79], v[52:55], v[224:227], v[76:79]
    v_exp_f32 v89, v89
    v_mfma_f32_16x16x32_bf16 v[64:67], v[48:51], v[136:139], v[64:67]
    v_exp_f32 v90, v90
    v_mfma_f32_16x16x32_bf16 v[64:67], v[52:55], v[140:143], v[64:67]
    v_exp_f32 v91, v91
    v_mfma_f32_16x16x32_bf16 v[68:71], v[48:51], v[168:171], v[68:71]
    buffer_load_dwordx4 v26, s[12:15], s69 offen nt lds
    v_mfma_f32_16x16x32_bf16 v[68:71], v[52:55], v[172:175], v[68:71]
    v_add_f32 v14, v14, v88
    v_add_f32_e64 v14, v14, v89
    v_mfma_f32_16x16x32_bf16 v[72:75], v[48:51], v[200:203], v[72:75]
    ds_read_b128 v[48:51], v1 offset:16896
    v_cvt_pk_bf16_f32 v88, v88, v89
    v_mfma_f32_16x16x32_bf16 v[72:75], v[52:55], v[204:207], v[72:75]
    s_waitcnt lgkmcnt(5)
    ds_read_b128 v[52:55], v1 offset:16960
    v_add_f32 v14, v14, v90
    v_mfma_f32_16x16x32_bf16 v[76:79], v[56:59], a[236:239], v[76:79]
    v_add_f32_e64 v14, v14, v91
    v_cvt_pk_bf16_f32 v89, v90, v91
    v_mfma_f32_16x16x32_bf16 v[76:79], v[60:63], v[228:231], v[76:79]
    v_fma_f32 v116, v116, s84, v18
    v_fma_f32 v117, v117, s84, v18
    v_mfma_f32_16x16x32_bf16 v[64:67], v[56:59], v[144:147], v[64:67]
    v_fma_f32 v118, v118, s84, v18
    v_fma_f32 v119, v119, s84, v18
    v_mfma_f32_16x16x32_bf16 v[64:67], v[60:63], v[148:151], v[64:67]
    v_exp_f32 v116, v116
    v_mfma_f32_16x16x32_bf16 v[68:71], v[56:59], v[176:179], v[68:71]
    v_exp_f32 v117, v117
    v_mfma_f32_16x16x32_bf16 v[68:71], v[60:63], v[180:183], v[68:71]
    v_exp_f32 v118, v118
    v_mfma_f32_16x16x32_bf16 v[72:75], v[56:59], v[208:211], v[72:75]
    v_exp_f32_e64 v119, v119
    v_mfma_f32_16x16x32_bf16 v[72:75], v[60:63], v[212:215], v[72:75]
    s_waitcnt lgkmcnt(4)
    ds_read_b128 v[56:59], v1 offset:17024
    v_add_f32 v14, v14, v116
    v_mfma_f32_16x16x32_bf16 v[96:99], v[32:35], v[120:123], 0
    ds_read_b128 v[60:63], v1 offset:17088
    v_add_f32 v14, v14, v117
    v_mfma_f32_16x16x32_bf16 v[96:99], v[36:39], v[124:127], v[96:99]
    s_waitcnt vmcnt(7) lgkmcnt(14)
    v_cvt_pk_bf16_f32 v90, v116, v117
    v_add_f32 v14, v14, v118
    v_mfma_f32_16x16x32_bf16 v[100:103], v[32:35], v[152:155], 0
    s_barrier
    v_mfma_f32_16x16x32_bf16 v[100:103], v[36:39], v[156:159], v[100:103]
    v_add_f32 v14, v14, v119
    v_cvt_pk_bf16_f32 v91, v118, v119
    v_mfma_f32_16x16x32_bf16 v[104:107], v[32:35], v[184:187], 0
    buffer_load_dwordx4 v26, s[12:15], s69 offen offset:1024 nt lds
    v_mfma_f32_16x16x32_bf16 v[104:107], v[36:39], v[188:191], v[104:107]
    s_waitcnt lgkmcnt(4)
    ds_read_b64_tr_b16 v[32:33], v2 offset:34304
    v_fma_f32 v76, v76, s84, v19
    v_mfma_f32_16x16x32_bf16 v[96:99], v[40:43], v[128:131], v[96:99]
    s_bitcmp1_b64 s[62:63], s70
    ds_read_b64_tr_b16 v[34:35], v2 offset:33280
    v_fma_f32 v77, v77, s84, v19
    v_mfma_f32_16x16x32_bf16 v[96:99], v[44:47], v[132:135], v[96:99]
    s_cselect_b64 s[12:13], s[58:59], s[60:61]
    ds_read_b64_tr_b16 v[36:37], v2 offset:34336
    v_fma_f32 v78, v78, s84, v19
    v_mfma_f32_16x16x32_bf16 v[100:103], v[40:43], v[160:163], v[100:103]
    s_cselect_b32 s69, s67, s68
    ds_read_b64_tr_b16 v[38:39], v2 offset:33312
    v_fma_f32 v79, v79, s84, v19
    v_mfma_f32_16x16x32_bf16 v[100:103], v[44:47], v[164:167], v[100:103]
    s_cselect_b32 s87, 8192, 0
    ds_read_b64 v[94:95], v8 offset:8200
    v_fma_f32 v64, v64, s84, v16
    v_mfma_f32_16x16x32_bf16 v[104:107], v[40:43], v[192:195], v[104:107]
    s_add_u32 s67, s67, s87
    ds_read_b64_tr_b16 v[40:41], v2 offset:34560
    v_fma_f32 v65, v65, s84, v16
    v_mfma_f32_16x16x32_bf16 v[104:107], v[44:47], v[196:199], v[104:107]
    s_waitcnt lgkmcnt(8)
    ds_read_b64_tr_b16 v[42:43], v2 offset:33536
    v_fma_f32 v66, v66, s84, v16
    v_mfma_f32_16x16x32_bf16 v[96:99], v[48:51], v[136:139], v[96:99]
    s_xor_b32 s87, s87, 8192
    ds_read_b64_tr_b16 v[44:45], v2 offset:34592
    v_fma_f32 v67, v67, s84, v16
    v_mfma_f32_16x16x32_bf16 v[96:99], v[52:55], v[140:143], v[96:99]
    s_add_u32 s68, s68, s87
    ds_read_b64_tr_b16 v[46:47], v2 offset:33568
    v_fma_f32 v68, v68, s84, v17
    v_mfma_f32_16x16x32_bf16 v[100:103], v[48:51], v[168:171], v[100:103]
    s_and_b32 s87, s70, 15
    v_exp_f32_e64 v76, v76
    v_mfma_f32_16x16x32_bf16 v[100:103], v[52:55], v[172:175], v[100:103]
    s_mul_i32 s87, s87, 8320
    v_exp_f32 v77, v77
    v_mfma_f32_16x16x32_bf16 v[104:107], v[48:51], v[200:203], v[104:107]
    s_add_u32 m0, s87, s71
    ds_read_b64_tr_b16 v[48:49], v2 offset:34368
    v_add_f32 v15, v15, v76
    v_mfma_f32_16x16x32_bf16 v[104:107], v[52:55], v[204:207], v[104:107]
    s_waitcnt lgkmcnt(10)
    ds_read_b64_tr_b16 v[50:51], v2 offset:33344
    v_add_f32 v15, v15, v77
    v_mfma_f32_16x16x32_bf16 v[96:99], v[56:59], v[144:147], v[96:99]
    s_add_u32 s70, s70, 1
    ds_read_b64_tr_b16 v[52:53], v2 offset:34400
    v_cvt_pk_bf16_f32 v76, v76, v77
    v_mfma_f32_16x16x32_bf16 v[96:99], v[60:63], v[148:151], v[96:99]
    buffer_load_dwordx4 v26, s[12:15], s69 offen nt lds
    v_mfma_f32_16x16x32_bf16 v[100:103], v[56:59], v[176:179], v[100:103]
    ds_read_b64_tr_b16 v[54:55], v2 offset:33376
    v_fma_f32 v69, v69, s84, v17
    v_mfma_f32_16x16x32_bf16 v[100:103], v[60:63], v[180:183], v[100:103]
    v_exp_f32_e64 v78, v78
    v_mfma_f32_16x16x32_bf16 v[104:107], v[56:59], v[208:211], v[104:107]
    ds_read_b64_tr_b16 v[56:57], v2 offset:34624
    v_add_f32 v15, v15, v78
    v_mfma_f32_16x16x32_bf16 v[104:107], v[60:63], v[212:215], v[104:107]
    s_waitcnt lgkmcnt(10)
    ds_read_b64_tr_b16 v[58:59], v2 offset:33600
    v_fma_f32 v70, v70, s84, v17
    v_mfma_f32_16x16x32_bf16 a[0:3], v[32:35], v[80:83], a[0:3]
    ds_read_b64_tr_b16 v[60:61], v2 offset:34656
    v_fma_f32 v71, v71, s84, v17
    v_mfma_f32_16x16x32_bf16 a[4:7], v[36:39], v[80:83], a[4:7]
    ds_read_b64_tr_b16 v[62:63], v2 offset:33632
    v_fma_f32 v72, v72, s84, v18
    v_mfma_f32_16x16x32_bf16 a[64:67], v[32:35], v[84:87], a[64:67]
    v_exp_f32 v79, v79
    v_mfma_f32_16x16x32_bf16 a[68:71], v[36:39], v[84:87], a[68:71]
    v_add_f32_e64 v15, v15, v79
    v_cvt_pk_bf16_f32 v77, v78, v79
    v_mfma_f32_16x16x32_bf16 a[128:131], v[32:35], v[88:91], a[128:131]
    ds_write_b64 v7, v[76:77] offset:8192
    v_mfma_f32_16x16x32_bf16 a[132:135], v[36:39], v[88:91], a[132:135]
    s_waitcnt lgkmcnt(9)
    ds_read_b64_tr_b16 v[32:33], v2 offset:34432
    v_fma_f32 v73, v73, s84, v18
    v_mfma_f32_16x16x32_bf16 a[32:35], v[40:43], v[80:83], a[32:35]
    ds_read_b64_tr_b16 v[34:35], v2 offset:33408
    v_fma_f32 v74, v74, s84, v18
    v_mfma_f32_16x16x32_bf16 a[36:39], v[44:47], v[80:83], a[36:39]
    ds_read_b64_tr_b16 v[36:37], v2 offset:34464
    v_fma_f32 v75, v75, s84, v18
    v_mfma_f32_16x16x32_bf16 a[96:99], v[40:43], v[84:87], a[96:99]
    ds_read_b64_tr_b16 v[38:39], v2 offset:33440
    v_fma_f32 v96, v96, s84, v16
    v_mfma_f32_16x16x32_bf16 a[100:103], v[44:47], v[84:87], a[100:103]
    buffer_load_dwordx4 v26, s[12:15], s69 offen offset:1024 nt lds
    v_mfma_f32_16x16x32_bf16 a[160:163], v[40:43], v[88:91], a[160:163]
    s_bitcmp1_b64 s[62:63], s70
    v_exp_f32 v64, v64
    v_mfma_f32_16x16x32_bf16 a[164:167], v[44:47], v[88:91], a[164:167]
    s_cselect_b64 s[12:13], s[58:59], s[60:61]
    v_exp_f32 v65, v65
    v_mfma_f32_16x16x32_bf16 a[192:195], v[40:43], v[92:95], a[192:195]
    s_cselect_b32 s69, s67, s68
    v_exp_f32 v66, v66
    v_mfma_f32_16x16x32_bf16 a[196:199], v[44:47], v[92:95], a[196:199]
    s_waitcnt lgkmcnt(9)
    v_exp_f32 v67, v67
    v_mfma_f32_16x16x32_bf16 a[8:11], v[48:51], v[80:83], a[8:11]
    s_cselect_b32 s87, 8192, 0
    ds_read_b64_tr_b16 v[40:41], v2 offset:34688
    v_add_f32_e64 v12, v12, v64
    v_mfma_f32_16x16x32_bf16 a[12:15], v[52:55], v[80:83], a[12:15]
    s_add_u32 s67, s67, s87
    ds_read_b64_tr_b16 v[42:43], v2 offset:33664
    v_add_f32 v12, v12, v65
    v_mfma_f32_16x16x32_bf16 a[72:75], v[48:51], v[84:87], a[72:75]
    s_xor_b32 s87, s87, 8192
    ds_read_b64_tr_b16 v[44:45], v2 offset:34720
    v_cvt_pk_bf16_f32 v64, v64, v65
    v_mfma_f32_16x16x32_bf16 a[76:79], v[52:55], v[84:87], a[76:79]
    s_add_u32 s68, s68, s87
    ds_read_b64_tr_b16 v[46:47], v2 offset:33696
    v_add_f32_e64 v12, v12, v66
    v_mfma_f32_16x16x32_bf16 a[136:139], v[48:51], v[88:91], a[136:139]
    s_and_b32 s87, s70, 15
    ds_read_b64_tr_b16 v[48:49], v2 offset:34496
    v_add_f32 v12, v12, v67
    v_mfma_f32_16x16x32_bf16 a[140:143], v[52:55], v[88:91], a[140:143]
    s_waitcnt lgkmcnt(10)
    ds_read_b64_tr_b16 v[50:51], v2 offset:33472
    v_cvt_pk_bf16_f32 v65, v66, v67
    v_mfma_f32_16x16x32_bf16 a[40:43], v[56:59], v[80:83], a[40:43]
    s_mul_i32 s87, s87, 8320
    ds_read_b64_tr_b16 v[52:53], v2 offset:34528
    v_fma_f32 v97, v97, s84, v16
    v_mfma_f32_16x16x32_bf16 a[44:47], v[60:63], v[80:83], a[44:47]
    s_add_u32 m0, s87, s71
    ds_read_b64_tr_b16 v[54:55], v2 offset:33504
    v_fma_f32 v98, v98, s84, v16
    v_mfma_f32_16x16x32_bf16 a[104:107], v[56:59], v[84:87], a[104:107]
    s_add_u32 s70, s70, 1
    v_exp_f32 v68, v68
    v_mfma_f32_16x16x32_bf16 a[108:111], v[60:63], v[84:87], a[108:111]
    v_exp_f32 v69, v69
    v_mfma_f32_16x16x32_bf16 a[168:171], v[56:59], v[88:91], a[168:171]
    v_exp_f32_e64 v70, v70
    v_mfma_f32_16x16x32_bf16 a[172:175], v[60:63], v[88:91], a[172:175]
    buffer_load_dwordx4 v26, s[12:15], s69 offen nt lds
    v_mfma_f32_16x16x32_bf16 a[200:203], v[56:59], v[92:95], a[200:203]
    v_exp_f32 v71, v71
    v_mfma_f32_16x16x32_bf16 a[204:207], v[60:63], v[92:95], a[204:207]
    s_waitcnt lgkmcnt(8)
    ds_read_b64_tr_b16 v[56:57], v2 offset:34752
    v_add_f32 v13, v13, v68
    v_mfma_f32_16x16x32_bf16 a[16:19], v[32:35], v[80:83], a[16:19]
    ds_read_b64_tr_b16 v[58:59], v2 offset:33728
    v_add_f32 v13, v13, v69
    v_mfma_f32_16x16x32_bf16 a[20:23], v[36:39], v[80:83], a[20:23]
    ds_read_b64_tr_b16 v[60:61], v2 offset:34784
    v_cvt_pk_bf16_f32 v68, v68, v69
    v_mfma_f32_16x16x32_bf16 a[80:83], v[32:35], v[84:87], a[80:83]
    ds_read_b64_tr_b16 v[62:63], v2 offset:33760
    v_add_f32 v13, v13, v70
    v_mfma_f32_16x16x32_bf16 a[84:87], v[36:39], v[84:87], a[84:87]
    s_waitcnt vmcnt(7)
    v_add_f32_e64 v13, v13, v71
    v_cvt_pk_bf16_f32 v69, v70, v71
    v_mfma_f32_16x16x32_bf16 a[144:147], v[32:35], v[88:91], a[144:147]
    s_barrier
    v_mfma_f32_16x16x32_bf16 a[148:151], v[36:39], v[88:91], a[148:151]
    s_waitcnt lgkmcnt(8)
    v_exp_f32_e64 v72, v72
    v_mfma_f32_16x16x32_bf16 a[48:51], v[40:43], v[80:83], a[48:51]
    v_exp_f32_e64 v73, v73
    v_mfma_f32_16x16x32_bf16 a[52:55], v[44:47], v[80:83], a[52:55]
    v_exp_f32_e64 v74, v74
    v_mfma_f32_16x16x32_bf16 a[112:115], v[40:43], v[84:87], a[112:115]
    v_exp_f32_e64 v75, v75
    v_mfma_f32_16x16x32_bf16 a[116:119], v[44:47], v[84:87], a[116:119]
    ds_read_b128 v[32:35], v1 offset:50944
    v_add_f32_e64 v14, v14, v72
    v_mfma_f32_16x16x32_bf16 a[176:179], v[40:43], v[88:91], a[176:179]
    ds_read_b128 v[36:39], v1 offset:51008
    v_add_f32_e64 v14, v14, v73
    v_mfma_f32_16x16x32_bf16 a[180:183], v[44:47], v[88:91], a[180:183]
    v_cvt_pk_bf16_f32 v72, v72, v73
    v_add_f32_e64 v14, v14, v74
    v_mfma_f32_16x16x32_bf16 a[208:211], v[40:43], v[92:95], a[208:211]
    ds_read_b128 v[40:43], v1 offset:51072
    v_add_f32 v14, v14, v75
    v_mfma_f32_16x16x32_bf16 a[212:215], v[44:47], v[92:95], a[212:215]
    s_waitcnt lgkmcnt(7)
    ds_read_b128 v[44:47], v1 offset:51136
    v_cvt_pk_bf16_f32 v73, v74, v75
    v_mfma_f32_16x16x32_bf16 a[24:27], v[48:51], v[80:83], a[24:27]
    buffer_load_dwordx4 v26, s[12:15], s69 offen offset:1024 nt lds
    v_mfma_f32_16x16x32_bf16 a[28:31], v[52:55], v[80:83], a[28:31]
    s_bitcmp1_b64 s[62:63], s70
    v_fma_f32 v99, v99, s84, v16
    v_fma_f32 v100, v100, s84, v17
    v_mfma_f32_16x16x32_bf16 a[88:91], v[48:51], v[84:87], a[88:91]
    s_cselect_b64 s[12:13], s[58:59], s[60:61]
    v_exp_f32 v96, v96
    v_mfma_f32_16x16x32_bf16 a[92:95], v[52:55], v[84:87], a[92:95]
    s_cselect_b32 s69, s67, s68
    v_exp_f32_e64 v97, v97
    v_mfma_f32_16x16x32_bf16 a[152:155], v[48:51], v[88:91], a[152:155]
    s_cselect_b32 s87, 8192, 0
    v_exp_f32 v98, v98
    v_mfma_f32_16x16x32_bf16 a[156:159], v[52:55], v[88:91], a[156:159]
    s_waitcnt lgkmcnt(4)
    v_exp_f32_e64 v99, v99
    v_mfma_f32_16x16x32_bf16 a[56:59], v[56:59], v[80:83], a[56:59]
    s_add_u32 s67, s67, s87
    ds_read_b128 v[48:51], v1 offset:51200
    v_add_f32 v12, v12, v96
    v_mfma_f32_16x16x32_bf16 a[60:63], v[60:63], v[80:83], a[60:63]
    s_xor_b32 s87, s87, 8192
    ds_read_b128 v[52:55], v1 offset:51264
    v_add_f32 v12, v12, v97
    v_mfma_f32_16x16x32_bf16 a[120:123], v[56:59], v[84:87], a[120:123]
    s_add_u32 s68, s68, s87
    v_cvt_pk_bf16_f32 v66, v96, v97
    v_add_f32 v12, v12, v98
    v_mfma_f32_16x16x32_bf16 a[124:127], v[60:63], v[84:87], a[124:127]
    s_and_b32 s87, s70, 15
    v_add_f32_e64 v12, v12, v99
    v_cvt_pk_bf16_f32 v67, v98, v99
    v_mfma_f32_16x16x32_bf16 a[184:187], v[56:59], v[88:91], a[184:187]
    s_mul_i32 s87, s87, 8320
    v_fma_f32 v101, v101, s84, v17
    v_fma_f32 v102, v102, s84, v17
    v_mfma_f32_16x16x32_bf16 a[188:191], v[60:63], v[88:91], a[188:191]
    s_add_u32 m0, s87, s71
    v_fma_f32 v103, v103, s84, v17
    v_fma_f32 v104, v104, s84, v18
    v_mfma_f32_16x16x32_bf16 a[216:219], v[56:59], v[92:95], a[216:219]
    s_cmp_ge_u32 s70, 76
    v_exp_f32 v100, v100
    v_mfma_f32_16x16x32_bf16 a[220:223], v[60:63], v[92:95], a[220:223]
    s_waitcnt lgkmcnt(4)
    v_exp_f32 v101, v101
    v_mfma_f32_16x16x32_bf16 v[92:95], v[32:35], a[224:227], 0
    s_cselect_b32 s14, 0, s14
    v_exp_f32 v102, v102
    v_mfma_f32_16x16x32_bf16 v[92:95], v[36:39], v[216:219], v[92:95]
    s_add_u32 s70, s70, 1
    v_exp_f32 v103, v103
    v_mfma_f32_16x16x32_bf16 v[80:83], v[32:35], v[120:123], 0
    buffer_load_dwordx4 v26, s[12:15], s69 offen nt lds
    v_mfma_f32_16x16x32_bf16 v[80:83], v[36:39], v[124:127], v[80:83]
    ds_read_b128 v[56:59], v1 offset:51328
    v_add_f32 v13, v13, v100
    v_mfma_f32_16x16x32_bf16 v[84:87], v[32:35], v[152:155], 0
    ds_read_b128 v[60:63], v1 offset:51392
    v_add_f32 v13, v13, v101
    v_mfma_f32_16x16x32_bf16 v[84:87], v[36:39], v[156:159], v[84:87]
    v_cvt_pk_bf16_f32 v70, v100, v101
    v_add_f32_e64 v13, v13, v102
    v_mfma_f32_16x16x32_bf16 v[88:91], v[32:35], v[184:187], 0
    ds_read_b128 v[32:35], v1 offset:49920
    v_add_f32 v13, v13, v103
    v_mfma_f32_16x16x32_bf16 v[88:91], v[36:39], v[188:191], v[88:91]
    s_waitcnt lgkmcnt(5)
    ds_read_b128 v[36:39], v1 offset:49984
    v_cvt_pk_bf16_f32 v71, v102, v103
    v_mfma_f32_16x16x32_bf16 v[92:95], v[40:43], a[228:231], v[92:95]
    v_fma_f32 v105, v105, s84, v18
    v_fma_f32 v106, v106, s84, v18
    v_mfma_f32_16x16x32_bf16 v[92:95], v[44:47], v[220:223], v[92:95]
    v_fma_f32 v107, v107, s84, v18
    v_add_u32 v2, s72, v2
    v_mfma_f32_16x16x32_bf16 v[80:83], v[40:43], v[128:131], v[80:83]
    v_exp_f32 v104, v104
    v_mfma_f32_16x16x32_bf16 v[80:83], v[44:47], v[132:135], v[80:83]
    v_exp_f32 v105, v105
    v_mfma_f32_16x16x32_bf16 v[84:87], v[40:43], v[160:163], v[84:87]
    v_exp_f32 v106, v106
    v_mfma_f32_16x16x32_bf16 v[84:87], v[44:47], v[164:167], v[84:87]
    v_exp_f32_e64 v107, v107
    v_mfma_f32_16x16x32_bf16 v[88:91], v[40:43], v[192:195], v[88:91]
    ds_read_b128 v[40:43], v1 offset:50048
    v_add_f32_e64 v14, v14, v104
    v_mfma_f32_16x16x32_bf16 v[88:91], v[44:47], v[196:199], v[88:91]
    s_waitcnt lgkmcnt(5)
    ds_read_b128 v[44:47], v1 offset:50112
    v_add_f32 v14, v14, v105
    v_mfma_f32_16x16x32_bf16 v[92:95], v[48:51], a[232:235], v[92:95]
    v_cvt_pk_bf16_f32 v74, v104, v105
    v_add_f32_e64 v14, v14, v106
    v_mfma_f32_16x16x32_bf16 v[92:95], v[52:55], v[224:227], v[92:95]
    buffer_load_dwordx4 v26, s[12:15], s69 offen offset:1024 nt lds
    v_mfma_f32_16x16x32_bf16 v[80:83], v[48:51], v[136:139], v[80:83]
    s_bitcmp1_b64 s[62:63], s70
    v_add_f32_e64 v14, v14, v107
    v_cvt_pk_bf16_f32 v75, v106, v107
    v_mfma_f32_16x16x32_bf16 v[80:83], v[52:55], v[140:143], v[80:83]
    s_cselect_b64 s[12:13], s[58:59], s[60:61]
    s_cselect_b32 s69, s67, s68
    s_cselect_b32 s87, 8192, 0
    v_mfma_f32_16x16x32_bf16 v[84:87], v[48:51], v[168:171], v[84:87]
    s_add_u32 s67, s67, s87
    s_xor_b32 s87, s87, 8192
    s_add_u32 s68, s68, s87
    v_mfma_f32_16x16x32_bf16 v[84:87], v[52:55], v[172:175], v[84:87]
    s_and_b32 s87, s70, 15
    s_mul_i32 s87, s87, 8320
    s_add_u32 m0, s87, s71
    v_mfma_f32_16x16x32_bf16 v[88:91], v[48:51], v[200:203], v[88:91]
    s_cmp_ge_u32 s70, 76
    ds_read_b128 v[48:51], v1 offset:50176
    s_cselect_b32 s14, 0, s14
    v_mfma_f32_16x16x32_bf16 v[88:91], v[52:55], v[204:207], v[88:91]
    s_waitcnt lgkmcnt(5)
    ds_read_b128 v[52:55], v1 offset:50240
    s_add_u32 s70, s70, 1
    v_mfma_f32_16x16x32_bf16 v[92:95], v[56:59], a[236:239], v[92:95]
    v_mfma_f32_16x16x32_bf16 v[92:95], v[60:63], v[228:231], v[92:95]
    v_mfma_f32_16x16x32_bf16 v[80:83], v[56:59], v[144:147], v[80:83]
    v_mfma_f32_16x16x32_bf16 v[80:83], v[60:63], v[148:151], v[80:83]
    v_mfma_f32_16x16x32_bf16 v[84:87], v[56:59], v[176:179], v[84:87]
    v_mfma_f32_16x16x32_bf16 v[84:87], v[60:63], v[180:183], v[84:87]
    v_mfma_f32_16x16x32_bf16 v[88:91], v[56:59], v[208:211], v[88:91]
    ds_read_b128 v[56:59], v1 offset:50304
    v_mfma_f32_16x16x32_bf16 v[88:91], v[60:63], v[212:215], v[88:91]
    ds_read_b128 v[60:63], v1 offset:50368
    s_waitcnt vmcnt(6) lgkmcnt(6)
    v_mfma_f32_16x16x32_bf16 v[108:111], v[32:35], v[120:123], 0
    s_barrier
    v_mfma_f32_16x16x32_bf16 v[108:111], v[36:39], v[124:127], v[108:111]
    buffer_load_dwordx4 v26, s[12:15], s69 offen nt lds
    v_mfma_f32_16x16x32_bf16 v[112:115], v[32:35], v[152:155], 0
    s_add_u32 s73, s73, 1
    v_add_u32 v1, s72, v1
    v_mfma_f32_16x16x32_bf16 v[112:115], v[36:39], v[156:159], v[112:115]
    v_mfma_f32_16x16x32_bf16 v[116:119], v[32:35], v[184:187], 0
    ds_read_b64_tr_b16 v[32:33], v2 offset:1024
    v_mfma_f32_16x16x32_bf16 v[116:119], v[36:39], v[188:191], v[116:119]
    s_waitcnt lgkmcnt(5)
    ds_read_b64_tr_b16 v[34:35], v2 offset:0
    v_mfma_f32_16x16x32_bf16 v[108:111], v[40:43], v[128:131], v[108:111]
    ds_read_b64_tr_b16 v[36:37], v2 offset:1056
    v_mfma_f32_16x16x32_bf16 v[108:111], v[44:47], v[132:135], v[108:111]
    ds_read_b64_tr_b16 v[38:39], v2 offset:32
    v_mfma_f32_16x16x32_bf16 v[112:115], v[40:43], v[160:163], v[112:115]
    ds_read_b64 v[78:79], v8 offset:8192
    v_mfma_f32_16x16x32_bf16 v[112:115], v[44:47], v[164:167], v[112:115]
    v_mfma_f32_16x16x32_bf16 v[116:119], v[40:43], v[192:195], v[116:119]
    ds_read_b64_tr_b16 v[40:41], v2 offset:1280
    v_mfma_f32_16x16x32_bf16 v[116:119], v[44:47], v[196:199], v[116:119]
    s_waitcnt lgkmcnt(8)
    ds_read_b64_tr_b16 v[42:43], v2 offset:256
    v_mfma_f32_16x16x32_bf16 v[108:111], v[48:51], v[136:139], v[108:111]
    ds_read_b64_tr_b16 v[44:45], v2 offset:1312
    v_mfma_f32_16x16x32_bf16 v[108:111], v[52:55], v[140:143], v[108:111]
    ds_read_b64_tr_b16 v[46:47], v2 offset:288
    v_mfma_f32_16x16x32_bf16 v[112:115], v[48:51], v[168:171], v[112:115]
    v_mfma_f32_16x16x32_bf16 v[112:115], v[52:55], v[172:175], v[112:115]
    v_mfma_f32_16x16x32_bf16 v[116:119], v[48:51], v[200:203], v[116:119]
    v_mfma_f32_16x16x32_bf16 v[116:119], v[52:55], v[204:207], v[116:119]
    s_waitcnt lgkmcnt(9)
    v_mfma_f32_16x16x32_bf16 v[108:111], v[56:59], v[144:147], v[108:111]
    buffer_load_dwordx4 v26, s[12:15], s69 offen offset:1024 nt lds
    v_mfma_f32_16x16x32_bf16 v[108:111], v[60:63], v[148:151], v[108:111]
    s_sub_u32 s72, 0, s72
    v_mfma_f32_16x16x32_bf16 v[112:115], v[56:59], v[176:179], v[112:115]
    v_mfma_f32_16x16x32_bf16 v[112:115], v[60:63], v[180:183], v[112:115]
    v_mfma_f32_16x16x32_bf16 v[116:119], v[56:59], v[208:211], v[116:119]
    v_mfma_f32_16x16x32_bf16 v[116:119], v[60:63], v[212:215], v[116:119]
    s_cmp_lt_u32 s73, 7
    s_cbranch_scc1 L_attn1
    s_waitcnt lgkmcnt(5)
    v_mfma_f32_16x16x32_bf16 a[0:3], v[32:35], v[64:67], a[0:3]
    s_lshl_b32 s83, s76, 7
    ds_read_b64_tr_b16 v[48:49], v2 offset:1088
    s_add_u32 s83, s83, s88
    v_mfma_f32_16x16x32_bf16 a[4:7], v[36:39], v[64:67], a[4:7]
    s_add_u32 s76, s76, 1
    ds_read_b64_tr_b16 v[50:51], v2 offset:64
    s_cmp_ge_u32 s76, 7
    s_cselect_b32 s76, 0, s76
    v_mfma_f32_16x16x32_bf16 a[64:67], v[32:35], v[68:71], a[64:67]
    s_add_u32 m0, s74, 0
    ds_read_b64_tr_b16 v[52:53], v2 offset:1120
    v_fma_f32 v92, v92, s84, v19
    v_fma_f32 v93, v93, s84, v19
    v_fma_f32 v94, v94, s84, v19
    v_mfma_f32_16x16x32_bf16 a[68:71], v[36:39], v[68:71], a[68:71]
    ds_read_b64_tr_b16 v[54:55], v2 offset:96
    v_fma_f32 v95, v95, s84, v19
    v_fma_f32 v80, v80, s84, v16
    v_fma_f32 v81, v81, s84, v16
    v_mfma_f32_16x16x32_bf16 a[128:131], v[32:35], v[72:75], a[128:131]
    ds_read_b64_tr_b16 v[56:57], v2 offset:1344
    v_fma_f32 v82, v82, s84, v16
    v_fma_f32 v83, v83, s84, v16
    v_fma_f32 v108, v108, s84, v16
    v_mfma_f32_16x16x32_bf16 a[132:135], v[36:39], v[72:75], a[132:135]
    s_waitcnt lgkmcnt(5)
    ds_read_b64_tr_b16 v[58:59], v2 offset:320
    v_exp_f32_e64 v92, v92
    v_fma_f32 v109, v109, s84, v16
    v_mfma_f32_16x16x32_bf16 a[32:35], v[40:43], v[64:67], a[32:35]
    buffer_load_dwordx4 v24, s[24:27], s83 offen lds
    v_mfma_f32_16x16x32_bf16 a[36:39], v[44:47], v[64:67], a[36:39]
    s_add_u32 s83, s83, 27648
    ds_read_b64_tr_b16 v[60:61], v2 offset:1376
    v_exp_f32_e64 v93, v93
    v_fma_f32 v110, v110, s84, v16
    v_mfma_f32_16x16x32_bf16 a[96:99], v[40:43], v[68:71], a[96:99]
    ds_read_b64_tr_b16 v[62:63], v2 offset:352
    v_exp_f32_e64 v94, v94
    v_fma_f32 v111, v111, s84, v16
    v_mfma_f32_16x16x32_bf16 a[100:103], v[44:47], v[68:71], a[100:103]
    ds_read_b64_tr_b16 v[32:33], v2 offset:1152
    v_exp_f32 v95, v95
    v_add_f32 v15, v15, v92
    v_mfma_f32_16x16x32_bf16 a[160:163], v[40:43], v[72:75], a[160:163]
    ds_read_b64_tr_b16 v[34:35], v2 offset:128
    v_exp_f32 v80, v80
    v_add_f32 v15, v15, v93
    v_mfma_f32_16x16x32_bf16 a[164:167], v[44:47], v[72:75], a[164:167]
    buffer_load_dwordx4 v24, s[24:27], s83 offen offset:1024 lds
    v_mfma_f32_16x16x32_bf16 a[192:195], v[40:43], v[76:79], a[192:195]
    s_add_u32 s83, s83, 27648
    ds_read_b64_tr_b16 v[36:37], v2 offset:1184
    v_exp_f32_e64 v81, v81
    v_cvt_pk_bf16_f32 v92, v92, v93
    v_mfma_f32_16x16x32_bf16 a[196:199], v[44:47], v[76:79], a[196:199]
    s_waitcnt lgkmcnt(7)
    ds_read_b64_tr_b16 v[38:39], v2 offset:160
    v_exp_f32 v82, v82
    v_add_f32_e64 v15, v15, v94
    v_mfma_f32_16x16x32_bf16 a[8:11], v[48:51], v[64:67], a[8:11]
    ds_read_b64_tr_b16 v[40:41], v2 offset:1408
    v_exp_f32 v83, v83
    v_add_f32 v15, v15, v95
    v_mfma_f32_16x16x32_bf16 a[12:15], v[52:55], v[64:67], a[12:15]
    ds_read_b64_tr_b16 v[42:43], v2 offset:384
    v_cvt_pk_bf16_f32 v93, v94, v95
    v_mov_b32_e64 v23, v15
    v_fma_f32 v84, v84, s84, v17
    v_mfma_f32_16x16x32_bf16 a[72:75], v[48:51], v[68:71], a[72:75]
    ds_write_b64 v7, v[92:93] offset:8200
    v_mfma_f32_16x16x32_bf16 a[76:79], v[52:55], v[68:71], a[76:79]
    buffer_load_dwordx4 v24, s[24:27], s83 offen offset:2048 lds
    v_mfma_f32_16x16x32_bf16 a[136:139], v[48:51], v[72:75], a[136:139]
    s_add_u32 s83, s83, 27648
    ds_read_b64_tr_b16 v[44:45], v2 offset:1440
    v_permlane16_swap_b32 v15, v23
    v_add_f32 v15, v15, v23
    v_mov_b32 v23, v15
    v_mfma_f32_16x16x32_bf16 a[140:143], v[52:55], v[72:75], a[140:143]
    s_waitcnt lgkmcnt(8)
    ds_read_b64_tr_b16 v[46:47], v2 offset:416
    v_permlane32_swap_b32 v15, v23
    v_add_f32 v15, v15, v23
    v_fma_f32 v85, v85, s84, v17
    v_mfma_f32_16x16x32_bf16 a[40:43], v[56:59], v[64:67], a[40:43]
    ds_write_b32 v7, v15 offset:0
    v_mfma_f32_16x16x32_bf16 a[44:47], v[60:63], v[64:67], a[44:47]
    ds_read_b64_tr_b16 v[48:49], v2 offset:1216
    v_fma_f32 v86, v86, s84, v17
    v_fma_f32 v87, v87, s84, v17
    v_add_f32_e64 v12, v12, v80
    v_mfma_f32_16x16x32_bf16 a[104:107], v[56:59], v[68:71], a[104:107]
    ds_read_b64_tr_b16 v[50:51], v2 offset:192
    v_exp_f32 v108, v108
    v_add_f32 v12, v12, v81
    v_mfma_f32_16x16x32_bf16 a[108:111], v[60:63], v[68:71], a[108:111]
    ds_read_b64_tr_b16 v[52:53], v2 offset:1248
    v_exp_f32_e64 v109, v109
    v_cvt_pk_bf16_f32 v80, v80, v81
    v_mfma_f32_16x16x32_bf16 a[168:171], v[56:59], v[72:75], a[168:171]
    ds_read_b64_tr_b16 v[54:55], v2 offset:224
    v_exp_f32 v110, v110
    v_add_f32 v12, v12, v82
    v_mfma_f32_16x16x32_bf16 a[172:175], v[60:63], v[72:75], a[172:175]
    v_exp_f32 v111, v111
    v_add_f32 v12, v12, v83
    v_cvt_pk_bf16_f32 v81, v82, v83
    v_mfma_f32_16x16x32_bf16 a[200:203], v[56:59], v[76:79], a[200:203]
    buffer_load_dwordx4 v24, s[24:27], s83 offen offset:3072 lds
    v_mfma_f32_16x16x32_bf16 a[204:207], v[60:63], v[76:79], a[204:207]
    s_waitcnt lgkmcnt(10)
    ds_read_b64_tr_b16 v[56:57], v2 offset:1472
    v_exp_f32 v84, v84
    v_add_f32_e64 v12, v12, v108
    v_mfma_f32_16x16x32_bf16 a[16:19], v[32:35], v[64:67], a[16:19]
    s_add_u32 s83, s83, 31744
    ds_read_b64_tr_b16 v[58:59], v2 offset:448
    v_exp_f32 v85, v85
    v_add_f32 v12, v12, v109
    v_mfma_f32_16x16x32_bf16 a[20:23], v[36:39], v[64:67], a[20:23]
    s_add_u32 m0, s74, 16512
    ds_read_b64_tr_b16 v[60:61], v2 offset:1504
    v_exp_f32_e64 v86, v86
    v_cvt_pk_bf16_f32 v82, v108, v109
    v_mfma_f32_16x16x32_bf16 a[80:83], v[32:35], v[68:71], a[80:83]
    ds_read_b64_tr_b16 v[62:63], v2 offset:480
    v_exp_f32 v87, v87
    v_add_f32 v12, v12, v110
    v_mfma_f32_16x16x32_bf16 a[84:87], v[36:39], v[68:71], a[84:87]
    s_waitcnt vmcnt(8) lgkmcnt(8)
    v_add_f32 v12, v12, v111
    v_cvt_pk_bf16_f32 v83, v110, v111
    v_fma_f32 v112, v112, s84, v17
    v_fma_f32 v113, v113, s84, v17
    v_mfma_f32_16x16x32_bf16 a[144:147], v[32:35], v[72:75], a[144:147]
    s_barrier
    v_mfma_f32_16x16x32_bf16 a[148:151], v[36:39], v[72:75], a[148:151]
    ds_read_b64 v[94:95], v8 offset:8200
    v_fma_f32 v114, v114, s84, v17
    v_fma_f32 v115, v115, s84, v17
    v_add_f32 v13, v13, v84
    v_mfma_f32_16x16x32_bf16 a[48:51], v[40:43], v[64:67], a[48:51]
    buffer_load_dwordx4 v24, s[24:27], s83 offen lds
    v_mfma_f32_16x16x32_bf16 a[52:55], v[44:47], v[64:67], a[52:55]
    s_add_u32 s83, s83, 27648
    ds_read_b32 v23, v8 offset:0
    v_add_f32_e64 v13, v13, v85
    v_cvt_pk_bf16_f32 v84, v84, v85
    v_add_f32 v13, v13, v86
    v_mfma_f32_16x16x32_bf16 a[112:115], v[40:43], v[68:71], a[112:115]
    ds_read_b64_tr_b16 v[32:33], v2 offset:17920
    v_add_f32 v13, v13, v87
    v_cvt_pk_bf16_f32 v85, v86, v87
    v_fma_f32 v88, v88, s84, v18
    v_mfma_f32_16x16x32_bf16 a[116:119], v[44:47], v[68:71], a[116:119]
    ds_read_b64_tr_b16 v[34:35], v2 offset:16896
    v_fma_f32 v89, v89, s84, v18
    v_fma_f32 v90, v90, s84, v18
    v_fma_f32 v91, v91, s84, v18
    v_mfma_f32_16x16x32_bf16 a[176:179], v[40:43], v[72:75], a[176:179]
    ds_read_b64_tr_b16 v[36:37], v2 offset:17952
    v_exp_f32_e64 v112, v112
    v_fma_f32 v116, v116, s84, v18
    v_mfma_f32_16x16x32_bf16 a[180:183], v[44:47], v[72:75], a[180:183]
    ds_read_b64_tr_b16 v[38:39], v2 offset:16928
    v_exp_f32_e64 v113, v113
    v_fma_f32 v117, v117, s84, v18
    v_mfma_f32_16x16x32_bf16 a[208:211], v[40:43], v[76:79], a[208:211]
    ds_read_b64_tr_b16 v[40:41], v2 offset:17984
    v_exp_f32 v114, v114
    v_fma_f32 v118, v118, s84, v18
    v_mfma_f32_16x16x32_bf16 a[212:215], v[44:47], v[76:79], a[212:215]
    s_waitcnt lgkmcnt(11)
    ds_read_b64_tr_b16 v[42:43], v2 offset:16960
    v_exp_f32_e64 v115, v115
    v_fma_f32 v119, v119, s84, v18
    v_mfma_f32_16x16x32_bf16 a[24:27], v[48:51], v[64:67], a[24:27]
    buffer_load_dwordx4 v24, s[24:27], s83 offen offset:1024 lds
    v_mfma_f32_16x16x32_bf16 a[28:31], v[52:55], v[64:67], a[28:31]
    s_add_u32 s83, s83, 27648
    ds_read_b64_tr_b16 v[44:45], v2 offset:18016
    v_exp_f32 v88, v88
    v_add_f32 v13, v13, v112
    v_mfma_f32_16x16x32_bf16 a[88:91], v[48:51], v[68:71], a[88:91]
    ds_read_b64_tr_b16 v[46:47], v2 offset:16992
    v_exp_f32 v89, v89
    v_add_f32 v13, v13, v113
    v_mfma_f32_16x16x32_bf16 a[92:95], v[52:55], v[68:71], a[92:95]
    v_exp_f32 v90, v90
    v_exp_f32 v91, v91
    v_mfma_f32_16x16x32_bf16 a[152:155], v[48:51], v[72:75], a[152:155]
    ds_read_b64_tr_b16 v[48:49], v2 offset:18048
    v_cvt_pk_bf16_f32 v86, v112, v113
    v_add_f32 v13, v13, v114
    v_add_f32_e64 v13, v13, v115
    v_mfma_f32_16x16x32_bf16 a[156:159], v[52:55], v[72:75], a[156:159]
    s_waitcnt lgkmcnt(11)
    ds_read_b64_tr_b16 v[50:51], v2 offset:17024
    v_cvt_pk_bf16_f32 v87, v114, v115
    v_exp_f32_e64 v116, v116
    v_mfma_f32_16x16x32_bf16 a[56:59], v[56:59], v[64:67], a[56:59]
    ds_read_b64_tr_b16 v[52:53], v2 offset:18080
    v_exp_f32 v117, v117
    v_add_f32 v14, v14, v88
    v_mfma_f32_16x16x32_bf16 a[60:63], v[60:63], v[64:67], a[60:63]
    v_exp_f32_e64 v118, v118
    v_mfma_f32_16x16x32_bf16 a[120:123], v[56:59], v[68:71], a[120:123]
    v_exp_f32 v119, v119
    v_mfma_f32_16x16x32_bf16 a[124:127], v[60:63], v[68:71], a[124:127]
    ds_read_b64_tr_b16 v[54:55], v2 offset:17056
    v_add_f32 v14, v14, v89
    v_mfma_f32_16x16x32_bf16 a[184:187], v[56:59], v[72:75], a[184:187]
    v_cvt_pk_bf16_f32 v88, v88, v89
    v_add_f32_e64 v14, v14, v90
    v_mfma_f32_16x16x32_bf16 a[188:191], v[60:63], v[72:75], a[188:191]
    v_add_f32_e64 v14, v14, v91
    v_cvt_pk_bf16_f32 v89, v90, v91
    v_mfma_f32_16x16x32_bf16 a[216:219], v[56:59], v[76:79], a[216:219]
    buffer_load_dwordx4 v24, s[24:27], s83 offen offset:2048 lds
    v_mfma_f32_16x16x32_bf16 a[220:223], v[60:63], v[76:79], a[220:223]
    s_waitcnt lgkmcnt(8)
    ds_read_b64_tr_b16 v[56:57], v2 offset:18112
    v_add_f32 v14, v14, v116
    v_mfma_f32_16x16x32_bf16 a[32:35], v[32:35], v[80:83], a[32:35]
    s_add_u32 s83, s83, 27648
    ds_read_b64_tr_b16 v[58:59], v2 offset:17088
    v_add_f32_e64 v14, v14, v117
    v_mfma_f32_16x16x32_bf16 a[36:39], v[36:39], v[80:83], a[36:39]
    ds_read_b64_tr_b16 v[60:61], v2 offset:18144
    v_cvt_pk_bf16_f32 v90, v116, v117
    v_mfma_f32_16x16x32_bf16 a[96:99], v[32:35], v[84:87], a[96:99]
    ds_read_b64_tr_b16 v[62:63], v2 offset:17120
    v_add_f32 v14, v14, v118
    v_mfma_f32_16x16x32_bf16 a[100:103], v[36:39], v[84:87], a[100:103]
    v_add_f32_e64 v14, v14, v119
    v_cvt_pk_bf16_f32 v91, v118, v119
    s_nop 1
    v_mfma_f32_16x16x32_bf16 a[160:163], v[32:35], v[88:91], a[160:163]
    buffer_load_dwordx4 v24, s[24:27], s83 offen offset:3072 lds
    v_mfma_f32_16x16x32_bf16 a[164:167], v[36:39], v[88:91], a[164:167]
    buffer_load_dword v1, v11, s[32:35], 0 offen sc1
    v_mfma_f32_16x16x32_bf16 a[192:195], v[32:35], v[92:95], a[192:195]
    s_lshl_b32 s83, s76, 7
    ds_read_b64_tr_b16 v[32:33], v2 offset:17664
    s_add_u32 s83, s83, s88
    v_mfma_f32_16x16x32_bf16 a[196:199], v[36:39], v[92:95], a[196:199]
    s_waitcnt lgkmcnt(9)
    ds_read_b64_tr_b16 v[34:35], v2 offset:16640
    s_add_u32 s76, s76, 1
    v_mfma_f32_16x16x32_bf16 a[40:43], v[40:43], v[80:83], a[40:43]
    s_cmp_ge_u32 s76, 7
    s_cselect_b32 s76, 0, s76
    ds_read_b64_tr_b16 v[36:37], v2 offset:17696
    s_add_u32 m0, s74, 33024
    v_mfma_f32_16x16x32_bf16 a[44:47], v[44:47], v[80:83], a[44:47]
    buffer_load_dwordx4 v24, s[24:27], s83 offen lds
    v_mfma_f32_16x16x32_bf16 a[104:107], v[40:43], v[84:87], a[104:107]
    s_add_u32 s83, s83, 27648
    ds_read_b64_tr_b16 v[38:39], v2 offset:16672
    v_add_f32_e64 v15, v15, v23
    v_mfma_f32_16x16x32_bf16 a[108:111], v[44:47], v[84:87], a[108:111]
    buffer_load_dwordx4 v24, s[24:27], s83 offen offset:1024 lds
    v_mfma_f32_16x16x32_bf16 a[168:171], v[40:43], v[88:91], a[168:171]
    s_add_u32 s83, s83, 27648
    v_rcp_f32_e64 v239, v15
    v_mfma_f32_16x16x32_bf16 a[172:175], v[44:47], v[88:91], a[172:175]
    buffer_load_dwordx4 v24, s[24:27], s83 offen offset:2048 lds
    v_mfma_f32_16x16x32_bf16 a[200:203], v[40:43], v[92:95], a[200:203]
    s_add_u32 s83, s83, 27648
    ds_read_b64_tr_b16 v[40:41], v2 offset:17728
    v_mov_b32 v20, v12
    v_mfma_f32_16x16x32_bf16 a[204:207], v[44:47], v[92:95], a[204:207]
    s_waitcnt lgkmcnt(9)
    ds_read_b64_tr_b16 v[42:43], v2 offset:16704
    v_mov_b32 v21, v13
    v_mfma_f32_16x16x32_bf16 a[48:51], v[48:51], v[80:83], a[48:51]
    ds_read_b64_tr_b16 v[44:45], v2 offset:17760
    v_mov_b32 v22, v14
    v_mfma_f32_16x16x32_bf16 a[52:55], v[52:55], v[80:83], a[52:55]
    ds_read_b64_tr_b16 v[46:47], v2 offset:16736
    v_permlane16_swap_b32 v12, v20
    v_mfma_f32_16x16x32_bf16 a[112:115], v[48:51], v[84:87], a[112:115]
    v_permlane16_swap_b32 v13, v21
    v_permlane16_swap_b32 v14, v22
    v_mfma_f32_16x16x32_bf16 a[116:119], v[52:55], v[84:87], a[116:119]
    v_add_f32 v12, v12, v20
    v_add_f32 v13, v13, v21
    v_mfma_f32_16x16x32_bf16 a[176:179], v[48:51], v[88:91], a[176:179]
    v_add_f32 v14, v14, v22
    v_mov_b32 v20, v12
    v_mfma_f32_16x16x32_bf16 a[180:183], v[52:55], v[88:91], a[180:183]
    v_mov_b32 v21, v13
    v_mov_b32_e64 v22, v14
    v_mfma_f32_16x16x32_bf16 a[208:211], v[48:51], v[92:95], a[208:211]
    ds_read_b64_tr_b16 v[48:49], v2 offset:17792
    v_permlane32_swap_b32 v12, v20
    v_mfma_f32_16x16x32_bf16 a[212:215], v[52:55], v[92:95], a[212:215]
    s_waitcnt lgkmcnt(9)
    ds_read_b64_tr_b16 v[50:51], v2 offset:16768
    v_permlane32_swap_b32 v13, v21
    v_mfma_f32_16x16x32_bf16 a[56:59], v[56:59], v[80:83], a[56:59]
    ds_read_b64_tr_b16 v[52:53], v2 offset:17824
    v_permlane32_swap_b32 v14, v22
    v_mfma_f32_16x16x32_bf16 a[60:63], v[60:63], v[80:83], a[60:63]
    ds_read_b64_tr_b16 v[54:55], v2 offset:16800
    v_add_f32 v12, v12, v20
    v_mfma_f32_16x16x32_bf16 a[120:123], v[56:59], v[84:87], a[120:123]
    v_add_f32 v13, v13, v21
    v_add_f32_e64 v14, v14, v22
    v_mfma_f32_16x16x32_bf16 a[124:127], v[60:63], v[84:87], a[124:127]
    v_rcp_f32 v236, v12
    v_mfma_f32_16x16x32_bf16 a[184:187], v[56:59], v[88:91], a[184:187]
    v_rcp_f32 v237, v13
    v_mfma_f32_16x16x32_bf16 a[188:191], v[60:63], v[88:91], a[188:191]
    v_rcp_f32 v238, v14
    v_mfma_f32_16x16x32_bf16 a[216:219], v[56:59], v[92:95], a[216:219]
    ds_read_b64_tr_b16 v[56:57], v2 offset:17856
    v_add_f32 v20, v12, v13
    v_mfma_f32_16x16x32_bf16 a[220:223], v[60:63], v[92:95], a[220:223]
    s_waitcnt lgkmcnt(9)
    ds_read_b64_tr_b16 v[58:59], v2 offset:16832
    v_add_f32 v21, v14, v15
    v_mfma_f32_16x16x32_bf16 a[0:3], v[32:35], v[80:83], a[0:3]
    ds_read_b64_tr_b16 v[60:61], v2 offset:17888
    v_add_f32_e64 v20, v20, v21
    v_mfma_f32_16x16x32_bf16 a[4:7], v[36:39], v[80:83], a[4:7]
    ds_read_b64_tr_b16 v[62:63], v2 offset:16864
    v_cmp_ngt_f32 vcc, 0x5d800000, v20
    v_mfma_f32_16x16x32_bf16 a[64:67], v[32:35], v[84:87], a[64:67]
    s_or_b32 s85, vcc_lo, vcc_hi
    s_andn2_b32 s85, s85, s90
    v_mov_b32 v20, s85
    v_mfma_f32_16x16x32_bf16 a[68:71], v[36:39], v[84:87], a[68:71]
    ds_write_b32 v7, v20 offset:8192
    v_mfma_f32_16x16x32_bf16 a[128:131], v[32:35], v[88:91], a[128:131]
    buffer_load_dwordx4 v24, s[24:27], s83 offen offset:3072 lds
    v_mfma_f32_16x16x32_bf16 a[132:135], v[36:39], v[88:91], a[132:135]
    s_waitcnt lgkmcnt(9)
    s_add_u32 s83, s83, 31744
    s_add_u32 m0, s74, 49536
    v_mfma_f32_16x16x32_bf16 a[8:11], v[40:43], v[80:83], a[8:11]
    buffer_load_dwordx4 v24, s[24:27], s83 offen lds
    v_mfma_f32_16x16x32_bf16 a[12:15], v[44:47], v[80:83], a[12:15]
    s_add_u32 s83, s83, 27648
    s_waitcnt vmcnt(6) lgkmcnt(1)
    s_barrier
    v_mfma_f32_16x16x32_bf16 a[72:75], v[40:43], v[84:87], a[72:75]
    buffer_load_dwordx4 v24, s[24:27], s83 offen offset:1024 lds
    v_mfma_f32_16x16x32_bf16 a[76:79], v[44:47], v[84:87], a[76:79]
    s_add_u32 s83, s83, 27648
    ds_read_b64_tr_b16 v[32:33], v0 offset:0
    s_lshr_b32 s86, s3, 1
    v_mfma_f32_16x16x32_bf16 a[136:139], v[40:43], v[88:91], a[136:139]
    buffer_load_dwordx4 v24, s[24:27], s83 offen offset:2048 lds
    v_mfma_f32_16x16x32_bf16 a[140:143], v[44:47], v[88:91], a[140:143]
    ds_read_b64_tr_b16 v[34:35], v0 offset:512
    s_add_u32 s83, s83, 27648
    v_mfma_f32_16x16x32_bf16 a[16:19], v[48:51], v[80:83], a[16:19]
    buffer_load_dwordx4 v24, s[24:27], s83 offen offset:3072 lds
    v_mfma_f32_16x16x32_bf16 a[20:23], v[52:55], v[80:83], a[20:23]
    s_lshl_b32 s83, s76, 7
    ds_read_b64_tr_b16 v[36:37], v0 offset:1024
    s_add_u32 s83, s83, s88
    v_mfma_f32_16x16x32_bf16 a[80:83], v[48:51], v[84:87], a[80:83]
    s_add_u32 s76, s76, 1
    ds_read_b64_tr_b16 v[38:39], v0 offset:1536
    s_cmp_ge_u32 s76, 7
    s_cselect_b32 s76, 0, s76
    v_mfma_f32_16x16x32_bf16 a[84:87], v[52:55], v[84:87], a[84:87]
    s_add_u32 m0, s74, 66560
    s_cmp_eq_u32 s86, s89
    s_cselect_b32 s94, 99840, 0
    v_add_u32_e64 v18, s94, v26
    v_mfma_f32_16x16x32_bf16 a[144:147], v[48:51], v[88:91], a[144:147]
    buffer_load_dwordx4 v24, s[24:27], s83 offen lds
    v_mfma_f32_16x16x32_bf16 a[148:151], v[52:55], v[88:91], a[148:151]
    s_add_u32 s83, s83, 27648
    v_add_u32 v16, 3072, v18
    v_mfma_f32_16x16x32_bf16 a[24:27], v[56:59], v[80:83], a[24:27]
    buffer_load_dwordx4 v24, s[24:27], s83 offen offset:1024 lds
    v_mfma_f32_16x16x32_bf16 a[28:31], v[60:63], v[80:83], a[28:31]
    s_add_u32 s83, s83, 27648
    v_add_u32 v17, 34816, v18
    s_xor_b32 s86, s37, 1
    v_mfma_f32_16x16x32_bf16 a[88:91], v[56:59], v[84:87], a[88:91]
    buffer_load_dwordx4 v24, s[24:27], s83 offen offset:2048 lds
    v_mfma_f32_16x16x32_bf16 a[92:95], v[60:63], v[84:87], a[92:95]
    s_add_u32 s83, s83, 27648
    s_mul_i32 s46, s86, 57344
    s_add_u32 s46, s46, 1835008
    v_mfma_f32_16x16x32_bf16 a[152:155], v[56:59], v[88:91], a[152:155]
    buffer_load_dwordx4 v24, s[24:27], s83 offen offset:3072 lds
    v_mfma_f32_16x16x32_bf16 a[156:159], v[60:63], v[88:91], a[156:159]
    s_add_u32 s83, s83, 31744
    s_add_u32 m0, s74, 83072
    s_lshl_b32 s48, s86, 8
    buffer_load_dwordx4 v24, s[24:27], s83 offen lds
    s_add_u32 s83, s83, 27648
    buffer_load_dwordx4 v24, s[24:27], s83 offen offset:1024 lds
    s_add_u32 s83, s83, 27648
    buffer_load_dwordx4 v24, s[24:27], s83 offen offset:2048 lds
    s_add_u32 s83, s83, 27648
    buffer_load_dwordx4 v24, s[24:27], s83 offen offset:3072 lds
    s_add_u32 s48, s48, 2752548
    v_add_u32 v4, 99840, v26
    s_mov_b32 s73, 3
    s_nop 5
    s_cmp_lt_u32 s3, 2
    s_cbranch_scc1 L_cb1
    s_branch L_cb3
L_cs0:
    s_add_u32 s87, s46, 0
    buffer_store_dwordx4 v[216:219], v17, s[28:31], s87 offen sc1
    s_add_u32 s87, s46, 0
    buffer_store_dwordx4 v[120:123], v16, s[28:31], s87 offen sc1
    buffer_store_dwordx4 v[152:155], v16, s[28:31], s87 offen offset:1024 sc1
    buffer_store_dwordx4 v[184:187], v16, s[28:31], s87 offen offset:2048 sc1
    s_add_u32 s87, s46, 7168
    buffer_store_dwordx4 v[124:127], v16, s[28:31], s87 offen sc1
    buffer_store_dwordx4 v[156:159], v16, s[28:31], s87 offen offset:1024 sc1
    buffer_store_dwordx4 v[188:191], v16, s[28:31], s87 offen offset:2048 sc1
    s_branch L_cn0
L_cs1:
    s_add_u32 s87, s46, 7168
    buffer_store_dwordx4 v[220:223], v17, s[28:31], s87 offen sc1
    s_add_u32 s87, s46, 14336
    buffer_store_dwordx4 v[128:131], v16, s[28:31], s87 offen sc1
    buffer_store_dwordx4 v[160:163], v16, s[28:31], s87 offen offset:1024 sc1
    buffer_store_dwordx4 v[192:195], v16, s[28:31], s87 offen offset:2048 sc1
    s_add_u32 s87, s46, 21504
    buffer_store_dwordx4 v[132:135], v16, s[28:31], s87 offen sc1
    buffer_store_dwordx4 v[164:167], v16, s[28:31], s87 offen offset:1024 sc1
    buffer_store_dwordx4 v[196:199], v16, s[28:31], s87 offen offset:2048 sc1
    s_branch L_cn1
L_cs2:
    s_add_u32 s87, s46, 14336
    buffer_store_dwordx4 v[224:227], v17, s[28:31], s87 offen sc1
    s_add_u32 s87, s46, 28672
    buffer_store_dwordx4 v[136:139], v16, s[28:31], s87 offen sc1
    buffer_store_dwordx4 v[168:171], v16, s[28:31], s87 offen offset:1024 sc1
    buffer_store_dwordx4 v[200:203], v16, s[28:31], s87 offen offset:2048 sc1
    s_add_u32 s87, s46, 35840
    buffer_store_dwordx4 v[140:143], v16, s[28:31], s87 offen sc1
    buffer_store_dwordx4 v[172:175], v16, s[28:31], s87 offen offset:1024 sc1
    buffer_store_dwordx4 v[204:207], v16, s[28:31], s87 offen offset:2048 sc1
    s_branch L_cn2
L_cs3:
    s_add_u32 s87, s46, 21504
    buffer_store_dwordx4 v[228:231], v17, s[28:31], s87 offen sc1
    s_add_u32 s87, s46, 43008
    buffer_store_dwordx4 v[144:147], v16, s[28:31], s87 offen sc1
    buffer_store_dwordx4 v[176:179], v16, s[28:31], s87 offen offset:1024 sc1
    buffer_store_dwordx4 v[208:211], v16, s[28:31], s87 offen offset:2048 sc1
    s_add_u32 s87, s46, 50176
    buffer_store_dwordx4 v[148:151], v16, s[28:31], s87 offen sc1
    buffer_store_dwordx4 v[180:183], v16, s[28:31], s87 offen offset:1024 sc1
    buffer_store_dwordx4 v[212:215], v16, s[28:31], s87 offen offset:2048 sc1
    s_branch L_cn3
L_cxs:
    s_waitcnt vmcnt(36) lgkmcnt(0)
    s_branch L_op
L_cb0:
    v_accvgpr_read_b32 v240, a192
    v_accvgpr_read_b32 v241, a193
    v_accvgpr_read_b32 v242, a194
    v_accvgpr_read_b32 v243, a195
    v_accvgpr_read_b32 v244, a196
    v_accvgpr_read_b32 v245, a197
    v_accvgpr_read_b32 v246, a198
    v_accvgpr_read_b32 v247, a199
    v_pk_mul_f32 v[240:241], v[240:241], v[238:239] op_sel:[0,1] op_sel_hi:[1,1]
    v_pk_mul_f32 v[242:243], v[242:243], v[238:239] op_sel:[0,1] op_sel_hi:[1,1]
    v_pk_mul_f32 v[244:245], v[244:245], v[238:239] op_sel:[0,1] op_sel_hi:[1,1]
    v_pk_mul_f32 v[246:247], v[246:247], v[238:239] op_sel:[0,1] op_sel_hi:[1,1]
    v_cvt_pk_bf16_f32 v216, v240, v241
    v_cvt_pk_bf16_f32 v217, v242, v243
    v_cvt_pk_bf16_f32 v218, v244, v245
    v_cvt_pk_bf16_f32 v219, v246, v247
    v_accvgpr_read_b32 v248, a0
    v_accvgpr_read_b32 v249, a1
    v_accvgpr_read_b32 v250, a2
    v_accvgpr_read_b32 v251, a3
    v_accvgpr_read_b32 v252, a4
    v_accvgpr_read_b32 v253, a5
    v_accvgpr_read_b32 v254, a6
    v_accvgpr_read_b32 v255, a7
    v_pk_mul_f32 v[248:249], v[248:249], v[236:237] op_sel:[0,0] op_sel_hi:[1,0]
    v_pk_mul_f32 v[250:251], v[250:251], v[236:237] op_sel:[0,0] op_sel_hi:[1,0]
    v_pk_mul_f32 v[252:253], v[252:253], v[236:237] op_sel:[0,0] op_sel_hi:[1,0]
    v_pk_mul_f32 v[254:255], v[254:255], v[236:237] op_sel:[0,0] op_sel_hi:[1,0]
    v_cvt_pk_bf16_f32 v120, v248, v249
    v_cvt_pk_bf16_f32 v121, v250, v251
    v_cvt_pk_bf16_f32 v122, v252, v253
    v_cvt_pk_bf16_f32 v123, v254, v255
    v_accvgpr_read_b32 v240, a64
    v_accvgpr_read_b32 v241, a65
    v_accvgpr_read_b32 v242, a66
    v_accvgpr_read_b32 v243, a67
    v_accvgpr_read_b32 v244, a68
    v_accvgpr_read_b32 v245, a69
    v_accvgpr_read_b32 v246, a70
    v_accvgpr_read_b32 v247, a71
    v_pk_mul_f32 v[240:241], v[240:241], v[236:237] op_sel:[0,1] op_sel_hi:[1,1]
    v_pk_mul_f32 v[242:243], v[242:243], v[236:237] op_sel:[0,1] op_sel_hi:[1,1]
    v_pk_mul_f32 v[244:245], v[244:245], v[236:237] op_sel:[0,1] op_sel_hi:[1,1]
    v_pk_mul_f32 v[246:247], v[246:247], v[236:237] op_sel:[0,1] op_sel_hi:[1,1]
    v_cvt_pk_bf16_f32 v152, v240, v241
    v_cvt_pk_bf16_f32 v153, v242, v243
    v_cvt_pk_bf16_f32 v154, v244, v245
    v_cvt_pk_bf16_f32 v155, v246, v247
    v_accvgpr_read_b32 v248, a128
    v_accvgpr_read_b32 v249, a129
    v_accvgpr_read_b32 v250, a130
    v_accvgpr_read_b32 v251, a131
    v_accvgpr_read_b32 v252, a132
    v_accvgpr_read_b32 v253, a133
    v_accvgpr_read_b32 v254, a134
    v_accvgpr_read_b32 v255, a135
    v_pk_mul_f32 v[248:249], v[248:249], v[238:239] op_sel:[0,0] op_sel_hi:[1,0]
    v_pk_mul_f32 v[250:251], v[250:251], v[238:239] op_sel:[0,0] op_sel_hi:[1,0]
    v_pk_mul_f32 v[252:253], v[252:253], v[238:239] op_sel:[0,0] op_sel_hi:[1,0]
    v_pk_mul_f32 v[254:255], v[254:255], v[238:239] op_sel:[0,0] op_sel_hi:[1,0]
    v_cvt_pk_bf16_f32 v184, v248, v249
    v_cvt_pk_bf16_f32 v185, v250, v251
    v_cvt_pk_bf16_f32 v186, v252, v253
    v_cvt_pk_bf16_f32 v187, v254, v255
    v_accvgpr_read_b32 v240, a8
    v_accvgpr_read_b32 v241, a9
    v_accvgpr_read_b32 v242, a10
    v_accvgpr_read_b32 v243, a11
    v_accvgpr_read_b32 v244, a12
    v_accvgpr_read_b32 v245, a13
    v_accvgpr_read_b32 v246, a14
    v_accvgpr_read_b32 v247, a15
    v_pk_mul_f32 v[240:241], v[240:241], v[236:237] op_sel:[0,0] op_sel_hi:[1,0]
    v_pk_mul_f32 v[242:243], v[242:243], v[236:237] op_sel:[0,0] op_sel_hi:[1,0]
    v_pk_mul_f32 v[244:245], v[244:245], v[236:237] op_sel:[0,0] op_sel_hi:[1,0]
    v_pk_mul_f32 v[246:247], v[246:247], v[236:237] op_sel:[0,0] op_sel_hi:[1,0]
    v_cvt_pk_bf16_f32 v124, v240, v241
    v_cvt_pk_bf16_f32 v125, v242, v243
    v_cvt_pk_bf16_f32 v126, v244, v245
    v_cvt_pk_bf16_f32 v127, v246, v247
    v_accvgpr_read_b32 v248, a72
    v_accvgpr_read_b32 v249, a73
    v_accvgpr_read_b32 v250, a74
    v_accvgpr_read_b32 v251, a75
    v_accvgpr_read_b32 v252, a76
    v_accvgpr_read_b32 v253, a77
    v_accvgpr_read_b32 v254, a78
    v_accvgpr_read_b32 v255, a79
    v_pk_mul_f32 v[248:249], v[248:249], v[236:237] op_sel:[0,1] op_sel_hi:[1,1]
    v_pk_mul_f32 v[250:251], v[250:251], v[236:237] op_sel:[0,1] op_sel_hi:[1,1]
    v_pk_mul_f32 v[252:253], v[252:253], v[236:237] op_sel:[0,1] op_sel_hi:[1,1]
    v_pk_mul_f32 v[254:255], v[254:255], v[236:237] op_sel:[0,1] op_sel_hi:[1,1]
    v_cvt_pk_bf16_f32 v156, v248, v249
    v_cvt_pk_bf16_f32 v157, v250, v251
    v_cvt_pk_bf16_f32 v158, v252, v253
    v_cvt_pk_bf16_f32 v159, v254, v255
    v_accvgpr_read_b32 v240, a136
    v_accvgpr_read_b32 v241, a137
    v_accvgpr_read_b32 v242, a138
    v_accvgpr_read_b32 v243, a139
    v_accvgpr_read_b32 v244, a140
    v_accvgpr_read_b32 v245, a141
    v_accvgpr_read_b32 v246, a142
    v_accvgpr_read_b32 v247, a143
    v_pk_mul_f32 v[240:241], v[240:241], v[238:239] op_sel:[0,0] op_sel_hi:[1,0]
    v_pk_mul_f32 v[242:243], v[242:243], v[238:239] op_sel:[0,0] op_sel_hi:[1,0]
    v_pk_mul_f32 v[244:245], v[244:245], v[238:239] op_sel:[0,0] op_sel_hi:[1,0]
    v_pk_mul_f32 v[246:247], v[246:247], v[238:239] op_sel:[0,0] op_sel_hi:[1,0]
    v_cvt_pk_bf16_f32 v188, v240, v241
    v_cvt_pk_bf16_f32 v189, v242, v243
    v_cvt_pk_bf16_f32 v190, v244, v245
    v_cvt_pk_bf16_f32 v191, v246, v247
    s_cmp_eq_u32 s94, 0
    s_cbranch_scc1 L_cs0
    ds_write_b128 v17, v[216:219] offset:0
    ds_write_b128 v16, v[120:123] offset:0
    ds_write_b128 v16, v[152:155] offset:1024
    ds_write_b128 v16, v[184:187] offset:2048
    ds_write_b128 v16, v[124:127] offset:7168
    ds_write_b128 v16, v[156:159] offset:8192
    ds_write_b128 v16, v[188:191] offset:9216
L_cn0:
    s_sub_u32 s73, s73, 1
    s_cbranch_scc1 L_cx
L_cb1:
    v_accvgpr_read_b32 v248, a200
    v_accvgpr_read_b32 v249, a201
    v_accvgpr_read_b32 v250, a202
    v_accvgpr_read_b32 v251, a203
    v_accvgpr_read_b32 v252, a204
    v_accvgpr_read_b32 v253, a205
    v_accvgpr_read_b32 v254, a206
    v_accvgpr_read_b32 v255, a207
    v_pk_mul_f32 v[248:249], v[248:249], v[238:239] op_sel:[0,1] op_sel_hi:[1,1]
    v_pk_mul_f32 v[250:251], v[250:251], v[238:239] op_sel:[0,1] op_sel_hi:[1,1]
    v_pk_mul_f32 v[252:253], v[252:253], v[238:239] op_sel:[0,1] op_sel_hi:[1,1]
    v_pk_mul_f32 v[254:255], v[254:255], v[238:239] op_sel:[0,1] op_sel_hi:[1,1]
    v_cvt_pk_bf16_f32 v220, v248, v249
    v_cvt_pk_bf16_f32 v221, v250, v251
    v_cvt_pk_bf16_f32 v222, v252, v253
    v_cvt_pk_bf16_f32 v223, v254, v255
    v_accvgpr_read_b32 v240, a16
    v_accvgpr_read_b32 v241, a17
    v_accvgpr_read_b32 v242, a18
    v_accvgpr_read_b32 v243, a19
    v_accvgpr_read_b32 v244, a20
    v_accvgpr_read_b32 v245, a21
    v_accvgpr_read_b32 v246, a22
    v_accvgpr_read_b32 v247, a23
    v_pk_mul_f32 v[240:241], v[240:241], v[236:237] op_sel:[0,0] op_sel_hi:[1,0]
    v_pk_mul_f32 v[242:243], v[242:243], v[236:237] op_sel:[0,0] op_sel_hi:[1,0]
    v_pk_mul_f32 v[244:245], v[244:245], v[236:237] op_sel:[0,0] op_sel_hi:[1,0]
    v_pk_mul_f32 v[246:247], v[246:247], v[236:237] op_sel:[0,0] op_sel_hi:[1,0]
    v_cvt_pk_bf16_f32 v128, v240, v241
    v_cvt_pk_bf16_f32 v129, v242, v243
    v_cvt_pk_bf16_f32 v130, v244, v245
    v_cvt_pk_bf16_f32 v131, v246, v247
    v_accvgpr_read_b32 v248, a80
    v_accvgpr_read_b32 v249, a81
    v_accvgpr_read_b32 v250, a82
    v_accvgpr_read_b32 v251, a83
    v_accvgpr_read_b32 v252, a84
    v_accvgpr_read_b32 v253, a85
    v_accvgpr_read_b32 v254, a86
    v_accvgpr_read_b32 v255, a87
    v_pk_mul_f32 v[248:249], v[248:249], v[236:237] op_sel:[0,1] op_sel_hi:[1,1]
    v_pk_mul_f32 v[250:251], v[250:251], v[236:237] op_sel:[0,1] op_sel_hi:[1,1]
    v_pk_mul_f32 v[252:253], v[252:253], v[236:237] op_sel:[0,1] op_sel_hi:[1,1]
    v_pk_mul_f32 v[254:255], v[254:255], v[236:237] op_sel:[0,1] op_sel_hi:[1,1]
    v_cvt_pk_bf16_f32 v160, v248, v249
    v_cvt_pk_bf16_f32 v161, v250, v251
    v_cvt_pk_bf16_f32 v162, v252, v253
    v_cvt_pk_bf16_f32 v163, v254, v255
    v_accvgpr_read_b32 v240, a144
    v_accvgpr_read_b32 v241, a145
    v_accvgpr_read_b32 v242, a146
    v_accvgpr_read_b32 v243, a147
    v_accvgpr_read_b32 v244, a148
    v_accvgpr_read_b32 v245, a149
    v_accvgpr_read_b32 v246, a150
    v_accvgpr_read_b32 v247, a151
    v_pk_mul_f32 v[240:241], v[240:241], v[238:239] op_sel:[0,0] op_sel_hi:[1,0]
    v_pk_mul_f32 v[242:243], v[242:243], v[238:239] op_sel:[0,0] op_sel_hi:[1,0]
    v_pk_mul_f32 v[244:245], v[244:245], v[238:239] op_sel:[0,0] op_sel_hi:[1,0]
    v_pk_mul_f32 v[246:247], v[246:247], v[238:239] op_sel:[0,0] op_sel_hi:[1,0]
    v_cvt_pk_bf16_f32 v192, v240, v241
    v_cvt_pk_bf16_f32 v193, v242, v243
    v_cvt_pk_bf16_f32 v194, v244, v245
    v_cvt_pk_bf16_f32 v195, v246, v247
    v_accvgpr_read_b32 v248, a24
    v_accvgpr_read_b32 v249, a25
    v_accvgpr_read_b32 v250, a26
    v_accvgpr_read_b32 v251, a27
    v_accvgpr_read_b32 v252, a28
    v_accvgpr_read_b32 v253, a29
    v_accvgpr_read_b32 v254, a30
    v_accvgpr_read_b32 v255, a31
    v_pk_mul_f32 v[248:249], v[248:249], v[236:237] op_sel:[0,0] op_sel_hi:[1,0]
    v_pk_mul_f32 v[250:251], v[250:251], v[236:237] op_sel:[0,0] op_sel_hi:[1,0]
    v_pk_mul_f32 v[252:253], v[252:253], v[236:237] op_sel:[0,0] op_sel_hi:[1,0]
    v_pk_mul_f32 v[254:255], v[254:255], v[236:237] op_sel:[0,0] op_sel_hi:[1,0]
    v_cvt_pk_bf16_f32 v132, v248, v249
    v_cvt_pk_bf16_f32 v133, v250, v251
    v_cvt_pk_bf16_f32 v134, v252, v253
    v_cvt_pk_bf16_f32 v135, v254, v255
    v_accvgpr_read_b32 v240, a88
    v_accvgpr_read_b32 v241, a89
    v_accvgpr_read_b32 v242, a90
    v_accvgpr_read_b32 v243, a91
    v_accvgpr_read_b32 v244, a92
    v_accvgpr_read_b32 v245, a93
    v_accvgpr_read_b32 v246, a94
    v_accvgpr_read_b32 v247, a95
    v_pk_mul_f32 v[240:241], v[240:241], v[236:237] op_sel:[0,1] op_sel_hi:[1,1]
    v_pk_mul_f32 v[242:243], v[242:243], v[236:237] op_sel:[0,1] op_sel_hi:[1,1]
    v_pk_mul_f32 v[244:245], v[244:245], v[236:237] op_sel:[0,1] op_sel_hi:[1,1]
    v_pk_mul_f32 v[246:247], v[246:247], v[236:237] op_sel:[0,1] op_sel_hi:[1,1]
    v_cvt_pk_bf16_f32 v164, v240, v241
    v_cvt_pk_bf16_f32 v165, v242, v243
    v_cvt_pk_bf16_f32 v166, v244, v245
    v_cvt_pk_bf16_f32 v167, v246, v247
    v_accvgpr_read_b32 v248, a152
    v_accvgpr_read_b32 v249, a153
    v_accvgpr_read_b32 v250, a154
    v_accvgpr_read_b32 v251, a155
    v_accvgpr_read_b32 v252, a156
    v_accvgpr_read_b32 v253, a157
    v_accvgpr_read_b32 v254, a158
    v_accvgpr_read_b32 v255, a159
    v_pk_mul_f32 v[248:249], v[248:249], v[238:239] op_sel:[0,0] op_sel_hi:[1,0]
    v_pk_mul_f32 v[250:251], v[250:251], v[238:239] op_sel:[0,0] op_sel_hi:[1,0]
    v_pk_mul_f32 v[252:253], v[252:253], v[238:239] op_sel:[0,0] op_sel_hi:[1,0]
    v_pk_mul_f32 v[254:255], v[254:255], v[238:239] op_sel:[0,0] op_sel_hi:[1,0]
    v_cvt_pk_bf16_f32 v196, v248, v249
    v_cvt_pk_bf16_f32 v197, v250, v251
    v_cvt_pk_bf16_f32 v198, v252, v253
    v_cvt_pk_bf16_f32 v199, v254, v255
    s_cmp_eq_u32 s94, 0
    s_cbranch_scc1 L_cs1
    ds_write_b128 v17, v[220:223] offset:7168
    ds_write_b128 v16, v[128:131] offset:14336
    ds_write_b128 v16, v[160:163] offset:15360
    ds_write_b128 v16, v[192:195] offset:16384
    ds_write_b128 v16, v[132:135] offset:21504
    ds_write_b128 v16, v[164:167] offset:22528
    ds_write_b128 v16, v[196:199] offset:23552
L_cn1:
    s_sub_u32 s73, s73, 1
    s_cbranch_scc1 L_cx
L_cb2:
    v_accvgpr_read_b32 v240, a208
    v_accvgpr_read_b32 v241, a209
    v_accvgpr_read_b32 v242, a210
    v_accvgpr_read_b32 v243, a211
    v_accvgpr_read_b32 v244, a212
    v_accvgpr_read_b32 v245, a213
    v_accvgpr_read_b32 v246, a214
    v_accvgpr_read_b32 v247, a215
    v_pk_mul_f32 v[240:241], v[240:241], v[238:239] op_sel:[0,1] op_sel_hi:[1,1]
    v_pk_mul_f32 v[242:243], v[242:243], v[238:239] op_sel:[0,1] op_sel_hi:[1,1]
    v_pk_mul_f32 v[244:245], v[244:245], v[238:239] op_sel:[0,1] op_sel_hi:[1,1]
    v_pk_mul_f32 v[246:247], v[246:247], v[238:239] op_sel:[0,1] op_sel_hi:[1,1]
    v_cvt_pk_bf16_f32 v224, v240, v241
    v_cvt_pk_bf16_f32 v225, v242, v243
    v_cvt_pk_bf16_f32 v226, v244, v245
    v_cvt_pk_bf16_f32 v227, v246, v247
    v_accvgpr_read_b32 v248, a32
    v_accvgpr_read_b32 v249, a33
    v_accvgpr_read_b32 v250, a34
    v_accvgpr_read_b32 v251, a35
    v_accvgpr_read_b32 v252, a36
    v_accvgpr_read_b32 v253, a37
    v_accvgpr_read_b32 v254, a38
    v_accvgpr_read_b32 v255, a39
    v_pk_mul_f32 v[248:249], v[248:249], v[236:237] op_sel:[0,0] op_sel_hi:[1,0]
    v_pk_mul_f32 v[250:251], v[250:251], v[236:237] op_sel:[0,0] op_sel_hi:[1,0]
    v_pk_mul_f32 v[252:253], v[252:253], v[236:237] op_sel:[0,0] op_sel_hi:[1,0]
    v_pk_mul_f32 v[254:255], v[254:255], v[236:237] op_sel:[0,0] op_sel_hi:[1,0]
    v_cvt_pk_bf16_f32 v136, v248, v249
    v_cvt_pk_bf16_f32 v137, v250, v251
    v_cvt_pk_bf16_f32 v138, v252, v253
    v_cvt_pk_bf16_f32 v139, v254, v255
    v_accvgpr_read_b32 v240, a96
    v_accvgpr_read_b32 v241, a97
    v_accvgpr_read_b32 v242, a98
    v_accvgpr_read_b32 v243, a99
    v_accvgpr_read_b32 v244, a100
    v_accvgpr_read_b32 v245, a101
    v_accvgpr_read_b32 v246, a102
    v_accvgpr_read_b32 v247, a103
    v_pk_mul_f32 v[240:241], v[240:241], v[236:237] op_sel:[0,1] op_sel_hi:[1,1]
    v_pk_mul_f32 v[242:243], v[242:243], v[236:237] op_sel:[0,1] op_sel_hi:[1,1]
    v_pk_mul_f32 v[244:245], v[244:245], v[236:237] op_sel:[0,1] op_sel_hi:[1,1]
    v_pk_mul_f32 v[246:247], v[246:247], v[236:237] op_sel:[0,1] op_sel_hi:[1,1]
    v_cvt_pk_bf16_f32 v168, v240, v241
    v_cvt_pk_bf16_f32 v169, v242, v243
    v_cvt_pk_bf16_f32 v170, v244, v245
    v_cvt_pk_bf16_f32 v171, v246, v247
    v_accvgpr_read_b32 v248, a160
    v_accvgpr_read_b32 v249, a161
    v_accvgpr_read_b32 v250, a162
    v_accvgpr_read_b32 v251, a163
    v_accvgpr_read_b32 v252, a164
    v_accvgpr_read_b32 v253, a165
    v_accvgpr_read_b32 v254, a166
    v_accvgpr_read_b32 v255, a167
    v_pk_mul_f32 v[248:249], v[248:249], v[238:239] op_sel:[0,0] op_sel_hi:[1,0]
    v_pk_mul_f32 v[250:251], v[250:251], v[238:239] op_sel:[0,0] op_sel_hi:[1,0]
    v_pk_mul_f32 v[252:253], v[252:253], v[238:239] op_sel:[0,0] op_sel_hi:[1,0]
    v_pk_mul_f32 v[254:255], v[254:255], v[238:239] op_sel:[0,0] op_sel_hi:[1,0]
    v_cvt_pk_bf16_f32 v200, v248, v249
    v_cvt_pk_bf16_f32 v201, v250, v251
    v_cvt_pk_bf16_f32 v202, v252, v253
    v_cvt_pk_bf16_f32 v203, v254, v255
    v_accvgpr_read_b32 v240, a40
    v_accvgpr_read_b32 v241, a41
    v_accvgpr_read_b32 v242, a42
    v_accvgpr_read_b32 v243, a43
    v_accvgpr_read_b32 v244, a44
    v_accvgpr_read_b32 v245, a45
    v_accvgpr_read_b32 v246, a46
    v_accvgpr_read_b32 v247, a47
    v_pk_mul_f32 v[240:241], v[240:241], v[236:237] op_sel:[0,0] op_sel_hi:[1,0]
    v_pk_mul_f32 v[242:243], v[242:243], v[236:237] op_sel:[0,0] op_sel_hi:[1,0]
    v_pk_mul_f32 v[244:245], v[244:245], v[236:237] op_sel:[0,0] op_sel_hi:[1,0]
    v_pk_mul_f32 v[246:247], v[246:247], v[236:237] op_sel:[0,0] op_sel_hi:[1,0]
    v_cvt_pk_bf16_f32 v140, v240, v241
    v_cvt_pk_bf16_f32 v141, v242, v243
    v_cvt_pk_bf16_f32 v142, v244, v245
    v_cvt_pk_bf16_f32 v143, v246, v247
    v_accvgpr_read_b32 v248, a104
    v_accvgpr_read_b32 v249, a105
    v_accvgpr_read_b32 v250, a106
    v_accvgpr_read_b32 v251, a107
    v_accvgpr_read_b32 v252, a108
    v_accvgpr_read_b32 v253, a109
    v_accvgpr_read_b32 v254, a110
    v_accvgpr_read_b32 v255, a111
    v_pk_mul_f32 v[248:249], v[248:249], v[236:237] op_sel:[0,1] op_sel_hi:[1,1]
    v_pk_mul_f32 v[250:251], v[250:251], v[236:237] op_sel:[0,1] op_sel_hi:[1,1]
    v_pk_mul_f32 v[252:253], v[252:253], v[236:237] op_sel:[0,1] op_sel_hi:[1,1]
    v_pk_mul_f32 v[254:255], v[254:255], v[236:237] op_sel:[0,1] op_sel_hi:[1,1]
    v_cvt_pk_bf16_f32 v172, v248, v249
    v_cvt_pk_bf16_f32 v173, v250, v251
    v_cvt_pk_bf16_f32 v174, v252, v253
    v_cvt_pk_bf16_f32 v175, v254, v255
    v_accvgpr_read_b32 v240, a168
    v_accvgpr_read_b32 v241, a169
    v_accvgpr_read_b32 v242, a170
    v_accvgpr_read_b32 v243, a171
    v_accvgpr_read_b32 v244, a172
    v_accvgpr_read_b32 v245, a173
    v_accvgpr_read_b32 v246, a174
    v_accvgpr_read_b32 v247, a175
    v_pk_mul_f32 v[240:241], v[240:241], v[238:239] op_sel:[0,0] op_sel_hi:[1,0]
    v_pk_mul_f32 v[242:243], v[242:243], v[238:239] op_sel:[0,0] op_sel_hi:[1,0]
    v_pk_mul_f32 v[244:245], v[244:245], v[238:239] op_sel:[0,0] op_sel_hi:[1,0]
    v_pk_mul_f32 v[246:247], v[246:247], v[238:239] op_sel:[0,0] op_sel_hi:[1,0]
    v_cvt_pk_bf16_f32 v204, v240, v241
    v_cvt_pk_bf16_f32 v205, v242, v243
    v_cvt_pk_bf16_f32 v206, v244, v245
    v_cvt_pk_bf16_f32 v207, v246, v247
    s_cmp_eq_u32 s94, 0
    s_cbranch_scc1 L_cs2
    ds_write_b128 v17, v[224:227] offset:14336
    ds_write_b128 v16, v[136:139] offset:28672
    ds_write_b128 v16, v[168:171] offset:29696
    ds_write_b128 v16, v[200:203] offset:30720
    ds_write_b128 v16, v[140:143] offset:35840
    ds_write_b128 v16, v[172:175] offset:36864
    ds_write_b128 v16, v[204:207] offset:37888
L_cn2:
    s_sub_u32 s73, s73, 1
    s_cbranch_scc1 L_cx
L_cb3:
    v_accvgpr_read_b32 v248, a216
    v_accvgpr_read_b32 v249, a217
    v_accvgpr_read_b32 v250, a218
    v_accvgpr_read_b32 v251, a219
    v_accvgpr_read_b32 v252, a220
    v_accvgpr_read_b32 v253, a221
    v_accvgpr_read_b32 v254, a222
    v_accvgpr_read_b32 v255, a223
    v_pk_mul_f32 v[248:249], v[248:249], v[238:239] op_sel:[0,1] op_sel_hi:[1,1]
    v_pk_mul_f32 v[250:251], v[250:251], v[238:239] op_sel:[0,1] op_sel_hi:[1,1]
    v_pk_mul_f32 v[252:253], v[252:253], v[238:239] op_sel:[0,1] op_sel_hi:[1,1]
    v_pk_mul_f32 v[254:255], v[254:255], v[238:239] op_sel:[0,1] op_sel_hi:[1,1]
    v_cvt_pk_bf16_f32 v228, v248, v249
    v_cvt_pk_bf16_f32 v229, v250, v251
    v_cvt_pk_bf16_f32 v230, v252, v253
    v_cvt_pk_bf16_f32 v231, v254, v255
    v_accvgpr_read_b32 v240, a48
    v_accvgpr_read_b32 v241, a49
    v_accvgpr_read_b32 v242, a50
    v_accvgpr_read_b32 v243, a51
    v_accvgpr_read_b32 v244, a52
    v_accvgpr_read_b32 v245, a53
    v_accvgpr_read_b32 v246, a54
    v_accvgpr_read_b32 v247, a55
    v_pk_mul_f32 v[240:241], v[240:241], v[236:237] op_sel:[0,0] op_sel_hi:[1,0]
    v_pk_mul_f32 v[242:243], v[242:243], v[236:237] op_sel:[0,0] op_sel_hi:[1,0]
    v_pk_mul_f32 v[244:245], v[244:245], v[236:237] op_sel:[0,0] op_sel_hi:[1,0]
    v_pk_mul_f32 v[246:247], v[246:247], v[236:237] op_sel:[0,0] op_sel_hi:[1,0]
    v_cvt_pk_bf16_f32 v144, v240, v241
    v_cvt_pk_bf16_f32 v145, v242, v243
    v_cvt_pk_bf16_f32 v146, v244, v245
    v_cvt_pk_bf16_f32 v147, v246, v247
    v_accvgpr_read_b32 v248, a112
    v_accvgpr_read_b32 v249, a113
    v_accvgpr_read_b32 v250, a114
    v_accvgpr_read_b32 v251, a115
    v_accvgpr_read_b32 v252, a116
    v_accvgpr_read_b32 v253, a117
    v_accvgpr_read_b32 v254, a118
    v_accvgpr_read_b32 v255, a119
    v_pk_mul_f32 v[248:249], v[248:249], v[236:237] op_sel:[0,1] op_sel_hi:[1,1]
    v_pk_mul_f32 v[250:251], v[250:251], v[236:237] op_sel:[0,1] op_sel_hi:[1,1]
    v_pk_mul_f32 v[252:253], v[252:253], v[236:237] op_sel:[0,1] op_sel_hi:[1,1]
    v_pk_mul_f32 v[254:255], v[254:255], v[236:237] op_sel:[0,1] op_sel_hi:[1,1]
    v_cvt_pk_bf16_f32 v176, v248, v249
    v_cvt_pk_bf16_f32 v177, v250, v251
    v_cvt_pk_bf16_f32 v178, v252, v253
    v_cvt_pk_bf16_f32 v179, v254, v255
    v_accvgpr_read_b32 v240, a176
    v_accvgpr_read_b32 v241, a177
    v_accvgpr_read_b32 v242, a178
    v_accvgpr_read_b32 v243, a179
    v_accvgpr_read_b32 v244, a180
    v_accvgpr_read_b32 v245, a181
    v_accvgpr_read_b32 v246, a182
    v_accvgpr_read_b32 v247, a183
    v_pk_mul_f32 v[240:241], v[240:241], v[238:239] op_sel:[0,0] op_sel_hi:[1,0]
    v_pk_mul_f32 v[242:243], v[242:243], v[238:239] op_sel:[0,0] op_sel_hi:[1,0]
    v_pk_mul_f32 v[244:245], v[244:245], v[238:239] op_sel:[0,0] op_sel_hi:[1,0]
    v_pk_mul_f32 v[246:247], v[246:247], v[238:239] op_sel:[0,0] op_sel_hi:[1,0]
    v_cvt_pk_bf16_f32 v208, v240, v241
    v_cvt_pk_bf16_f32 v209, v242, v243
    v_cvt_pk_bf16_f32 v210, v244, v245
    v_cvt_pk_bf16_f32 v211, v246, v247
    v_accvgpr_read_b32 v248, a56
    v_accvgpr_read_b32 v249, a57
    v_accvgpr_read_b32 v250, a58
    v_accvgpr_read_b32 v251, a59
    v_accvgpr_read_b32 v252, a60
    v_accvgpr_read_b32 v253, a61
    v_accvgpr_read_b32 v254, a62
    v_accvgpr_read_b32 v255, a63
    v_pk_mul_f32 v[248:249], v[248:249], v[236:237] op_sel:[0,0] op_sel_hi:[1,0]
    v_pk_mul_f32 v[250:251], v[250:251], v[236:237] op_sel:[0,0] op_sel_hi:[1,0]
    v_pk_mul_f32 v[252:253], v[252:253], v[236:237] op_sel:[0,0] op_sel_hi:[1,0]
    v_pk_mul_f32 v[254:255], v[254:255], v[236:237] op_sel:[0,0] op_sel_hi:[1,0]
    v_cvt_pk_bf16_f32 v148, v248, v249
    v_cvt_pk_bf16_f32 v149, v250, v251
    v_cvt_pk_bf16_f32 v150, v252, v253
    v_cvt_pk_bf16_f32 v151, v254, v255
    v_accvgpr_read_b32 v240, a120
    v_accvgpr_read_b32 v241, a121
    v_accvgpr_read_b32 v242, a122
    v_accvgpr_read_b32 v243, a123
    v_accvgpr_read_b32 v244, a124
    v_accvgpr_read_b32 v245, a125
    v_accvgpr_read_b32 v246, a126
    v_accvgpr_read_b32 v247, a127
    v_pk_mul_f32 v[240:241], v[240:241], v[236:237] op_sel:[0,1] op_sel_hi:[1,1]
    v_pk_mul_f32 v[242:243], v[242:243], v[236:237] op_sel:[0,1] op_sel_hi:[1,1]
    v_pk_mul_f32 v[244:245], v[244:245], v[236:237] op_sel:[0,1] op_sel_hi:[1,1]
    v_pk_mul_f32 v[246:247], v[246:247], v[236:237] op_sel:[0,1] op_sel_hi:[1,1]
    v_cvt_pk_bf16_f32 v180, v240, v241
    v_cvt_pk_bf16_f32 v181, v242, v243
    v_cvt_pk_bf16_f32 v182, v244, v245
    v_cvt_pk_bf16_f32 v183, v246, v247
    v_accvgpr_read_b32 v248, a184
    v_accvgpr_read_b32 v249, a185
    v_accvgpr_read_b32 v250, a186
    v_accvgpr_read_b32 v251, a187
    v_accvgpr_read_b32 v252, a188
    v_accvgpr_read_b32 v253, a189
    v_accvgpr_read_b32 v254, a190
    v_accvgpr_read_b32 v255, a191
    v_pk_mul_f32 v[248:249], v[248:249], v[238:239] op_sel:[0,0] op_sel_hi:[1,0]
    v_pk_mul_f32 v[250:251], v[250:251], v[238:239] op_sel:[0,0] op_sel_hi:[1,0]
    v_pk_mul_f32 v[252:253], v[252:253], v[238:239] op_sel:[0,0] op_sel_hi:[1,0]
    v_pk_mul_f32 v[254:255], v[254:255], v[238:239] op_sel:[0,0] op_sel_hi:[1,0]
    v_cvt_pk_bf16_f32 v212, v248, v249
    v_cvt_pk_bf16_f32 v213, v250, v251
    v_cvt_pk_bf16_f32 v214, v252, v253
    v_cvt_pk_bf16_f32 v215, v254, v255
    s_cmp_eq_u32 s94, 0
    s_cbranch_scc1 L_cs3
    ds_write_b128 v17, v[228:231] offset:21504
    ds_write_b128 v16, v[144:147] offset:43008
    ds_write_b128 v16, v[176:179] offset:44032
    ds_write_b128 v16, v[208:211] offset:45056
    ds_write_b128 v16, v[148:151] offset:50176
    ds_write_b128 v16, v[180:183] offset:51200
    ds_write_b128 v16, v[212:215] offset:52224
L_cn3:
    s_sub_u32 s73, s73, 1
    s_cbranch_scc0 L_cb0
L_cx:
    s_cmp_eq_u32 s94, 0
    s_cbranch_scc1 L_cxs
    s_waitcnt vmcnt(8) lgkmcnt(0)
L_op:
    s_barrier
    ds_read_b128 a[0:3], v4 offset:0
    ds_read_b128 a[28:31], v4 offset:7168
    ds_read_b128 a[4:7], v4 offset:1024
    ds_read_b128 a[32:35], v4 offset:8192
    ds_read_b128 a[8:11], v4 offset:2048
    ds_read_b128 a[36:39], v4 offset:9216
    ds_read_b128 a[12:15], v4 offset:3072
    ds_read_b128 a[40:43], v4 offset:10240
    ds_read_b128 a[16:19], v4 offset:4096
    ds_read_b128 a[44:47], v4 offset:11264
    s_waitcnt lgkmcnt(6)
    v_mfma_f32_16x16x32_bf16 v[64:67], v[32:35], a[0:3], 0
    s_lshl_b32 s83, s76, 7
    ds_read_b128 a[20:23], v4 offset:5120
    v_and_b32 v7, 48, v26
    v_mfma_f32_16x16x32_bf16 v[64:67], v[36:39], a[28:31], v[64:67]
    s_add_u32 s83, s83, s88
    ds_read_b128 a[48:51], v4 offset:12288
    v_lshlrev_b32 v7, 6, v7
    v_mfma_f32_16x16x32_bf16 v[68:71], v[32:35], a[4:7], 0
    s_add_u32 s76, s76, 1
    ds_read_b128 a[24:27], v4 offset:6144
    v_add_u32 v7, 157696, v7
    v_mfma_f32_16x16x32_bf16 v[68:71], v[36:39], a[32:35], v[68:71]
    s_waitcnt lgkmcnt(5)
    ds_read_b128 a[52:55], v4 offset:13312
    v_readfirstlane_b32 s86, v1
    v_mfma_f32_16x16x32_bf16 v[72:75], v[32:35], a[8:11], 0
    s_cmp_lt_u32 s86, 16
    s_cbranch_scc1 L_rdy
    L_rdyok:
    ds_read_b64_tr_b16 v[40:41], v0 offset:33024
    v_add_u32 v10, 66560, v0
    v_mfma_f32_16x16x32_bf16 v[72:75], v[36:39], a[36:39], v[72:75]
    s_cmp_ge_u32 s76, 7
    s_cselect_b32 s76, 0, s76
    ds_read_b64_tr_b16 v[42:43], v0 offset:33536
    v_lshrrev_b32_e64 v2, 6, v26
    v_mfma_f32_16x16x32_bf16 v[76:79], v[32:35], a[12:15], 0
    s_add_u32 m0, s74, 0
    ds_read_b64_tr_b16 v[44:45], v0 offset:34048
    v_or_b32_e64 v2, s94, v2
    v_mfma_f32_16x16x32_bf16 v[76:79], v[36:39], a[40:43], v[76:79]
    s_waitcnt lgkmcnt(5)
    ds_read_b64_tr_b16 v[46:47], v0 offset:34560
    v_min_u32_e64 v2, 1, v2
    v_mfma_f32_16x16x32_bf16 v[80:83], v[32:35], a[16:19], 0
    ds_read_b128 a[56:59], v4 offset:14336
    v_lshlrev_b32_e64 v2, 31, v2
    v_mfma_f32_16x16x32_bf16 v[80:83], v[36:39], a[44:47], v[80:83]
    ds_read_b128 a[84:87], v4 offset:21504
    v_lshl_or_b32 v25, v26, 2, v2
    v_mfma_f32_16x16x32_bf16 v[84:87], v[32:35], a[20:23], 0
    ds_read_b128 a[60:63], v4 offset:15360
    v_mfma_f32_16x16x32_bf16 v[84:87], v[36:39], a[48:51], v[84:87]
    s_waitcnt lgkmcnt(7)
    ds_read_b128 a[88:91], v4 offset:22528
    v_mfma_f32_16x16x32_bf16 v[88:91], v[32:35], a[24:27], 0
    ds_read_b64_tr_b16 v[48:49], v0 offset:2048
    v_mfma_f32_16x16x32_bf16 v[88:91], v[36:39], a[52:55], v[88:91]
    s_waitcnt lgkmcnt(5)
    ds_read_b64_tr_b16 v[50:51], v0 offset:2560
    v_mfma_f32_16x16x32_bf16 v[92:95], v[40:43], a[0:3], 0
    ds_read_b64_tr_b16 v[52:53], v0 offset:3072
    v_mfma_f32_16x16x32_bf16 v[92:95], v[44:47], a[28:31], v[92:95]
    ds_read_b64_tr_b16 v[54:55], v0 offset:3584
    v_mfma_f32_16x16x32_bf16 v[96:99], v[40:43], a[4:7], 0
    ds_read_b128 a[64:67], v4 offset:16384
    v_mfma_f32_16x16x32_bf16 v[96:99], v[44:47], a[32:35], v[96:99]
    ds_read_b128 a[92:95], v4 offset:23552
    v_mfma_f32_16x16x32_bf16 v[100:103], v[40:43], a[8:11], 0
    ds_read_b128 a[68:71], v4 offset:17408
    v_mfma_f32_16x16x32_bf16 v[100:103], v[44:47], a[36:39], v[100:103]
    ds_read_b128 a[96:99], v4 offset:24576
    v_mfma_f32_16x16x32_bf16 v[104:107], v[40:43], a[12:15], 0
    ds_read_b128 a[72:75], v4 offset:18432
    v_mfma_f32_16x16x32_bf16 v[104:107], v[44:47], a[40:43], v[104:107]
    ds_read_b128 a[100:103], v4 offset:25600
    v_mfma_f32_16x16x32_bf16 v[108:111], v[40:43], a[16:19], 0
    ds_read_b32 v8, v7 offset:0
    v_mfma_f32_16x16x32_bf16 v[108:111], v[44:47], a[44:47], v[108:111]
    ds_read_b128 a[76:79], v4 offset:19456
    v_mfma_f32_16x16x32_bf16 v[112:115], v[40:43], a[20:23], 0
    ds_read_b128 a[104:107], v4 offset:26624
    v_mfma_f32_16x16x32_bf16 v[112:115], v[44:47], a[48:51], v[112:115]
    ds_read_b128 a[80:83], v4 offset:20480
    v_mfma_f32_16x16x32_bf16 v[116:119], v[40:43], a[24:27], 0
    ds_read_b128 a[108:111], v4 offset:27648
    v_mfma_f32_16x16x32_bf16 v[116:119], v[44:47], a[52:55], v[116:119]
    s_waitcnt lgkmcnt(10)
    ds_read_b64_tr_b16 v[56:57], v0 offset:35072
    v_mfma_f32_16x16x32_bf16 v[64:67], v[48:51], a[56:59], v[64:67]
    ds_read_b64_tr_b16 v[58:59], v0 offset:35584
    v_mfma_f32_16x16x32_bf16 v[64:67], v[52:55], a[84:87], v[64:67]
    ds_read_b64_tr_b16 v[60:61], v0 offset:36096
    v_mfma_f32_16x16x32_bf16 v[68:71], v[48:51], a[60:63], v[68:71]
    ds_read_b64_tr_b16 v[62:63], v0 offset:36608
    v_mfma_f32_16x16x32_bf16 v[68:71], v[52:55], a[88:91], v[68:71]
    ds_read_b64_tr_b16 v[32:33], v0 offset:16512
    v_mfma_f32_16x16x32_bf16 v[72:75], v[48:51], a[64:67], v[72:75]
    s_waitcnt lgkmcnt(5)
    ds_read_b64_tr_b16 v[34:35], v0 offset:17024
    v_cmp_ne_u32 vcc, 0, v8
    v_mfma_f32_16x16x32_bf16 v[72:75], v[52:55], a[92:95], v[72:75]
    s_nop 0
    s_cbranch_vccnz L_redo
    ds_read_b64_tr_b16 v[36:37], v0 offset:17536
    s_mov_b32 s52, 400000
    v_mfma_f32_16x16x32_bf16 v[76:79], v[48:51], a[68:71], v[76:79]
    s_mov_b32 s8, s28
    ds_read_b64_tr_b16 v[38:39], v0 offset:18048
    s_mov_b32 s9, s29
    v_mfma_f32_16x16x32_bf16 v[76:79], v[52:55], a[96:99], v[76:79]
    s_mov_b32 s10, s30
    ds_read_b64_tr_b16 v[40:41], v0 offset:49536
    s_mov_b32 s11, s31
    v_mfma_f32_16x16x32_bf16 v[80:83], v[48:51], a[72:75], v[80:83]
    s_lshl_b32 s72, s37, 8
    ds_read_b64_tr_b16 v[42:43], v0 offset:50048
    s_lshl_b32 s85, s3, 6
    v_mfma_f32_16x16x32_bf16 v[80:83], v[52:55], a[100:103], v[80:83]
    s_add_u32 s72, s72, s85
    ds_read_b64_tr_b16 v[44:45], v0 offset:50560
    s_add_u32 s72, s72, 2752512
    v_mfma_f32_16x16x32_bf16 v[84:87], v[48:51], a[76:79], v[84:87]
    s_mul_i32 s71, s37, 114688
    ds_read_b64_tr_b16 v[46:47], v0 offset:51072
    s_mul_i32 s85, s3, 28672
    v_mfma_f32_16x16x32_bf16 v[84:87], v[52:55], a[104:107], v[84:87]
    s_add_u32 s71, s71, s85
    ds_read_b128 a[112:115], v4 offset:28672
    s_lshr_b32 s85, s37, 1
    v_mfma_f32_16x16x32_bf16 v[88:91], v[48:51], a[80:83], v[88:91]
    s_lshl_b32 s68, 1, s85
    ds_read_b128 a[140:143], v4 offset:35840
    s_or_b32 s68, s68, 0xffffff00
    v_mfma_f32_16x16x32_bf16 v[88:91], v[52:55], a[108:111], v[88:91]
    s_waitcnt lgkmcnt(10)
    ds_read_b128 a[116:119], v4 offset:29696
    s_cmp_ge_u32 s37, 14
    s_cselect_b32 s68, -1, s68
    v_mfma_f32_16x16x32_bf16 v[92:95], v[56:59], a[56:59], v[92:95]
    s_mul_i32 s47, s37, 57344
    ds_read_b128 a[144:147], v4 offset:36864
    s_mul_i32 s85, s3, 14336
    v_mfma_f32_16x16x32_bf16 v[92:95], v[60:63], a[84:87], v[92:95]
    s_add_u32 s47, s47, s85
    ds_read_b128 a[120:123], v4 offset:30720
    s_add_u32 s47, s47, 1835008
    v_mfma_f32_16x16x32_bf16 v[96:99], v[56:59], a[60:63], v[96:99]
    s_add_u32 s82, s85, 99840
    ds_read_b128 a[148:151], v4 offset:37888
    s_mul_i32 s49, s89, 4294508544
    v_mfma_f32_16x16x32_bf16 v[96:99], v[60:63], a[88:91], v[96:99]
    s_add_u32 s49, s49, 229376
    ds_read_b128 a[124:127], v4 offset:31744
    v_mfma_f32_16x16x32_bf16 v[100:103], v[56:59], a[64:67], v[100:103]
    ds_read_b128 a[152:155], v4 offset:38912
    v_mfma_f32_16x16x32_bf16 v[100:103], v[60:63], a[92:95], v[100:103]
    ds_read_b128 a[128:131], v4 offset:32768
    v_mfma_f32_16x16x32_bf16 v[104:107], v[56:59], a[68:71], v[104:107]
    ds_read_b128 a[156:159], v4 offset:39936
    v_mfma_f32_16x16x32_bf16 v[104:107], v[60:63], a[96:99], v[104:107]
    ds_read_b128 a[132:135], v4 offset:33792
    v_mfma_f32_16x16x32_bf16 v[108:111], v[56:59], a[72:75], v[108:111]
    ds_read_b128 a[160:163], v4 offset:40960
    v_mfma_f32_16x16x32_bf16 v[108:111], v[60:63], a[100:103], v[108:111]
    ds_read_b64_tr_b16 v[48:49], v0 offset:18560
    v_mfma_f32_16x16x32_bf16 v[112:115], v[56:59], a[76:79], v[112:115]
    ds_read_b64_tr_b16 v[50:51], v0 offset:19072
    v_mfma_f32_16x16x32_bf16 v[112:115], v[60:63], a[104:107], v[112:115]
    ds_read_b64_tr_b16 v[52:53], v0 offset:19584
    v_mfma_f32_16x16x32_bf16 v[116:119], v[56:59], a[80:83], v[116:119]
    ds_read_b64_tr_b16 v[54:55], v0 offset:20096
    v_mfma_f32_16x16x32_bf16 v[116:119], v[60:63], a[108:111], v[116:119]
    s_waitcnt lgkmcnt(12)
    ds_read_b128 a[136:139], v4 offset:34816
    v_mfma_f32_16x16x32_bf16 v[64:67], v[32:35], a[112:115], v[64:67]
    ds_read_b128 a[164:167], v4 offset:41984
    v_mfma_f32_16x16x32_bf16 v[64:67], v[36:39], a[140:143], v[64:67]
    ds_read_b64_tr_b16 v[56:57], v0 offset:51584
    v_mfma_f32_16x16x32_bf16 v[68:71], v[32:35], a[116:119], v[68:71]
    ds_read_b64_tr_b16 v[58:59], v0 offset:52096
    v_mfma_f32_16x16x32_bf16 v[68:71], v[36:39], a[144:147], v[68:71]
    s_waitcnt vmcnt(0) lgkmcnt(9)
    ds_read_b64_tr_b16 v[60:61], v0 offset:52608
    v_mfma_f32_16x16x32_bf16 v[72:75], v[32:35], a[120:123], v[72:75]
    buffer_store_dword v5, v25, s[28:31], s48 offen sc1
    v_mfma_f32_16x16x32_bf16 v[72:75], v[36:39], a[148:151], v[72:75]
    ds_read_b64_tr_b16 v[62:63], v0 offset:53120
    v_mfma_f32_16x16x32_bf16 v[76:79], v[32:35], a[124:127], v[76:79]
    ds_read_b128 a[168:171], v4 offset:43008
    v_mfma_f32_16x16x32_bf16 v[76:79], v[36:39], a[152:155], v[76:79]
    ds_read_b128 a[196:199], v4 offset:50176
    v_mfma_f32_16x16x32_bf16 v[80:83], v[32:35], a[128:131], v[80:83]
    ds_read_b128 a[172:175], v4 offset:44032
    v_mfma_f32_16x16x32_bf16 v[80:83], v[36:39], a[156:159], v[80:83]
    ds_read_b128 a[200:203], v4 offset:51200
    v_mfma_f32_16x16x32_bf16 v[84:87], v[32:35], a[132:135], v[84:87]
    s_waitcnt vmcnt(1) lgkmcnt(4)
    ds_read_b128 a[176:179], v4 offset:45056
    s_barrier
    v_mfma_f32_16x16x32_bf16 v[84:87], v[36:39], a[160:163], v[84:87]
    buffer_load_dwordx4 v24, s[24:27], s83 offen lds
    v_mfma_f32_16x16x32_bf16 v[88:91], v[32:35], a[136:139], v[88:91]
    s_add_u32 s83, s83, 27648
    ds_read_b128 a[204:207], v4 offset:52224
    v_mfma_f32_16x16x32_bf16 v[88:91], v[36:39], a[164:167], v[88:91]
    ds_read_b128 a[180:183], v4 offset:46080
    v_mfma_f32_16x16x32_bf16 v[92:95], v[40:43], a[112:115], v[92:95]
    buffer_load_dwordx4 v24, s[24:27], s83 offen offset:1024 lds
    v_mfma_f32_16x16x32_bf16 v[92:95], v[44:47], a[140:143], v[92:95]
    s_add_u32 s83, s83, 27648
    ds_read_b128 a[208:211], v4 offset:53248
    v_mfma_f32_16x16x32_bf16 v[96:99], v[40:43], a[116:119], v[96:99]
    buffer_load_dwordx4 v24, s[24:27], s83 offen offset:2048 lds
    v_mfma_f32_16x16x32_bf16 v[96:99], v[44:47], a[144:147], v[96:99]
    s_add_u32 s83, s83, 27648
    ds_read_b128 a[184:187], v4 offset:47104
    v_mfma_f32_16x16x32_bf16 v[100:103], v[40:43], a[120:123], v[100:103]
    buffer_load_dwordx4 v24, s[24:27], s83 offen offset:3072 lds
    v_mfma_f32_16x16x32_bf16 v[100:103], v[44:47], a[148:151], v[100:103]
    s_add_u32 s83, s83, 31744
    ds_read_b128 a[212:215], v4 offset:54272
    s_add_u32 m0, s74, 16512
    v_mfma_f32_16x16x32_bf16 v[104:107], v[40:43], a[124:127], v[104:107]
    buffer_load_dwordx4 v24, s[24:27], s83 offen lds
    v_mfma_f32_16x16x32_bf16 v[104:107], v[44:47], a[152:155], v[104:107]
    s_add_u32 s83, s83, 27648
    ds_read_b128 a[188:191], v4 offset:48128
    v_mfma_f32_16x16x32_bf16 v[108:111], v[40:43], a[128:131], v[108:111]
    buffer_load_dwordx4 v24, s[24:27], s83 offen offset:1024 lds
    v_mfma_f32_16x16x32_bf16 v[108:111], v[44:47], a[156:159], v[108:111]
    s_add_u32 s83, s83, 27648
    ds_read_b128 a[216:219], v4 offset:55296
    v_mfma_f32_16x16x32_bf16 v[112:115], v[40:43], a[132:135], v[112:115]
    ds_read_b64_tr_b16 v[32:33], v10 offset:0
    v_mfma_f32_16x16x32_bf16 v[112:115], v[44:47], a[160:163], v[112:115]
    ds_read_b64_tr_b16 v[34:35], v10 offset:512
    v_mfma_f32_16x16x32_bf16 v[116:119], v[40:43], a[136:139], v[116:119]
    ds_read_b64_tr_b16 v[36:37], v10 offset:1024
    v_mfma_f32_16x16x32_bf16 v[116:119], v[44:47], a[164:167], v[116:119]
    s_waitcnt lgkmcnt(3)
    ds_read_b64_tr_b16 v[38:39], v10 offset:1536
    v_mfma_f32_16x16x32_bf16 v[64:67], v[48:51], a[168:171], v[64:67]
    buffer_load_dwordx4 v24, s[24:27], s83 offen offset:2048 lds
    v_mfma_f32_16x16x32_bf16 v[64:67], v[52:55], a[196:199], v[64:67]
    s_add_u32 s83, s83, 27648
    ds_read_b128 a[192:195], v4 offset:49152
    v_mfma_f32_16x16x32_bf16 v[68:71], v[48:51], a[172:175], v[68:71]
    ds_read_b128 a[220:223], v4 offset:56320
    v_mfma_f32_16x16x32_bf16 v[68:71], v[52:55], a[200:203], v[68:71]
    buffer_load_dwordx4 v24, s[24:27], s83 offen offset:3072 lds
    v_mfma_f32_16x16x32_bf16 v[72:75], v[48:51], a[176:179], v[72:75]
    s_lshl_b32 s83, s76, 7
    ds_read_b64_tr_b16 v[40:41], v10 offset:2048
    s_add_u32 s83, s83, s88
    v_mfma_f32_16x16x32_bf16 v[72:75], v[52:55], a[204:207], v[72:75]
    s_add_u32 s76, s76, 1
    ds_read_b64_tr_b16 v[42:43], v10 offset:2560
    s_cmp_ge_u32 s76, 7
    s_cselect_b32 s76, 0, s76
    v_mfma_f32_16x16x32_bf16 v[76:79], v[48:51], a[180:183], v[76:79]
    s_add_u32 m0, s74, 33024
    ds_read_b64_tr_b16 v[44:45], v10 offset:3072
    v_mfma_f32_16x16x32_bf16 v[76:79], v[52:55], a[208:211], v[76:79]
    buffer_load_dwordx4 v24, s[24:27], s83 offen lds
    v_mfma_f32_16x16x32_bf16 v[80:83], v[48:51], a[184:187], v[80:83]
    s_add_u32 s83, s83, 27648
    ds_read_b64_tr_b16 v[46:47], v10 offset:3584
    v_mfma_f32_16x16x32_bf16 v[80:83], v[52:55], a[212:215], v[80:83]
    buffer_load_dwordx4 v24, s[24:27], s83 offen offset:1024 lds
    v_mfma_f32_16x16x32_bf16 v[84:87], v[48:51], a[188:191], v[84:87]
    s_add_u32 s83, s83, 27648
    v_mfma_f32_16x16x32_bf16 v[84:87], v[52:55], a[216:219], v[84:87]
    s_waitcnt lgkmcnt(4)
    v_mfma_f32_16x16x32_bf16 v[88:91], v[48:51], a[192:195], v[88:91]
    ds_read_b64_tr_b16 v[48:49], v10 offset:16512
    v_mfma_f32_16x16x32_bf16 v[88:91], v[52:55], a[220:223], v[88:91]
    ds_read_b64_tr_b16 v[50:51], v10 offset:17024
    v_mfma_f32_16x16x32_bf16 v[92:95], v[56:59], a[168:171], v[92:95]
    buffer_load_dwordx4 v24, s[24:27], s83 offen offset:2048 lds
    v_mfma_f32_16x16x32_bf16 v[92:95], v[60:63], a[196:199], v[92:95]
    s_add_u32 s83, s83, 27648
    ds_read_b64_tr_b16 v[52:53], v10 offset:17536
    v_mfma_f32_16x16x32_bf16 v[96:99], v[56:59], a[172:175], v[96:99]
    ds_read_b64_tr_b16 v[54:55], v10 offset:18048
    v_mfma_f32_16x16x32_bf16 v[96:99], v[60:63], a[200:203], v[96:99]
    buffer_load_dwordx4 v24, s[24:27], s83 offen offset:3072 lds
    v_mfma_f32_16x16x32_bf16 v[100:103], v[56:59], a[176:179], v[100:103]
    s_add_u32 s83, s83, 31744
    s_add_u32 m0, s74, 49536
    v_mfma_f32_16x16x32_bf16 v[100:103], v[60:63], a[204:207], v[100:103]
    v_mfma_f32_16x16x32_bf16 v[104:107], v[56:59], a[180:183], v[104:107]
    v_mfma_f32_16x16x32_bf16 v[104:107], v[60:63], a[208:211], v[104:107]
    buffer_load_dwordx4 v24, s[24:27], s83 offen lds
    v_mfma_f32_16x16x32_bf16 v[108:111], v[56:59], a[184:187], v[108:111]
    s_add_u32 s83, s83, 27648
    v_mfma_f32_16x16x32_bf16 v[108:111], v[60:63], a[212:215], v[108:111]
    v_mfma_f32_16x16x32_bf16 v[112:115], v[56:59], a[188:191], v[112:115]
    v_mfma_f32_16x16x32_bf16 v[112:115], v[60:63], a[216:219], v[112:115]
    buffer_load_dwordx4 v24, s[24:27], s83 offen offset:1024 lds
    v_mfma_f32_16x16x32_bf16 v[116:119], v[56:59], a[192:195], v[116:119]
    s_add_u32 s83, s83, 27648
    ds_read_b64_tr_b16 v[56:57], v10 offset:18560
    v_mfma_f32_16x16x32_bf16 v[116:119], v[60:63], a[220:223], v[116:119]
    ds_read_b64_tr_b16 v[58:59], v10 offset:19072
    v_mfma_f32_16x16x32_bf16 v[120:123], v[32:35], a[0:3], 0
    ds_read_b64_tr_b16 v[60:61], v10 offset:19584
    v_mfma_f32_16x16x32_bf16 v[120:123], v[36:39], a[28:31], v[120:123]
    buffer_load_dwordx4 v24, s[24:27], s83 offen offset:2048 lds
    v_mfma_f32_16x16x32_bf16 v[124:127], v[32:35], a[4:7], 0
    s_add_u32 s83, s83, 27648
    ds_read_b64_tr_b16 v[62:63], v10 offset:20096
    v_mfma_f32_16x16x32_bf16 v[124:127], v[36:39], a[32:35], v[124:127]
    v_mfma_f32_16x16x32_bf16 v[128:131], v[32:35], a[8:11], 0
    v_mfma_f32_16x16x32_bf16 v[128:131], v[36:39], a[36:39], v[128:131]
    buffer_load_dwordx4 v24, s[24:27], s83 offen offset:3072 lds
    v_mfma_f32_16x16x32_bf16 v[132:135], v[32:35], a[12:15], 0
    s_lshl_b32 s83, s76, 7
    s_add_u32 s83, s83, s88
    s_add_u32 s76, s76, 1
    v_mfma_f32_16x16x32_bf16 v[132:135], v[36:39], a[40:43], v[132:135]
    s_cmp_ge_u32 s76, 7
    s_cselect_b32 s76, 0, s76
    s_waitcnt vmcnt(8) lgkmcnt(0)
    s_barrier
    v_mfma_f32_16x16x32_bf16 v[136:139], v[32:35], a[16:19], 0
    s_add_u32 m0, s74, 66560
    v_mfma_f32_16x16x32_bf16 v[136:139], v[36:39], a[44:47], v[136:139]
    v_mfma_f32_16x16x32_bf16 v[140:143], v[32:35], a[20:23], 0
    v_mfma_f32_16x16x32_bf16 v[140:143], v[36:39], a[48:51], v[140:143]
    buffer_load_dwordx4 v24, s[24:27], s83 offen lds
    v_mfma_f32_16x16x32_bf16 v[144:147], v[32:35], a[24:27], 0
    s_add_u32 s83, s83, 27648
    ds_read_b64_tr_b16 v[32:33], v0 offset:0
    v_mfma_f32_16x16x32_bf16 v[144:147], v[36:39], a[52:55], v[144:147]
    ds_read_b64_tr_b16 v[34:35], v0 offset:512
    v_mfma_f32_16x16x32_bf16 v[120:123], v[40:43], a[56:59], v[120:123]
    ds_read_b64_tr_b16 v[36:37], v0 offset:1024
    v_mfma_f32_16x16x32_bf16 v[120:123], v[44:47], a[84:87], v[120:123]
    ds_read_b64_tr_b16 v[38:39], v0 offset:1536
    v_mfma_f32_16x16x32_bf16 v[124:127], v[40:43], a[60:63], v[124:127]
    buffer_load_dwordx4 v24, s[24:27], s83 offen offset:1024 lds
    v_mfma_f32_16x16x32_bf16 v[124:127], v[44:47], a[88:91], v[124:127]
    s_add_u32 s83, s83, 27648
    v_mfma_f32_16x16x32_bf16 v[128:131], v[40:43], a[64:67], v[128:131]
    v_mfma_f32_16x16x32_bf16 v[128:131], v[44:47], a[92:95], v[128:131]
    v_mfma_f32_16x16x32_bf16 v[132:135], v[40:43], a[68:71], v[132:135]
    v_mfma_f32_16x16x32_bf16 v[132:135], v[44:47], a[96:99], v[132:135]
    buffer_load_dwordx4 v24, s[24:27], s83 offen offset:2048 lds
    v_mfma_f32_16x16x32_bf16 v[136:139], v[40:43], a[72:75], v[136:139]
    buffer_load_dword v2, v3, s[28:31], s72 offen sc1
    v_mfma_f32_16x16x32_bf16 v[136:139], v[44:47], a[100:103], v[136:139]
    s_add_u32 s83, s83, 27648
    v_mfma_f32_16x16x32_bf16 v[140:143], v[40:43], a[76:79], v[140:143]
    v_mfma_f32_16x16x32_bf16 v[140:143], v[44:47], a[104:107], v[140:143]
    v_mfma_f32_16x16x32_bf16 v[144:147], v[40:43], a[80:83], v[144:147]
    buffer_load_dwordx4 v24, s[24:27], s83 offen offset:3072 lds
    v_mfma_f32_16x16x32_bf16 v[144:147], v[44:47], a[108:111], v[144:147]
    ds_read_b64_tr_b16 v[40:41], v0 offset:2048
    s_add_u32 s83, s83, 31744
    v_mfma_f32_16x16x32_bf16 v[120:123], v[48:51], a[112:115], v[120:123]
    s_add_u32 m0, s74, 83072
    ds_read_b64_tr_b16 v[42:43], v0 offset:2560
    v_mfma_f32_16x16x32_bf16 v[120:123], v[52:55], a[140:143], v[120:123]
    ds_read_b64_tr_b16 v[44:45], v0 offset:3072
    v_mfma_f32_16x16x32_bf16 v[124:127], v[48:51], a[116:119], v[124:127]
    ds_read_b64_tr_b16 v[46:47], v0 offset:3584
    v_mfma_f32_16x16x32_bf16 v[124:127], v[52:55], a[144:147], v[124:127]
    buffer_load_dwordx4 v24, s[24:27], s83 offen lds
    v_mfma_f32_16x16x32_bf16 v[128:131], v[48:51], a[120:123], v[128:131]
    s_add_u32 s83, s83, 27648
    v_mfma_f32_16x16x32_bf16 v[128:131], v[52:55], a[148:151], v[128:131]
    v_mfma_f32_16x16x32_bf16 v[132:135], v[48:51], a[124:127], v[132:135]
    v_mfma_f32_16x16x32_bf16 v[132:135], v[52:55], a[152:155], v[132:135]
    v_mfma_f32_16x16x32_bf16 v[136:139], v[48:51], a[128:131], v[136:139]
    buffer_load_dwordx4 v24, s[24:27], s83 offen offset:1024 lds
    v_mfma_f32_16x16x32_bf16 v[136:139], v[52:55], a[156:159], v[136:139]
    s_add_u32 s83, s83, 27648
    v_mfma_f32_16x16x32_bf16 v[140:143], v[48:51], a[132:135], v[140:143]
    v_mfma_f32_16x16x32_bf16 v[140:143], v[52:55], a[160:163], v[140:143]
    v_mfma_f32_16x16x32_bf16 v[144:147], v[48:51], a[136:139], v[144:147]
    ds_read_b64_tr_b16 v[48:49], v0 offset:16512
    v_mfma_f32_16x16x32_bf16 v[144:147], v[52:55], a[164:167], v[144:147]
    ds_read_b64_tr_b16 v[50:51], v0 offset:17024
    v_mfma_f32_16x16x32_bf16 v[120:123], v[56:59], a[168:171], v[120:123]
    buffer_load_dwordx4 v24, s[24:27], s83 offen offset:2048 lds
    v_mfma_f32_16x16x32_bf16 v[120:123], v[60:63], a[196:199], v[120:123]
    s_add_u32 s83, s83, 27648
    ds_read_b64_tr_b16 v[52:53], v0 offset:17536
    v_mfma_f32_16x16x32_bf16 v[124:127], v[56:59], a[172:175], v[124:127]
    ds_read_b64_tr_b16 v[54:55], v0 offset:18048
    v_mfma_f32_16x16x32_bf16 v[124:127], v[60:63], a[200:203], v[124:127]
    v_mfma_f32_16x16x32_bf16 v[128:131], v[56:59], a[176:179], v[128:131]
    buffer_load_dwordx4 v24, s[24:27], s83 offen offset:3072 lds
    v_mfma_f32_16x16x32_bf16 v[128:131], v[60:63], a[204:207], v[128:131]
    s_lshl_b32 s83, s76, 7
    s_add_u32 s83, s83, s88
    s_add_u32 s76, s76, 1
    v_mfma_f32_16x16x32_bf16 v[132:135], v[56:59], a[180:183], v[132:135]
    s_cmp_ge_u32 s76, 7
    s_cselect_b32 s76, 0, s76
    s_add_u32 m0, s74, 0
    v_mfma_f32_16x16x32_bf16 v[132:135], v[60:63], a[208:211], v[132:135]
    v_mfma_f32_16x16x32_bf16 v[136:139], v[56:59], a[184:187], v[136:139]
    v_mfma_f32_16x16x32_bf16 v[136:139], v[60:63], a[212:215], v[136:139]
    v_mfma_f32_16x16x32_bf16 v[140:143], v[56:59], a[188:191], v[140:143]
    v_mfma_f32_16x16x32_bf16 v[140:143], v[60:63], a[216:219], v[140:143]
    v_mfma_f32_16x16x32_bf16 v[144:147], v[56:59], a[192:195], v[144:147]
    ds_read_b64_tr_b16 v[56:57], v0 offset:18560
    v_mfma_f32_16x16x32_bf16 v[144:147], v[60:63], a[220:223], v[144:147]
    s_waitcnt lgkmcnt(9)
    ds_read_b64_tr_b16 v[58:59], v0 offset:19072
    v_mfma_f32_16x16x32_bf16 v[148:151], v[32:35], a[0:3], 0
    ds_read_b64_tr_b16 v[60:61], v0 offset:19584
    v_mfma_f32_16x16x32_bf16 v[148:151], v[36:39], a[28:31], v[148:151]
    ds_read_b64_tr_b16 v[62:63], v0 offset:20096
    v_mfma_f32_16x16x32_bf16 v[152:155], v[32:35], a[4:7], 0
    v_mfma_f32_16x16x32_bf16 v[152:155], v[36:39], a[32:35], v[152:155]
    v_mfma_f32_16x16x32_bf16 v[156:159], v[32:35], a[8:11], 0
    v_mfma_f32_16x16x32_bf16 v[156:159], v[36:39], a[36:39], v[156:159]
    v_mfma_f32_16x16x32_bf16 v[160:163], v[32:35], a[12:15], 0
    s_waitcnt vmcnt(9) lgkmcnt(0)
    s_barrier
    v_mfma_f32_16x16x32_bf16 v[160:163], v[36:39], a[40:43], v[160:163]
    v_mfma_f32_16x16x32_bf16 v[164:167], v[32:35], a[16:19], 0
    v_mfma_f32_16x16x32_bf16 v[164:167], v[36:39], a[44:47], v[164:167]
    v_mfma_f32_16x16x32_bf16 v[168:171], v[32:35], a[20:23], 0
    v_mfma_f32_16x16x32_bf16 v[168:171], v[36:39], a[48:51], v[168:171]
    buffer_load_dwordx4 v24, s[24:27], s83 offen lds
    v_mfma_f32_16x16x32_bf16 v[172:175], v[32:35], a[24:27], 0
    s_add_u32 s83, s83, 27648
    ds_read_b64_tr_b16 v[32:33], v0 offset:33024
    v_mfma_f32_16x16x32_bf16 v[172:175], v[36:39], a[52:55], v[172:175]
    ds_read_b64_tr_b16 v[34:35], v0 offset:33536
    v_mfma_f32_16x16x32_bf16 v[148:151], v[40:43], a[56:59], v[148:151]
    buffer_load_dwordx4 v24, s[24:27], s83 offen offset:1024 lds
    v_mfma_f32_16x16x32_bf16 v[148:151], v[44:47], a[84:87], v[148:151]
    s_add_u32 s83, s83, 27648
    ds_read_b64_tr_b16 v[36:37], v0 offset:34048
    v_mfma_f32_16x16x32_bf16 v[152:155], v[40:43], a[60:63], v[152:155]
    ds_read_b64_tr_b16 v[38:39], v0 offset:34560
    v_mfma_f32_16x16x32_bf16 v[152:155], v[44:47], a[88:91], v[152:155]
    buffer_load_dwordx4 v24, s[24:27], s83 offen offset:2048 lds
    v_mfma_f32_16x16x32_bf16 v[156:159], v[40:43], a[64:67], v[156:159]
    s_add_u32 s83, s83, 27648
    v_mfma_f32_16x16x32_bf16 v[156:159], v[44:47], a[92:95], v[156:159]
    v_mfma_f32_16x16x32_bf16 v[160:163], v[40:43], a[68:71], v[160:163]
    buffer_load_dwordx4 v24, s[24:27], s83 offen offset:3072 lds
    v_mfma_f32_16x16x32_bf16 v[160:163], v[44:47], a[96:99], v[160:163]
    s_add_u32 s83, s83, 31744
    s_add_u32 m0, s74, 16512
    v_mfma_f32_16x16x32_bf16 v[164:167], v[40:43], a[72:75], v[164:167]
    v_mfma_f32_16x16x32_bf16 v[164:167], v[44:47], a[100:103], v[164:167]
    buffer_load_dwordx4 v24, s[24:27], s83 offen lds
    v_mfma_f32_16x16x32_bf16 v[168:171], v[40:43], a[76:79], v[168:171]
    s_add_u32 s83, s83, 27648
    v_mfma_f32_16x16x32_bf16 v[168:171], v[44:47], a[104:107], v[168:171]
    v_mfma_f32_16x16x32_bf16 v[172:175], v[40:43], a[80:83], v[172:175]
    buffer_load_dwordx4 v24, s[24:27], s83 offen offset:1024 lds
    v_mfma_f32_16x16x32_bf16 v[172:175], v[44:47], a[108:111], v[172:175]
    ds_read_b64_tr_b16 v[40:41], v0 offset:35072
    s_add_u32 s83, s83, 27648
    v_mfma_f32_16x16x32_bf16 v[148:151], v[48:51], a[112:115], v[148:151]
    ds_read_b64_tr_b16 v[42:43], v0 offset:35584
    v_mfma_f32_16x16x32_bf16 v[148:151], v[52:55], a[140:143], v[148:151]
    buffer_load_dwordx4 v24, s[24:27], s83 offen offset:2048 lds
    v_mfma_f32_16x16x32_bf16 v[152:155], v[48:51], a[116:119], v[152:155]
    s_waitcnt vmcnt(12)
    ds_read_b64_tr_b16 v[44:45], v0 offset:36096
    v_cmp_ne_u32 vcc, 0, v2
    v_mfma_f32_16x16x32_bf16 v[152:155], v[52:55], a[144:147], v[152:155]
    s_and_b32 s85, vcc_lo, 0x300
    s_cmp_lg_u32 s85, 0x300
    s_cbranch_scc1 L_ow
    L_owok:
    ds_read_b64_tr_b16 v[46:47], v0 offset:36608
    s_add_u32 s83, s83, 27648
    v_mfma_f32_16x16x32_bf16 v[156:159], v[48:51], a[120:123], v[156:159]
    buffer_load_dwordx4 v24, s[24:27], s83 offen offset:3072 lds
    v_mfma_f32_16x16x32_bf16 v[156:159], v[52:55], a[148:151], v[156:159]
    s_add_u32 m0, s82, 0
    s_add_u32 s87, s47, 0
    v_mfma_f32_16x16x32_bf16 v[160:163], v[48:51], a[124:127], v[160:163]
    v_mfma_f32_16x16x32_bf16 v[160:163], v[52:55], a[152:155], v[160:163]
    buffer_load_dwordx4 v26, s[28:31], s87 offen sc1 lds
    v_mfma_f32_16x16x32_bf16 v[164:167], v[48:51], a[128:131], v[164:167]
    v_mfma_f32_16x16x32_bf16 v[164:167], v[52:55], a[156:159], v[164:167]
    v_mfma_f32_16x16x32_bf16 v[168:171], v[48:51], a[132:135], v[168:171]
    buffer_load_dwordx4 v26, s[28:31], s87 offen offset:1024 sc1 lds
    v_mfma_f32_16x16x32_bf16 v[168:171], v[52:55], a[160:163], v[168:171]
    v_mfma_f32_16x16x32_bf16 v[172:175], v[48:51], a[136:139], v[172:175]
    ds_read_b64_tr_b16 v[48:49], v0 offset:49536
    v_mfma_f32_16x16x32_bf16 v[172:175], v[52:55], a[164:167], v[172:175]
    ds_read_b64_tr_b16 v[50:51], v0 offset:50048
    v_mfma_f32_16x16x32_bf16 v[148:151], v[56:59], a[168:171], v[148:151]
    buffer_load_dwordx4 v26, s[28:31], s87 offen offset:2048 sc1 lds
    v_mfma_f32_16x16x32_bf16 v[148:151], v[60:63], a[196:199], v[148:151]
    ds_read_b64_tr_b16 v[52:53], v0 offset:50560
    v_mfma_f32_16x16x32_bf16 v[152:155], v[56:59], a[172:175], v[152:155]
    buffer_load_dwordx4 v26, s[28:31], s87 offen offset:3072 sc1 lds
    v_mfma_f32_16x16x32_bf16 v[152:155], v[60:63], a[200:203], v[152:155]
    s_add_u32 m0, s82, 4096
    ds_read_b64_tr_b16 v[54:55], v0 offset:51072
    s_add_u32 s87, s47, 4096
    v_mfma_f32_16x16x32_bf16 v[156:159], v[56:59], a[176:179], v[156:159]
    v_mfma_f32_16x16x32_bf16 v[156:159], v[60:63], a[204:207], v[156:159]
    buffer_load_dwordx4 v26, s[28:31], s87 offen sc1 lds
    v_mfma_f32_16x16x32_bf16 v[160:163], v[56:59], a[180:183], v[160:163]
    v_mfma_f32_16x16x32_bf16 v[160:163], v[60:63], a[208:211], v[160:163]
    v_mfma_f32_16x16x32_bf16 v[164:167], v[56:59], a[184:187], v[164:167]
    buffer_load_dwordx4 v26, s[28:31], s87 offen offset:1024 sc1 lds
    v_mfma_f32_16x16x32_bf16 v[164:167], v[60:63], a[212:215], v[164:167]
    v_mfma_f32_16x16x32_bf16 v[168:171], v[56:59], a[188:191], v[168:171]
    v_mfma_f32_16x16x32_bf16 v[168:171], v[60:63], a[216:219], v[168:171]
    buffer_load_dwordx4 v26, s[28:31], s87 offen offset:2048 sc1 lds
    v_mfma_f32_16x16x32_bf16 v[172:175], v[56:59], a[192:195], v[172:175]
    s_add_u32 s88, s88, s49
    ds_read_b64_tr_b16 v[56:57], v0 offset:51584
    s_lshl_b32 s83, s76, 7
    v_mfma_f32_16x16x32_bf16 v[172:175], v[60:63], a[220:223], v[172:175]
    s_waitcnt lgkmcnt(9)
    ds_read_b64_tr_b16 v[58:59], v0 offset:52096
    s_add_u32 s83, s83, s88
    v_mfma_f32_16x16x32_bf16 v[176:179], v[32:35], a[0:3], 0
    s_add_u32 s76, s76, 1
    ds_read_b64_tr_b16 v[60:61], v0 offset:52608
    s_cmp_ge_u32 s76, 7
    s_cselect_b32 s76, 0, s76
    v_mfma_f32_16x16x32_bf16 v[176:179], v[36:39], a[28:31], v[176:179]
    s_add_u32 m0, s74, 33024
    ds_read_b64_tr_b16 v[62:63], v0 offset:53120
    v_mfma_f32_16x16x32_bf16 v[180:183], v[32:35], a[4:7], 0
    v_mfma_f32_16x16x32_bf16 v[180:183], v[36:39], a[32:35], v[180:183]
    v_mfma_f32_16x16x32_bf16 v[184:187], v[32:35], a[8:11], 0
    v_mfma_f32_16x16x32_bf16 v[184:187], v[36:39], a[36:39], v[184:187]
    v_mfma_f32_16x16x32_bf16 v[188:191], v[32:35], a[12:15], 0
    s_waitcnt vmcnt(15) lgkmcnt(0)
    s_barrier
    v_mfma_f32_16x16x32_bf16 v[188:191], v[36:39], a[40:43], v[188:191]
    v_mfma_f32_16x16x32_bf16 v[192:195], v[32:35], a[16:19], 0
    v_mfma_f32_16x16x32_bf16 v[192:195], v[36:39], a[44:47], v[192:195]
    v_mfma_f32_16x16x32_bf16 v[196:199], v[32:35], a[20:23], 0
    v_mfma_f32_16x16x32_bf16 v[196:199], v[36:39], a[48:51], v[196:199]
    buffer_load_dwordx4 v24, s[24:27], s83 offen lds
    v_mfma_f32_16x16x32_bf16 v[200:203], v[32:35], a[24:27], 0
    s_add_u32 s83, s83, 27648
    ds_read_b64_tr_b16 v[32:33], v10 offset:0
    v_mfma_f32_16x16x32_bf16 v[200:203], v[36:39], a[52:55], v[200:203]
    ds_read_b64_tr_b16 v[34:35], v10 offset:512
    v_mfma_f32_16x16x32_bf16 v[176:179], v[40:43], a[56:59], v[176:179]
    buffer_load_dwordx4 v24, s[24:27], s83 offen offset:1024 lds
    v_mfma_f32_16x16x32_bf16 v[176:179], v[44:47], a[84:87], v[176:179]
    s_add_u32 s83, s83, 27648
    ds_read_b64_tr_b16 v[36:37], v10 offset:1024
    v_mfma_f32_16x16x32_bf16 v[180:183], v[40:43], a[60:63], v[180:183]
    ds_read_b64_tr_b16 v[38:39], v10 offset:1536
    v_mfma_f32_16x16x32_bf16 v[180:183], v[44:47], a[88:91], v[180:183]
    buffer_load_dwordx4 v24, s[24:27], s83 offen offset:2048 lds
    v_mfma_f32_16x16x32_bf16 v[184:187], v[40:43], a[64:67], v[184:187]
    s_add_u32 s83, s83, 27648
    v_mfma_f32_16x16x32_bf16 v[184:187], v[44:47], a[92:95], v[184:187]
    v_mfma_f32_16x16x32_bf16 v[188:191], v[40:43], a[68:71], v[188:191]
    buffer_load_dwordx4 v24, s[24:27], s83 offen offset:3072 lds
    v_mfma_f32_16x16x32_bf16 v[188:191], v[44:47], a[96:99], v[188:191]
    s_add_u32 s83, s83, 31744
    s_add_u32 m0, s74, 49536
    v_mfma_f32_16x16x32_bf16 v[192:195], v[40:43], a[72:75], v[192:195]
    v_mfma_f32_16x16x32_bf16 v[192:195], v[44:47], a[100:103], v[192:195]
    buffer_load_dwordx4 v24, s[24:27], s83 offen lds
    v_mfma_f32_16x16x32_bf16 v[196:199], v[40:43], a[76:79], v[196:199]
    s_add_u32 s83, s83, 27648
    v_mfma_f32_16x16x32_bf16 v[196:199], v[44:47], a[104:107], v[196:199]
    v_mfma_f32_16x16x32_bf16 v[200:203], v[40:43], a[80:83], v[200:203]
    buffer_load_dwordx4 v24, s[24:27], s83 offen offset:1024 lds
    v_mfma_f32_16x16x32_bf16 v[200:203], v[44:47], a[108:111], v[200:203]
    ds_read_b64_tr_b16 v[40:41], v10 offset:2048
    s_add_u32 s83, s83, 27648
    v_mfma_f32_16x16x32_bf16 v[176:179], v[48:51], a[112:115], v[176:179]
    ds_read_b64_tr_b16 v[42:43], v10 offset:2560
    v_mfma_f32_16x16x32_bf16 v[176:179], v[52:55], a[140:143], v[176:179]
    buffer_load_dwordx4 v24, s[24:27], s83 offen offset:2048 lds
    v_mfma_f32_16x16x32_bf16 v[180:183], v[48:51], a[116:119], v[180:183]
    s_add_u32 s83, s83, 27648
    ds_read_b64_tr_b16 v[44:45], v10 offset:3072
    v_mfma_f32_16x16x32_bf16 v[180:183], v[52:55], a[144:147], v[180:183]
    ds_read_b64_tr_b16 v[46:47], v10 offset:3584
    v_mfma_f32_16x16x32_bf16 v[184:187], v[48:51], a[120:123], v[184:187]
    buffer_load_dwordx4 v24, s[24:27], s83 offen offset:3072 lds
    v_mfma_f32_16x16x32_bf16 v[184:187], v[52:55], a[148:151], v[184:187]
    s_add_u32 m0, s82, 4096
    s_add_u32 s87, s47, 4096
    v_mfma_f32_16x16x32_bf16 v[188:191], v[48:51], a[124:127], v[188:191]
    v_mfma_f32_16x16x32_bf16 v[188:191], v[52:55], a[152:155], v[188:191]
    buffer_load_dwordx4 v26, s[28:31], s87 offen offset:3072 sc1 lds
    v_mfma_f32_16x16x32_bf16 v[192:195], v[48:51], a[128:131], v[192:195]
    s_add_u32 m0, s82, 8192
    s_add_u32 s87, s47, 8192
    v_mfma_f32_16x16x32_bf16 v[192:195], v[52:55], a[156:159], v[192:195]
    v_mfma_f32_16x16x32_bf16 v[196:199], v[48:51], a[132:135], v[196:199]
    buffer_load_dwordx4 v26, s[28:31], s87 offen sc1 lds
    v_mfma_f32_16x16x32_bf16 v[196:199], v[52:55], a[160:163], v[196:199]
    v_mfma_f32_16x16x32_bf16 v[200:203], v[48:51], a[136:139], v[200:203]
    ds_read_b64_tr_b16 v[48:49], v10 offset:16512
    v_mfma_f32_16x16x32_bf16 v[200:203], v[52:55], a[164:167], v[200:203]
    ds_read_b64_tr_b16 v[50:51], v10 offset:17024
    v_mfma_f32_16x16x32_bf16 v[176:179], v[56:59], a[168:171], v[176:179]
    buffer_load_dwordx4 v26, s[28:31], s87 offen offset:1024 sc1 lds
    v_mfma_f32_16x16x32_bf16 v[176:179], v[60:63], a[196:199], v[176:179]
    ds_read_b64_tr_b16 v[52:53], v10 offset:17536
    v_mfma_f32_16x16x32_bf16 v[180:183], v[56:59], a[172:175], v[180:183]
    buffer_load_dwordx4 v26, s[28:31], s87 offen offset:2048 sc1 lds
    v_mfma_f32_16x16x32_bf16 v[180:183], v[60:63], a[200:203], v[180:183]
    ds_read_b64_tr_b16 v[54:55], v10 offset:18048
    v_mfma_f32_16x16x32_bf16 v[184:187], v[56:59], a[176:179], v[184:187]
    v_mfma_f32_16x16x32_bf16 v[184:187], v[60:63], a[204:207], v[184:187]
    buffer_load_dwordx4 v26, s[28:31], s87 offen offset:3072 sc1 lds
    v_mfma_f32_16x16x32_bf16 v[188:191], v[56:59], a[180:183], v[188:191]
    s_add_u32 m0, s82, 12288
    s_add_u32 s87, s47, 12288
    v_mfma_f32_16x16x32_bf16 v[188:191], v[60:63], a[208:211], v[188:191]
    v_mfma_f32_16x16x32_bf16 v[192:195], v[56:59], a[184:187], v[192:195]
    buffer_load_dwordx4 v26, s[28:31], s87 offen sc1 lds
    v_mfma_f32_16x16x32_bf16 v[192:195], v[60:63], a[212:215], v[192:195]
    v_mfma_f32_16x16x32_bf16 v[196:199], v[56:59], a[188:191], v[196:199]
    v_mfma_f32_16x16x32_bf16 v[196:199], v[60:63], a[216:219], v[196:199]
    buffer_load_dwordx4 v26, s[28:31], s87 offen offset:1024 sc1 lds
    v_mfma_f32_16x16x32_bf16 v[200:203], v[56:59], a[192:195], v[200:203]
    s_lshl_b32 s83, s76, 7
    ds_read_b64_tr_b16 v[56:57], v10 offset:18560
    s_add_u32 s83, s83, s88
    v_mfma_f32_16x16x32_bf16 v[200:203], v[60:63], a[220:223], v[200:203]
    s_waitcnt lgkmcnt(9)
    ds_read_b64_tr_b16 v[58:59], v10 offset:19072
    s_add_u32 s76, s76, 1
    v_mfma_f32_16x16x32_bf16 v[204:207], v[32:35], a[0:3], 0
    s_cmp_ge_u32 s76, 7
    s_cselect_b32 s76, 0, s76
    ds_read_b64_tr_b16 v[60:61], v10 offset:19584
    s_add_u32 m0, s74, 66560
    v_mfma_f32_16x16x32_bf16 v[204:207], v[36:39], a[28:31], v[204:207]
    ds_read_b64_tr_b16 v[62:63], v10 offset:20096
    v_mfma_f32_16x16x32_bf16 v[208:211], v[32:35], a[4:7], 0
    v_mfma_f32_16x16x32_bf16 v[208:211], v[36:39], a[32:35], v[208:211]
    v_mfma_f32_16x16x32_bf16 v[212:215], v[32:35], a[8:11], 0
    v_mfma_f32_16x16x32_bf16 v[212:215], v[36:39], a[36:39], v[212:215]
    v_mfma_f32_16x16x32_bf16 v[216:219], v[32:35], a[12:15], 0
    s_waitcnt vmcnt(22) lgkmcnt(0)
    s_barrier
    v_mfma_f32_16x16x32_bf16 v[216:219], v[36:39], a[40:43], v[216:219]
    v_mfma_f32_16x16x32_bf16 v[220:223], v[32:35], a[16:19], 0
    v_mfma_f32_16x16x32_bf16 v[220:223], v[36:39], a[44:47], v[220:223]
    v_mfma_f32_16x16x32_bf16 v[224:227], v[32:35], a[20:23], 0
    v_mfma_f32_16x16x32_bf16 v[224:227], v[36:39], a[48:51], v[224:227]
    buffer_load_dwordx4 v24, s[24:27], s83 offen lds
    v_mfma_f32_16x16x32_bf16 v[228:231], v[32:35], a[24:27], 0
    s_add_u32 s83, s83, 27648
    ds_read_b64_tr_b16 v[32:33], v0 offset:0
    v_mfma_f32_16x16x32_bf16 v[228:231], v[36:39], a[52:55], v[228:231]
    ds_read_b64_tr_b16 v[34:35], v0 offset:512
    v_mfma_f32_16x16x32_bf16 v[204:207], v[40:43], a[56:59], v[204:207]
    ds_read_b64_tr_b16 v[36:37], v0 offset:1024
    v_mfma_f32_16x16x32_bf16 v[204:207], v[44:47], a[84:87], v[204:207]
    ds_read_b64_tr_b16 v[38:39], v0 offset:1536
    v_mfma_f32_16x16x32_bf16 v[208:211], v[40:43], a[60:63], v[208:211]
    buffer_load_dwordx4 v24, s[24:27], s83 offen offset:1024 lds
    v_mfma_f32_16x16x32_bf16 v[208:211], v[44:47], a[88:91], v[208:211]
    s_add_u32 s83, s83, 27648
    v_mfma_f32_16x16x32_bf16 v[212:215], v[40:43], a[64:67], v[212:215]
    v_mfma_f32_16x16x32_bf16 v[212:215], v[44:47], a[92:95], v[212:215]
    v_mfma_f32_16x16x32_bf16 v[216:219], v[40:43], a[68:71], v[216:219]
    v_mfma_f32_16x16x32_bf16 v[216:219], v[44:47], a[96:99], v[216:219]
    buffer_load_dwordx4 v24, s[24:27], s83 offen offset:2048 lds
    v_mfma_f32_16x16x32_bf16 v[220:223], v[40:43], a[72:75], v[220:223]
    s_add_u32 s83, s83, 27648
    v_mfma_f32_16x16x32_bf16 v[220:223], v[44:47], a[100:103], v[220:223]
    v_mfma_f32_16x16x32_bf16 v[224:227], v[40:43], a[76:79], v[224:227]
    v_mfma_f32_16x16x32_bf16 v[224:227], v[44:47], a[104:107], v[224:227]
    v_mfma_f32_16x16x32_bf16 v[228:231], v[40:43], a[80:83], v[228:231]
    buffer_load_dwordx4 v24, s[24:27], s83 offen offset:3072 lds
    v_mfma_f32_16x16x32_bf16 v[228:231], v[44:47], a[108:111], v[228:231]
    ds_read_b64_tr_b16 v[40:41], v0 offset:2048
    s_add_u32 s83, s83, 31744
    v_mfma_f32_16x16x32_bf16 v[204:207], v[48:51], a[112:115], v[204:207]
    s_add_u32 m0, s74, 83072
    ds_read_b64_tr_b16 v[42:43], v0 offset:2560
    v_mfma_f32_16x16x32_bf16 v[204:207], v[52:55], a[140:143], v[204:207]
    ds_read_b64_tr_b16 v[44:45], v0 offset:3072
    v_mfma_f32_16x16x32_bf16 v[208:211], v[48:51], a[116:119], v[208:211]
    ds_read_b64_tr_b16 v[46:47], v0 offset:3584
    v_mfma_f32_16x16x32_bf16 v[208:211], v[52:55], a[144:147], v[208:211]
    buffer_load_dwordx4 v24, s[24:27], s83 offen lds
    v_mfma_f32_16x16x32_bf16 v[212:215], v[48:51], a[120:123], v[212:215]
    s_add_u32 s83, s83, 27648
    v_mfma_f32_16x16x32_bf16 v[212:215], v[52:55], a[148:151], v[212:215]
    v_mfma_f32_16x16x32_bf16 v[216:219], v[48:51], a[124:127], v[216:219]
    v_mfma_f32_16x16x32_bf16 v[216:219], v[52:55], a[152:155], v[216:219]
    v_mfma_f32_16x16x32_bf16 v[220:223], v[48:51], a[128:131], v[220:223]
    buffer_load_dwordx4 v24, s[24:27], s83 offen offset:1024 lds
    v_mfma_f32_16x16x32_bf16 v[220:223], v[52:55], a[156:159], v[220:223]
    s_add_u32 s83, s83, 27648
    v_mfma_f32_16x16x32_bf16 v[224:227], v[48:51], a[132:135], v[224:227]
    v_mfma_f32_16x16x32_bf16 v[224:227], v[52:55], a[160:163], v[224:227]
    v_mfma_f32_16x16x32_bf16 v[228:231], v[48:51], a[136:139], v[228:231]
    ds_read_b64_tr_b16 v[48:49], v0 offset:16512
    v_mfma_f32_16x16x32_bf16 v[228:231], v[52:55], a[164:167], v[228:231]
    ds_read_b64_tr_b16 v[50:51], v0 offset:17024
    v_mfma_f32_16x16x32_bf16 v[204:207], v[56:59], a[168:171], v[204:207]
    buffer_load_dwordx4 v24, s[24:27], s83 offen offset:2048 lds
    v_mfma_f32_16x16x32_bf16 v[204:207], v[60:63], a[196:199], v[204:207]
    s_add_u32 s83, s83, 27648
    ds_read_b64_tr_b16 v[52:53], v0 offset:17536
    v_mfma_f32_16x16x32_bf16 v[208:211], v[56:59], a[172:175], v[208:211]
    ds_read_b64_tr_b16 v[54:55], v0 offset:18048
    v_mfma_f32_16x16x32_bf16 v[208:211], v[60:63], a[200:203], v[208:211]
    v_mfma_f32_16x16x32_bf16 v[212:215], v[56:59], a[176:179], v[212:215]
    buffer_load_dwordx4 v24, s[24:27], s83 offen offset:3072 lds
    v_mfma_f32_16x16x32_bf16 v[212:215], v[60:63], a[204:207], v[212:215]
    s_lshl_b32 s83, s76, 7
    s_add_u32 s83, s83, s88
    s_add_u32 s76, s76, 1
    v_mfma_f32_16x16x32_bf16 v[216:219], v[56:59], a[180:183], v[216:219]
    s_cmp_ge_u32 s76, 7
    s_cselect_b32 s76, 0, s76
    s_add_u32 m0, s74, 0
    v_mfma_f32_16x16x32_bf16 v[216:219], v[60:63], a[208:211], v[216:219]
    v_mfma_f32_16x16x32_bf16 v[220:223], v[56:59], a[184:187], v[220:223]
    v_mfma_f32_16x16x32_bf16 v[220:223], v[60:63], a[212:215], v[220:223]
    v_mfma_f32_16x16x32_bf16 v[224:227], v[56:59], a[188:191], v[224:227]
    v_mfma_f32_16x16x32_bf16 v[224:227], v[60:63], a[216:219], v[224:227]
    v_mfma_f32_16x16x32_bf16 v[228:231], v[56:59], a[192:195], v[228:231]
    ds_read_b64_tr_b16 v[56:57], v0 offset:18560
    v_mfma_f32_16x16x32_bf16 v[228:231], v[60:63], a[220:223], v[228:231]
    s_waitcnt lgkmcnt(9)
    ds_read_b64_tr_b16 v[58:59], v0 offset:19072
    v_mfma_f32_16x16x32_bf16 v[232:235], v[32:35], a[0:3], 0
    ds_read_b64_tr_b16 v[60:61], v0 offset:19584
    v_mfma_f32_16x16x32_bf16 v[232:235], v[36:39], a[28:31], v[232:235]
    ds_read_b64_tr_b16 v[62:63], v0 offset:20096
    v_mfma_f32_16x16x32_bf16 v[236:239], v[32:35], a[4:7], 0
    v_mfma_f32_16x16x32_bf16 v[236:239], v[36:39], a[32:35], v[236:239]
    v_mfma_f32_16x16x32_bf16 v[240:243], v[32:35], a[8:11], 0
    v_mfma_f32_16x16x32_bf16 v[240:243], v[36:39], a[36:39], v[240:243]
    v_mfma_f32_16x16x32_bf16 v[244:247], v[32:35], a[12:15], 0
    s_waitcnt vmcnt(15) lgkmcnt(0)
    s_barrier
    v_mfma_f32_16x16x32_bf16 v[244:247], v[36:39], a[40:43], v[244:247]
    v_mfma_f32_16x16x32_bf16 v[248:251], v[32:35], a[16:19], 0
    v_mfma_f32_16x16x32_bf16 v[248:251], v[36:39], a[44:47], v[248:251]
    v_mfma_f32_16x16x32_bf16 v[252:255], v[32:35], a[20:23], 0
    v_mfma_f32_16x16x32_bf16 v[252:255], v[36:39], a[48:51], v[252:255]
    buffer_load_dwordx4 v24, s[24:27], s83 offen lds
    v_mfma_f32_16x16x32_bf16 v[28:31], v[32:35], a[24:27], 0
    s_waitcnt vmcnt(9)
    s_barrier
    v_mfma_f32_16x16x32_bf16 v[28:31], v[36:39], a[52:55], v[28:31]
    ds_read_b64_tr_b16 v[32:33], v0 offset:33024
    s_add_u32 s83, s83, 27648
    v_mfma_f32_16x16x32_bf16 v[232:235], v[40:43], a[56:59], v[232:235]
    ds_read_b64_tr_b16 v[34:35], v0 offset:33536
    v_mfma_f32_16x16x32_bf16 v[232:235], v[44:47], a[84:87], v[232:235]
    ds_read_b64_tr_b16 v[36:37], v0 offset:34048
    v_mfma_f32_16x16x32_bf16 v[236:239], v[40:43], a[60:63], v[236:239]
    buffer_load_dwordx4 v24, s[24:27], s83 offen offset:1024 lds
    v_mfma_f32_16x16x32_bf16 v[236:239], v[44:47], a[88:91], v[236:239]
    s_add_u32 s83, s83, 27648
    ds_read_b64_tr_b16 v[38:39], v0 offset:34560
    v_mfma_f32_16x16x32_bf16 v[240:243], v[40:43], a[64:67], v[240:243]
    ds_read_b128 a[0:3], v4 offset:0
    v_mfma_f32_16x16x32_bf16 v[240:243], v[44:47], a[92:95], v[240:243]
    ds_read_b128 a[28:31], v4 offset:7168
    v_mfma_f32_16x16x32_bf16 v[244:247], v[40:43], a[68:71], v[244:247]
    ds_read_b128 a[4:7], v4 offset:1024
    v_mfma_f32_16x16x32_bf16 v[244:247], v[44:47], a[96:99], v[244:247]
    buffer_load_dwordx4 v24, s[24:27], s83 offen offset:2048 lds
    v_mfma_f32_16x16x32_bf16 v[248:251], v[40:43], a[72:75], v[248:251]
    s_add_u32 s83, s83, 27648
    ds_read_b128 a[32:35], v4 offset:8192
    v_mfma_f32_16x16x32_bf16 v[248:251], v[44:47], a[100:103], v[248:251]
    ds_read_b128 a[8:11], v4 offset:2048
    v_mfma_f32_16x16x32_bf16 v[252:255], v[40:43], a[76:79], v[252:255]
    ds_read_b128 a[36:39], v4 offset:9216
    v_mfma_f32_16x16x32_bf16 v[252:255], v[44:47], a[104:107], v[252:255]
    ds_read_b128 a[12:15], v4 offset:3072
    v_mfma_f32_16x16x32_bf16 v[28:31], v[40:43], a[80:83], v[28:31]
    buffer_load_dwordx4 v24, s[24:27], s83 offen offset:3072 lds
    v_mfma_f32_16x16x32_bf16 v[28:31], v[44:47], a[108:111], v[28:31]
    ds_read_b64_tr_b16 v[40:41], v0 offset:35072
    s_add_u32 s83, s83, 31744
    v_mfma_f32_16x16x32_bf16 v[232:235], v[48:51], a[112:115], v[232:235]
    s_add_u32 m0, s74, 16512
    ds_read_b64_tr_b16 v[42:43], v0 offset:35584
    v_mfma_f32_16x16x32_bf16 v[232:235], v[52:55], a[140:143], v[232:235]
    ds_read_b64_tr_b16 v[44:45], v0 offset:36096
    v_mfma_f32_16x16x32_bf16 v[236:239], v[48:51], a[116:119], v[236:239]
    ds_read_b64_tr_b16 v[46:47], v0 offset:36608
    v_mfma_f32_16x16x32_bf16 v[236:239], v[52:55], a[144:147], v[236:239]
    buffer_load_dwordx4 v24, s[24:27], s83 offen lds
    v_mfma_f32_16x16x32_bf16 v[240:243], v[48:51], a[120:123], v[240:243]
    s_add_u32 s83, s83, 27648
    ds_read_b128 a[40:43], v4 offset:10240
    v_mfma_f32_16x16x32_bf16 v[240:243], v[52:55], a[148:151], v[240:243]
    ds_read_b128 a[16:19], v4 offset:4096
    v_mfma_f32_16x16x32_bf16 v[244:247], v[48:51], a[124:127], v[244:247]
    ds_read_b128 a[44:47], v4 offset:11264
    v_mfma_f32_16x16x32_bf16 v[244:247], v[52:55], a[152:155], v[244:247]
    ds_read_b128 a[20:23], v4 offset:5120
    v_mfma_f32_16x16x32_bf16 v[248:251], v[48:51], a[128:131], v[248:251]
    buffer_load_dwordx4 v24, s[24:27], s83 offen offset:1024 lds
    v_mfma_f32_16x16x32_bf16 v[248:251], v[52:55], a[156:159], v[248:251]
    s_add_u32 s83, s83, 27648
    ds_read_b128 a[48:51], v4 offset:12288
    v_mfma_f32_16x16x32_bf16 v[252:255], v[48:51], a[132:135], v[252:255]
    ds_read_b128 a[24:27], v4 offset:6144
    v_mfma_f32_16x16x32_bf16 v[252:255], v[52:55], a[160:163], v[252:255]
    ds_read_b128 a[52:55], v4 offset:13312
    v_mfma_f32_16x16x32_bf16 v[28:31], v[48:51], a[136:139], v[28:31]
    ds_read_b128 a[56:59], v4 offset:14336
    v_mfma_f32_16x16x32_bf16 v[28:31], v[52:55], a[164:167], v[28:31]
    ds_read_b128 a[84:87], v4 offset:21504
    v_mfma_f32_16x16x32_bf16 v[232:235], v[56:59], a[168:171], v[232:235]
    buffer_load_dwordx4 v24, s[24:27], s83 offen offset:2048 lds
    v_mfma_f32_16x16x32_bf16 v[232:235], v[60:63], a[196:199], v[232:235]
    s_add_u32 s83, s83, 27648
    ds_read_b64_tr_b16 v[48:49], v0 offset:49536
    v_mfma_f32_16x16x32_bf16 v[236:239], v[56:59], a[172:175], v[236:239]
    ds_read_b64_tr_b16 v[50:51], v0 offset:50048
    v_mfma_f32_16x16x32_bf16 v[236:239], v[60:63], a[200:203], v[236:239]
    ds_read_b64_tr_b16 v[52:53], v0 offset:50560
    v_mfma_f32_16x16x32_bf16 v[240:243], v[56:59], a[176:179], v[240:243]
    buffer_load_dwordx4 v24, s[24:27], s83 offen offset:3072 lds
    v_mfma_f32_16x16x32_bf16 v[240:243], v[60:63], a[204:207], v[240:243]
    s_lshl_b32 s83, s76, 7
    ds_read_b64_tr_b16 v[54:55], v0 offset:51072
    s_add_u32 s83, s83, s88
    v_mfma_f32_16x16x32_bf16 v[244:247], v[56:59], a[180:183], v[244:247]
    s_add_u32 s76, s76, 1
    ds_read_b128 a[60:63], v4 offset:15360
    s_cmp_ge_u32 s76, 7
    s_cselect_b32 s76, 0, s76
    v_mfma_f32_16x16x32_bf16 v[244:247], v[60:63], a[208:211], v[244:247]
    s_add_u32 m0, s74, 33024
    ds_read_b128 a[88:91], v4 offset:22528
    v_mfma_f32_16x16x32_bf16 v[248:251], v[56:59], a[184:187], v[248:251]
    ds_read_b128 a[64:67], v4 offset:16384
    v_mfma_f32_16x16x32_bf16 v[248:251], v[60:63], a[212:215], v[248:251]
    ds_read_b128 a[92:95], v4 offset:23552
    v_mfma_f32_16x16x32_bf16 v[252:255], v[56:59], a[188:191], v[252:255]
    ds_read_b128 a[68:71], v4 offset:17408
    v_mfma_f32_16x16x32_bf16 v[252:255], v[60:63], a[216:219], v[252:255]
    ds_read_b128 a[96:99], v4 offset:24576
    v_mfma_f32_16x16x32_bf16 v[28:31], v[56:59], a[192:195], v[28:31]
    ds_read_b128 a[72:75], v4 offset:18432
    v_mfma_f32_16x16x32_bf16 v[28:31], v[60:63], a[220:223], v[28:31]
    s_waitcnt lgkmcnt(14)
    ds_read_b128 a[100:103], v4 offset:25600
    v_mfma_f32_16x16x32_bf16 v[64:67], v[32:35], a[0:3], v[64:67]
    ds_read_b128 a[76:79], v4 offset:19456
    v_mfma_f32_16x16x32_bf16 v[64:67], v[36:39], a[28:31], v[64:67]
    ds_read_b128 a[104:107], v4 offset:26624
    v_mfma_f32_16x16x32_bf16 v[68:71], v[32:35], a[4:7], v[68:71]
    ds_read_b128 a[80:83], v4 offset:20480
    v_mfma_f32_16x16x32_bf16 v[68:71], v[36:39], a[32:35], v[68:71]
    ds_read_b128 a[108:111], v4 offset:27648
    v_mfma_f32_16x16x32_bf16 v[72:75], v[32:35], a[8:11], v[72:75]
    ds_read_b128 a[112:115], v4 offset:28672
    v_mfma_f32_16x16x32_bf16 v[72:75], v[36:39], a[36:39], v[72:75]
    s_waitcnt lgkmcnt(14)
    ds_read_b128 a[140:143], v4 offset:35840
    v_mfma_f32_16x16x32_bf16 v[76:79], v[32:35], a[12:15], v[76:79]
    ds_read_b64_tr_b16 v[56:57], v0 offset:51584
    v_mfma_f32_16x16x32_bf16 v[76:79], v[36:39], a[40:43], v[76:79]
    ds_read_b64_tr_b16 v[58:59], v0 offset:52096
    v_mfma_f32_16x16x32_bf16 v[80:83], v[32:35], a[16:19], v[80:83]
    ds_read_b64_tr_b16 v[60:61], v0 offset:52608
    v_mfma_f32_16x16x32_bf16 v[80:83], v[36:39], a[44:47], v[80:83]
    s_mul_i32 s40, s75, 229376
    ds_read_b64_tr_b16 v[62:63], v0 offset:53120
    s_add_u32 s40, s40, s80
    v_mfma_f32_16x16x32_bf16 v[84:87], v[32:35], a[20:23], v[84:87]
    s_lshl_b32 s42, s75, 9
    ds_read_b128 a[116:119], v4 offset:29696
    s_add_u32 s42, s42, s95
    v_mfma_f32_16x16x32_bf16 v[84:87], v[36:39], a[48:51], v[84:87]
    s_add_u32 s75, s75, 1
    ds_read_b128 a[144:147], v4 offset:36864
    s_cmp_ge_u32 s75, 7
    s_cselect_b32 s75, 0, s75
    v_mfma_f32_16x16x32_bf16 v[88:91], v[32:35], a[24:27], v[88:91]
    ds_read_b128 a[120:123], v4 offset:30720
    v_mfma_f32_16x16x32_bf16 v[88:91], v[36:39], a[52:55], v[88:91]
    s_waitcnt lgkmcnt(14)
    ds_read_b128 a[148:151], v4 offset:37888
    v_mfma_f32_16x16x32_bf16 v[64:67], v[40:43], a[56:59], v[64:67]
    s_waitcnt vmcnt(8) lgkmcnt(4)
    ds_read_b128 a[124:127], v4 offset:31744
    s_barrier
    v_mfma_f32_16x16x32_bf16 v[64:67], v[44:47], a[84:87], v[64:67]
    buffer_load_dwordx4 v24, s[24:27], s83 offen lds
    v_mfma_f32_16x16x32_bf16 v[68:71], v[40:43], a[60:63], v[68:71]
    s_add_u32 s83, s83, 27648
    ds_read_b128 a[152:155], v4 offset:38912
    v_mfma_f32_16x16x32_bf16 v[68:71], v[44:47], a[88:91], v[68:71]
    buffer_load_dwordx4 v24, s[24:27], s83 offen offset:1024 lds
    v_mfma_f32_16x16x32_bf16 v[72:75], v[40:43], a[64:67], v[72:75]
    s_add_u32 s83, s83, 27648
    ds_read_b128 a[128:131], v4 offset:32768
    v_mfma_f32_16x16x32_bf16 v[72:75], v[44:47], a[92:95], v[72:75]
    ds_read_b128 a[156:159], v4 offset:39936
    v_mfma_f32_16x16x32_bf16 v[76:79], v[40:43], a[68:71], v[76:79]
    ds_read_b128 a[132:135], v4 offset:33792
    v_mfma_f32_16x16x32_bf16 v[76:79], v[44:47], a[96:99], v[76:79]
    ds_read_b128 a[160:163], v4 offset:40960
    v_mfma_f32_16x16x32_bf16 v[80:83], v[40:43], a[72:75], v[80:83]
    ds_read_b128 a[136:139], v4 offset:34816
    v_mfma_f32_16x16x32_bf16 v[80:83], v[44:47], a[100:103], v[80:83]
    ds_read_b128 a[164:167], v4 offset:41984
    v_mfma_f32_16x16x32_bf16 v[84:87], v[40:43], a[76:79], v[84:87]
    buffer_load_dwordx4 v24, s[24:27], s83 offen offset:2048 lds
    v_mfma_f32_16x16x32_bf16 v[84:87], v[44:47], a[104:107], v[84:87]
    s_add_u32 s83, s83, 27648
    ds_read_b128 a[168:171], v4 offset:43008
    v_mfma_f32_16x16x32_bf16 v[88:91], v[40:43], a[80:83], v[88:91]
    ds_read_b128 a[196:199], v4 offset:50176
    v_mfma_f32_16x16x32_bf16 v[88:91], v[44:47], a[108:111], v[88:91]
    s_waitcnt lgkmcnt(10)
    ds_read_b64_tr_b16 v[32:33], v10 offset:0
    v_mfma_f32_16x16x32_bf16 v[64:67], v[48:51], a[112:115], v[64:67]
    ds_read_b64_tr_b16 v[34:35], v10 offset:512
    v_mfma_f32_16x16x32_bf16 v[64:67], v[52:55], a[140:143], v[64:67]
    ds_read_b64_tr_b16 v[36:37], v10 offset:1024
    v_mfma_f32_16x16x32_bf16 v[68:71], v[48:51], a[116:119], v[68:71]
    ds_read_b64_tr_b16 v[38:39], v10 offset:1536
    v_mfma_f32_16x16x32_bf16 v[68:71], v[52:55], a[144:147], v[68:71]
    ds_read_b128 a[172:175], v4 offset:44032
    v_mfma_f32_16x16x32_bf16 v[72:75], v[48:51], a[120:123], v[72:75]
    ds_read_b128 a[200:203], v4 offset:51200
    v_mfma_f32_16x16x32_bf16 v[72:75], v[52:55], a[148:151], v[72:75]
    s_waitcnt lgkmcnt(8)
    ds_read_b128 a[176:179], v4 offset:45056
    v_mfma_f32_16x16x32_bf16 v[76:79], v[48:51], a[124:127], v[76:79]
    buffer_load_dwordx4 v24, s[24:27], s83 offen offset:3072 lds
    v_mfma_f32_16x16x32_bf16 v[76:79], v[52:55], a[152:155], v[76:79]
    s_add_u32 s83, s83, 31744
    ds_read_b128 a[204:207], v4 offset:52224
    s_add_u32 m0, s74, 49536
    v_mfma_f32_16x16x32_bf16 v[80:83], v[48:51], a[128:131], v[80:83]
    ds_read_b128 a[180:183], v4 offset:46080
    v_mfma_f32_16x16x32_bf16 v[80:83], v[52:55], a[156:159], v[80:83]
    ds_read_b128 a[208:211], v4 offset:53248
    v_mfma_f32_16x16x32_bf16 v[84:87], v[48:51], a[132:135], v[84:87]
    ds_read_b128 a[184:187], v4 offset:47104
    v_mfma_f32_16x16x32_bf16 v[84:87], v[52:55], a[160:163], v[84:87]
    ds_read_b128 a[212:215], v4 offset:54272
    v_mfma_f32_16x16x32_bf16 v[88:91], v[48:51], a[136:139], v[88:91]
    buffer_load_dwordx4 v24, s[24:27], s83 offen lds
    v_mfma_f32_16x16x32_bf16 v[88:91], v[52:55], a[164:167], v[88:91]
    s_waitcnt lgkmcnt(4)
    ds_read_b128 a[188:191], v4 offset:48128
    s_add_u32 s83, s83, 27648
    v_mfma_f32_16x16x32_bf16 v[64:67], v[56:59], a[168:171], v[64:67]
    ds_read_b128 a[216:219], v4 offset:55296
    v_mfma_f32_16x16x32_bf16 v[64:67], v[60:63], a[196:199], v[64:67]
    ds_read_b128 a[192:195], v4 offset:49152
    v_mfma_f32_16x16x32_bf16 v[68:71], v[56:59], a[172:175], v[68:71]
    ds_read_b128 a[220:223], v4 offset:56320
    v_mfma_f32_16x16x32_bf16 v[68:71], v[60:63], a[200:203], v[68:71]
    buffer_load_dwordx4 v24, s[24:27], s83 offen offset:1024 lds
    v_mfma_f32_16x16x32_bf16 v[72:75], v[56:59], a[176:179], v[72:75]
    s_add_u32 s83, s83, 27648
    ds_read_b64_tr_b16 v[40:41], v10 offset:2048
    v_cvt_pk_bf16_f32 v64, v64, v65
    v_mfma_f32_16x16x32_bf16 v[72:75], v[60:63], a[204:207], v[72:75]
    s_waitcnt lgkmcnt(1)
    ds_read_b64_tr_b16 v[42:43], v10 offset:2560
    v_cvt_pk_bf16_f32 v65, v66, v67
    v_mfma_f32_16x16x32_bf16 v[76:79], v[56:59], a[180:183], v[76:79]
    ds_read_b64_tr_b16 v[44:45], v10 offset:3072
    v_cvt_pk_bf16_f32 v66, v68, v69
    v_mfma_f32_16x16x32_bf16 v[76:79], v[60:63], a[208:211], v[76:79]
    ds_read_b64_tr_b16 v[46:47], v10 offset:3584
    v_cvt_pk_bf16_f32 v67, v70, v71
    v_mfma_f32_16x16x32_bf16 v[80:83], v[56:59], a[184:187], v[80:83]
    buffer_load_dwordx4 v24, s[24:27], s83 offen offset:2048 lds
    v_mfma_f32_16x16x32_bf16 v[80:83], v[60:63], a[212:215], v[80:83]
    s_add_u32 s83, s83, 27648
    ds_read_b64_tr_b16 v[48:49], v10 offset:16512
    v_cvt_pk_bf16_f32 v72, v72, v73
    v_mfma_f32_16x16x32_bf16 v[84:87], v[56:59], a[188:191], v[84:87]
    buffer_load_dwordx4 v24, s[24:27], s83 offen offset:3072 lds
    v_mfma_f32_16x16x32_bf16 v[84:87], v[60:63], a[216:219], v[84:87]
    s_lshl_b32 s83, s76, 7
    ds_read_b64_tr_b16 v[50:51], v10 offset:17024
    v_cvt_pk_bf16_f32 v73, v74, v75
    v_mfma_f32_16x16x32_bf16 v[88:91], v[56:59], a[192:195], v[88:91]
    s_add_u32 s83, s83, s88
    ds_read_b64_tr_b16 v[52:53], v10 offset:17536
    v_cvt_pk_bf16_f32 v74, v76, v77
    v_mfma_f32_16x16x32_bf16 v[88:91], v[60:63], a[220:223], v[88:91]
    ds_read_b64_tr_b16 v[54:55], v10 offset:18048
    v_cvt_pk_bf16_f32 v75, v78, v79
    v_mfma_f32_16x16x32_bf16 v[92:95], v[32:35], a[0:3], v[92:95]
    s_add_u32 s76, s76, 1
    ds_read_b64_tr_b16 v[56:57], v10 offset:18560
    v_cvt_pk_bf16_f32 v80, v80, v81
    v_mfma_f32_16x16x32_bf16 v[92:95], v[36:39], a[28:31], v[92:95]
    s_cmp_ge_u32 s76, 7
    s_cselect_b32 s76, 0, s76
    ds_read_b64_tr_b16 v[58:59], v10 offset:19072
    v_cvt_pk_bf16_f32 v81, v82, v83
    v_mfma_f32_16x16x32_bf16 v[96:99], v[32:35], a[4:7], v[96:99]
    s_add_u32 m0, s74, 66560
    ds_read_b64_tr_b16 v[60:61], v10 offset:19584
    v_cvt_pk_bf16_f32 v82, v84, v85
    v_mfma_f32_16x16x32_bf16 v[96:99], v[36:39], a[32:35], v[96:99]
    ds_read_b64_tr_b16 v[62:63], v10 offset:20096
    v_cvt_pk_bf16_f32 v83, v86, v87
    v_mfma_f32_16x16x32_bf16 v[100:103], v[32:35], a[8:11], v[100:103]
    v_cvt_pk_bf16_f32 v88, v88, v89
    v_cvt_pk_bf16_f32 v89, v90, v91
    v_mfma_f32_16x16x32_bf16 v[100:103], v[36:39], a[36:39], v[100:103]
    buffer_store_dwordx4 v[64:67], v26, s[28:31], s40 offen sc1
    v_mfma_f32_16x16x32_bf16 v[104:107], v[32:35], a[12:15], v[104:107]
    v_mfma_f32_16x16x32_bf16 v[104:107], v[36:39], a[40:43], v[104:107]
    v_mfma_f32_16x16x32_bf16 v[108:111], v[32:35], a[16:19], v[108:111]
    s_waitcnt vmcnt(9) lgkmcnt(0)
    s_barrier
    v_mfma_f32_16x16x32_bf16 v[108:111], v[36:39], a[44:47], v[108:111]
    buffer_store_dwordx4 v[72:75], v26, s[28:31], s40 offen offset:1024 sc1
    v_mfma_f32_16x16x32_bf16 v[112:115], v[32:35], a[20:23], v[112:115]
    s_mul_i32 s41, s75, 229376
    s_add_u32 s41, s41, s80
    s_lshl_b32 s43, s75, 9
    v_mfma_f32_16x16x32_bf16 v[112:115], v[36:39], a[48:51], v[112:115]
    buffer_load_dwordx4 v24, s[24:27], s83 offen lds
    v_mfma_f32_16x16x32_bf16 v[116:119], v[32:35], a[24:27], v[116:119]
    s_add_u32 s83, s83, 27648
    ds_read_b64_tr_b16 v[32:33], v0 offset:0
    s_add_u32 s43, s43, s95
    v_mfma_f32_16x16x32_bf16 v[116:119], v[36:39], a[52:55], v[116:119]
    ds_read_b64_tr_b16 v[34:35], v0 offset:512
    s_add_u32 s75, s75, 1
    v_mfma_f32_16x16x32_bf16 v[92:95], v[40:43], a[56:59], v[92:95]
    s_cmp_ge_u32 s75, 7
    s_cselect_b32 s75, 0, s75
    ds_read_b64_tr_b16 v[36:37], v0 offset:1024
    v_mfma_f32_16x16x32_bf16 v[92:95], v[44:47], a[84:87], v[92:95]
    ds_read_b64_tr_b16 v[38:39], v0 offset:1536
    v_mfma_f32_16x16x32_bf16 v[96:99], v[40:43], a[60:63], v[96:99]
    buffer_load_dwordx4 v24, s[24:27], s83 offen offset:1024 lds
    v_mfma_f32_16x16x32_bf16 v[96:99], v[44:47], a[88:91], v[96:99]
    s_add_u32 s83, s83, 27648
    v_mfma_f32_16x16x32_bf16 v[100:103], v[40:43], a[64:67], v[100:103]
    v_mfma_f32_16x16x32_bf16 v[100:103], v[44:47], a[92:95], v[100:103]
    buffer_store_dwordx4 v[80:83], v26, s[28:31], s40 offen offset:2048 sc1
    v_mfma_f32_16x16x32_bf16 v[104:107], v[40:43], a[68:71], v[104:107]
    v_mfma_f32_16x16x32_bf16 v[104:107], v[44:47], a[96:99], v[104:107]
    buffer_load_dwordx4 v24, s[24:27], s83 offen offset:2048 lds
    v_mfma_f32_16x16x32_bf16 v[108:111], v[40:43], a[72:75], v[108:111]
    s_add_u32 s83, s83, 27648
    v_mfma_f32_16x16x32_bf16 v[108:111], v[44:47], a[100:103], v[108:111]
    v_mfma_f32_16x16x32_bf16 v[112:115], v[40:43], a[76:79], v[112:115]
    v_mfma_f32_16x16x32_bf16 v[112:115], v[44:47], a[104:107], v[112:115]
    v_mfma_f32_16x16x32_bf16 v[116:119], v[40:43], a[80:83], v[116:119]
    buffer_load_dwordx4 v24, s[24:27], s83 offen offset:3072 lds
    v_mfma_f32_16x16x32_bf16 v[116:119], v[44:47], a[108:111], v[116:119]
    ds_read_b64_tr_b16 v[40:41], v0 offset:2048
    s_add_u32 s83, s83, 31744
    v_mfma_f32_16x16x32_bf16 v[92:95], v[48:51], a[112:115], v[92:95]
    s_add_u32 m0, s74, 83072
    ds_read_b64_tr_b16 v[42:43], v0 offset:2560
    v_mfma_f32_16x16x32_bf16 v[92:95], v[52:55], a[140:143], v[92:95]
    buffer_store_dwordx2 v[88:89], v27, s[28:31], s40 offen offset:3072 sc1
    v_mfma_f32_16x16x32_bf16 v[96:99], v[48:51], a[116:119], v[96:99]
    ds_read_b64_tr_b16 v[44:45], v0 offset:3072
    v_mfma_f32_16x16x32_bf16 v[96:99], v[52:55], a[144:147], v[96:99]
    buffer_load_dwordx4 v24, s[24:27], s83 offen lds
    v_mfma_f32_16x16x32_bf16 v[100:103], v[48:51], a[120:123], v[100:103]
    s_add_u32 s83, s83, 27648
    ds_read_b64_tr_b16 v[46:47], v0 offset:3584
    v_mfma_f32_16x16x32_bf16 v[100:103], v[52:55], a[148:151], v[100:103]
    v_mfma_f32_16x16x32_bf16 v[104:107], v[48:51], a[124:127], v[104:107]
    v_mfma_f32_16x16x32_bf16 v[104:107], v[52:55], a[152:155], v[104:107]
    v_mfma_f32_16x16x32_bf16 v[108:111], v[48:51], a[128:131], v[108:111]
    buffer_load_dwordx4 v24, s[24:27], s83 offen offset:1024 lds
    v_mfma_f32_16x16x32_bf16 v[108:111], v[52:55], a[156:159], v[108:111]
    s_add_u32 s83, s83, 27648
    v_mfma_f32_16x16x32_bf16 v[112:115], v[48:51], a[132:135], v[112:115]
    v_mfma_f32_16x16x32_bf16 v[112:115], v[52:55], a[160:163], v[112:115]
    v_mfma_f32_16x16x32_bf16 v[116:119], v[48:51], a[136:139], v[116:119]
    ds_read_b64_tr_b16 v[48:49], v0 offset:16512
    v_mfma_f32_16x16x32_bf16 v[116:119], v[52:55], a[164:167], v[116:119]
    ds_read_b64_tr_b16 v[50:51], v0 offset:17024
    v_mfma_f32_16x16x32_bf16 v[92:95], v[56:59], a[168:171], v[92:95]
    buffer_load_dwordx4 v24, s[24:27], s83 offen offset:2048 lds
    v_mfma_f32_16x16x32_bf16 v[92:95], v[60:63], a[196:199], v[92:95]
    s_add_u32 s83, s83, 27648
    ds_read_b64_tr_b16 v[52:53], v0 offset:17536
    v_mfma_f32_16x16x32_bf16 v[96:99], v[56:59], a[172:175], v[96:99]
    ds_read_b64_tr_b16 v[54:55], v0 offset:18048
    v_mfma_f32_16x16x32_bf16 v[96:99], v[60:63], a[200:203], v[96:99]
    v_mfma_f32_16x16x32_bf16 v[100:103], v[56:59], a[176:179], v[100:103]
    buffer_load_dwordx4 v24, s[24:27], s83 offen offset:3072 lds
    v_mfma_f32_16x16x32_bf16 v[100:103], v[60:63], a[204:207], v[100:103]
    s_lshl_b32 s83, s76, 7
    v_cvt_pk_bf16_f32 v92, v92, v93
    v_cvt_pk_bf16_f32 v93, v94, v95
    v_mfma_f32_16x16x32_bf16 v[104:107], v[56:59], a[180:183], v[104:107]
    s_add_u32 s83, s83, s88
    v_cvt_pk_bf16_f32 v94, v96, v97
    v_cvt_pk_bf16_f32 v95, v98, v99
    v_mfma_f32_16x16x32_bf16 v[104:107], v[60:63], a[208:211], v[104:107]
    s_add_u32 s76, s76, 1
    v_cvt_pk_bf16_f32 v100, v100, v101
    v_cvt_pk_bf16_f32 v101, v102, v103
    v_mfma_f32_16x16x32_bf16 v[108:111], v[56:59], a[184:187], v[108:111]
    s_cmp_ge_u32 s76, 7
    s_cselect_b32 s76, 0, s76
    s_add_u32 m0, s74, 0
    v_mfma_f32_16x16x32_bf16 v[108:111], v[60:63], a[212:215], v[108:111]
    v_mfma_f32_16x16x32_bf16 v[112:115], v[56:59], a[188:191], v[112:115]
    v_cvt_pk_bf16_f32 v102, v104, v105
    v_cvt_pk_bf16_f32 v103, v106, v107
    v_mfma_f32_16x16x32_bf16 v[112:115], v[60:63], a[216:219], v[112:115]
    v_mfma_f32_16x16x32_bf16 v[116:119], v[56:59], a[192:195], v[116:119]
    ds_read_b64_tr_b16 v[56:57], v0 offset:18560
    v_mfma_f32_16x16x32_bf16 v[116:119], v[60:63], a[220:223], v[116:119]
    s_waitcnt lgkmcnt(9)
    ds_read_b64_tr_b16 v[58:59], v0 offset:19072
    v_cvt_pk_bf16_f32 v108, v108, v109
    v_mfma_f32_16x16x32_bf16 v[120:123], v[32:35], a[0:3], v[120:123]
    ds_read_b64_tr_b16 v[60:61], v0 offset:19584
    v_cvt_pk_bf16_f32 v109, v110, v111
    v_mfma_f32_16x16x32_bf16 v[120:123], v[36:39], a[28:31], v[120:123]
    ds_read_b64_tr_b16 v[62:63], v0 offset:20096
    v_cvt_pk_bf16_f32 v110, v112, v113
    v_mfma_f32_16x16x32_bf16 v[124:127], v[32:35], a[4:7], v[124:127]
    v_cvt_pk_bf16_f32 v111, v114, v115
    v_cvt_pk_bf16_f32 v116, v116, v117
    v_mfma_f32_16x16x32_bf16 v[124:127], v[36:39], a[32:35], v[124:127]
    v_cvt_pk_bf16_f32 v117, v118, v119
    v_lshrrev_b32 v1, 4, v26
    v_mfma_f32_16x16x32_bf16 v[128:131], v[32:35], a[8:11], v[128:131]
    buffer_store_dwordx4 v[92:95], v26, s[28:31], s41 offen sc1
    v_mfma_f32_16x16x32_bf16 v[128:131], v[36:39], a[36:39], v[128:131]
    v_lshrrev_b32_e64 v7, 4, v1
    v_bfe_u32 v8, v1, 2, 2
    v_mfma_f32_16x16x32_bf16 v[132:135], v[32:35], a[12:15], v[132:135]
    s_waitcnt vmcnt(13) lgkmcnt(0)
    s_barrier
    v_mfma_f32_16x16x32_bf16 v[132:135], v[36:39], a[40:43], v[132:135]
    v_xor_b32 v8, v8, v7
    v_min_u32 v8, 1, v8
    v_mfma_f32_16x16x32_bf16 v[136:139], v[32:35], a[16:19], v[136:139]
    v_xor_b32_e64 v8, 1, v8
    v_mul_u32_u24 v8, 0x3f80, v8
    v_mfma_f32_16x16x32_bf16 v[136:139], v[36:39], a[44:47], v[136:139]
    buffer_store_dwordx4 v[100:103], v26, s[28:31], s41 offen offset:1024 sc1
    v_mfma_f32_16x16x32_bf16 v[140:143], v[32:35], a[20:23], v[140:143]
    s_mul_i32 s40, s75, 229376
    v_and_b32 v9, 1, v1
    v_lshlrev_b32 v9, 4, v9
    v_mfma_f32_16x16x32_bf16 v[140:143], v[36:39], a[48:51], v[140:143]
    buffer_load_dwordx4 v24, s[24:27], s83 offen lds
    v_mfma_f32_16x16x32_bf16 v[144:147], v[32:35], a[24:27], v[144:147]
    s_add_u32 s83, s83, 27648
    ds_read_b64_tr_b16 v[32:33], v0 offset:33024
    v_lshlrev_b32_e64 v8, v9, v8
    v_mfma_f32_16x16x32_bf16 v[144:147], v[36:39], a[52:55], v[144:147]
    ds_read_b64_tr_b16 v[34:35], v0 offset:33536
    v_bfe_i32 v9, v1, 1, 1
    v_mfma_f32_16x16x32_bf16 v[120:123], v[40:43], a[56:59], v[120:123]
    s_add_u32 s40, s40, s80
    ds_read_b64_tr_b16 v[36:37], v0 offset:34048
    v_and_b32_e64 v13, v8, v9
    v_mfma_f32_16x16x32_bf16 v[120:123], v[44:47], a[84:87], v[120:123]
    s_lshl_b32 s44, s75, 9
    ds_read_b64_tr_b16 v[38:39], v0 offset:34560
    v_xor_b32_e64 v12, v13, v8
    v_mfma_f32_16x16x32_bf16 v[124:127], v[40:43], a[60:63], v[124:127]
    buffer_load_dwordx4 v24, s[24:27], s83 offen offset:1024 lds
    v_mfma_f32_16x16x32_bf16 v[124:127], v[44:47], a[88:91], v[124:127]
    s_add_u32 s83, s83, 27648
    v_mov_b32 v14, 0
    v_mov_b32 v15, 0
    v_mfma_f32_16x16x32_bf16 v[128:131], v[40:43], a[64:67], v[128:131]
    s_add_u32 s44, s44, s95
    v_mov_b32 v16, 0
    v_mov_b32_e64 v17, 0
    v_mfma_f32_16x16x32_bf16 v[128:131], v[44:47], a[92:95], v[128:131]
    buffer_store_dwordx4 v[108:111], v26, s[28:31], s41 offen offset:2048 sc1
    v_mfma_f32_16x16x32_bf16 v[132:135], v[40:43], a[68:71], v[132:135]
    s_add_u32 s75, s75, 1
    v_mov_b32 v18, v12
    v_mov_b32_e64 v20, v12
    v_mfma_f32_16x16x32_bf16 v[132:135], v[44:47], a[96:99], v[132:135]
    buffer_load_dwordx4 v24, s[24:27], s83 offen offset:2048 lds
    v_mfma_f32_16x16x32_bf16 v[136:139], v[40:43], a[72:75], v[136:139]
    s_add_u32 s83, s83, 27648
    v_mov_b32 v22, v12
    v_mov_b32 v19, v13
    v_mfma_f32_16x16x32_bf16 v[136:139], v[44:47], a[100:103], v[136:139]
    s_cmp_ge_u32 s75, 7
    s_cselect_b32 s75, 0, s75
    v_mov_b32 v21, v13
    v_mov_b32 v23, v13
    v_mfma_f32_16x16x32_bf16 v[140:143], v[40:43], a[76:79], v[140:143]
    v_and_b32 v25, 15, v1
    v_mul_u32_u24 v25, 144, v25
    v_mfma_f32_16x16x32_bf16 v[140:143], v[44:47], a[104:107], v[140:143]
    v_lshl_add_u32 v25, v7, 3, v25
    s_lshl_b32 s49, s3, 5
    v_mfma_f32_16x16x32_bf16 v[144:147], v[40:43], a[80:83], v[144:147]
    buffer_load_dwordx4 v24, s[24:27], s83 offen offset:3072 lds
    v_mfma_f32_16x16x32_bf16 v[144:147], v[44:47], a[108:111], v[144:147]
    ds_read_b64_tr_b16 v[40:41], v0 offset:35072
    s_add_u32 s83, s83, 31744
    v_mfma_f32_16x16x32_bf16 v[120:123], v[48:51], a[112:115], v[120:123]
    s_add_u32 m0, s74, 16512
    ds_read_b64_tr_b16 v[42:43], v0 offset:35584
    s_add_u32 s49, s49, 99840
    v_mfma_f32_16x16x32_bf16 v[120:123], v[52:55], a[140:143], v[120:123]
    buffer_store_dwordx2 v[116:117], v27, s[28:31], s41 offen offset:3072 sc1
    v_mfma_f32_16x16x32_bf16 v[124:127], v[48:51], a[116:119], v[124:127]
    ds_read_b64_tr_b16 v[44:45], v0 offset:36096
    v_add_u32 v25, s49, v25
    v_mfma_f32_16x16x32_bf16 v[124:127], v[52:55], a[144:147], v[124:127]
    buffer_load_dwordx4 v24, s[24:27], s83 offen lds
    v_mfma_f32_16x16x32_bf16 v[128:131], v[48:51], a[120:123], v[128:131]
    s_add_u32 s83, s83, 27648
    ds_read_b64_tr_b16 v[46:47], v0 offset:36608
    s_mul_i32 s49, s3, 28
    v_mfma_f32_16x16x32_bf16 v[128:131], v[52:55], a[148:151], v[128:131]
    v_lshrrev_b32 v7, 3, v1
    v_add_u32 v7, s49, v7
    v_mfma_f32_16x16x32_bf16 v[132:135], v[48:51], a[124:127], v[132:135]
    v_and_b32 v8, 0x70, v26
    v_mul_u32_u24 v4, 144, v7
    v_mfma_f32_16x16x32_bf16 v[132:135], v[52:55], a[152:155], v[132:135]
    v_add_u32 v4, v4, v8
    v_add_u32 v4, 99840, v4
    v_mfma_f32_16x16x32_bf16 v[136:139], v[48:51], a[128:131], v[136:139]
    buffer_load_dwordx4 v24, s[24:27], s83 offen offset:1024 lds
    v_mfma_f32_16x16x32_bf16 v[136:139], v[52:55], a[156:159], v[136:139]
    s_add_u32 s83, s83, 27648
    s_waitcnt vmcnt(14)
    s_mul_i32 s49, s89, 96
    v_mfma_f32_16x16x32_bf16 v[140:143], v[48:51], a[132:135], v[140:143]
    buffer_store_dword v5, v11, s[28:31], s42 offen sc1
    v_mfma_f32_16x16x32_bf16 v[140:143], v[52:55], a[160:163], v[140:143]
    s_mul_i32 s47, s89, 4294967216
    s_add_u32 s47, s47, 96
    v_add_u32_e64 v9, 32, v7
    v_mfma_f32_16x16x32_bf16 v[144:147], v[48:51], a[136:139], v[144:147]
    ds_read_b64_tr_b16 v[48:49], v0 offset:49536
    v_lshrrev_b32 v9, 7, v9
    v_mfma_f32_16x16x32_bf16 v[144:147], v[52:55], a[164:167], v[144:147]
    ds_read_b64_tr_b16 v[50:51], v0 offset:50048
    v_mul_u32_u24 v9, s47, v9
    v_mfma_f32_16x16x32_bf16 v[120:123], v[56:59], a[168:171], v[120:123]
    buffer_load_dwordx4 v24, s[24:27], s83 offen offset:2048 lds
    v_mfma_f32_16x16x32_bf16 v[120:123], v[60:63], a[196:199], v[120:123]
    s_add_u32 s83, s83, 27648
    ds_read_b64_tr_b16 v[52:53], v0 offset:50560
    v_add3_u32 v9, v9, v7, s49
    v_mfma_f32_16x16x32_bf16 v[124:127], v[56:59], a[172:175], v[124:127]
    ds_read_b64_tr_b16 v[54:55], v0 offset:51072
    v_add_u32_e64 v9, 0, v9
    v_mfma_f32_16x16x32_bf16 v[124:127], v[60:63], a[200:203], v[124:127]
    v_mul_u32_u24 v9, 1792, v9
    v_cvt_pk_bf16_f32 v120, v120, v121
    v_mfma_f32_16x16x32_bf16 v[128:131], v[56:59], a[176:179], v[128:131]
    buffer_load_dwordx4 v24, s[24:27], s83 offen offset:3072 lds
    v_mfma_f32_16x16x32_bf16 v[128:131], v[60:63], a[204:207], v[128:131]
    s_lshl_b32 s83, s76, 7
    v_cvt_pk_bf16_f32 v121, v122, v123
    v_add_u32 v9, v9, v8
    v_mfma_f32_16x16x32_bf16 v[132:135], v[56:59], a[180:183], v[132:135]
    s_add_u32 s83, s83, s88
    v_cvt_pk_bf16_f32 v122, v124, v125
    v_cvt_pk_bf16_f32 v123, v126, v127
    v_mfma_f32_16x16x32_bf16 v[132:135], v[60:63], a[208:211], v[132:135]
    s_add_u32 s76, s76, 1
    v_cvt_pk_bf16_f32 v128, v128, v129
    v_cvt_pk_bf16_f32 v129, v130, v131
    v_mfma_f32_16x16x32_bf16 v[136:139], v[56:59], a[184:187], v[136:139]
    s_cmp_ge_u32 s76, 7
    s_cselect_b32 s76, 0, s76
    v_accvgpr_write_b32 a224, v9
    v_add_u32_e64 v9, 40, v7
    v_mfma_f32_16x16x32_bf16 v[136:139], v[60:63], a[212:215], v[136:139]
    s_add_u32 m0, s74, 33024
    v_cvt_pk_bf16_f32 v130, v132, v133
    v_cvt_pk_bf16_f32 v131, v134, v135
    v_mfma_f32_16x16x32_bf16 v[140:143], v[56:59], a[188:191], v[140:143]
    v_lshrrev_b32_e64 v9, 7, v9
    v_mul_u32_u24 v9, s47, v9
    v_mfma_f32_16x16x32_bf16 v[140:143], v[60:63], a[216:219], v[140:143]
    buffer_load_dword v2, v3, s[28:31], s72 offen sc1
    v_mfma_f32_16x16x32_bf16 v[144:147], v[56:59], a[192:195], v[144:147]
    ds_read_b64_tr_b16 v[56:57], v0 offset:51584
    v_cvt_pk_bf16_f32 v136, v136, v137
    v_mfma_f32_16x16x32_bf16 v[144:147], v[60:63], a[220:223], v[144:147]
    s_waitcnt lgkmcnt(9)
    ds_read_b64_tr_b16 v[58:59], v0 offset:52096
    v_cvt_pk_bf16_f32 v137, v138, v139
    v_mfma_f32_16x16x32_bf16 v[148:151], v[32:35], a[0:3], v[148:151]
    ds_read_b64_tr_b16 v[60:61], v0 offset:52608
    v_cvt_pk_bf16_f32 v138, v140, v141
    v_mfma_f32_16x16x32_bf16 v[148:151], v[36:39], a[28:31], v[148:151]
    ds_read_b64_tr_b16 v[62:63], v0 offset:53120
    v_cvt_pk_bf16_f32 v139, v142, v143
    v_mfma_f32_16x16x32_bf16 v[152:155], v[32:35], a[4:7], v[152:155]
    v_cvt_pk_bf16_f32 v144, v144, v145
    v_cvt_pk_bf16_f32 v145, v146, v147
    v_mfma_f32_16x16x32_bf16 v[152:155], v[36:39], a[32:35], v[152:155]
    buffer_store_dwordx4 v[120:123], v26, s[28:31], s40 offen sc1
    v_mfma_f32_16x16x32_bf16 v[156:159], v[32:35], a[8:11], v[156:159]
    v_add3_u32 v9, v9, v7, s49
    v_add_u32_e64 v9, 8, v9
    v_mfma_f32_16x16x32_bf16 v[156:159], v[36:39], a[36:39], v[156:159]
    v_mul_u32_u24 v9, 1792, v9
    v_add_u32_e64 v9, v9, v8
    v_mfma_f32_16x16x32_bf16 v[160:163], v[32:35], a[12:15], v[160:163]
    s_waitcnt vmcnt(15) lgkmcnt(0)
    s_barrier
    v_mfma_f32_16x16x32_bf16 v[160:163], v[36:39], a[40:43], v[160:163]
    v_accvgpr_write_b32 a225, v9
    v_add_u32_e64 v9, 48, v7
    v_mfma_f32_16x16x32_bf16 v[164:167], v[32:35], a[16:19], v[164:167]
    v_lshrrev_b32 v9, 7, v9
    v_mul_u32_u24 v9, s47, v9
    v_mfma_f32_16x16x32_bf16 v[164:167], v[36:39], a[44:47], v[164:167]
    buffer_store_dwordx4 v[128:131], v26, s[28:31], s40 offen offset:1024 sc1
    v_mfma_f32_16x16x32_bf16 v[168:171], v[32:35], a[20:23], v[168:171]
    s_mul_i32 s41, s75, 229376
    v_add3_u32 v9, v9, v7, s49
    v_add_u32_e64 v9, 16, v9
    v_mfma_f32_16x16x32_bf16 v[168:171], v[36:39], a[48:51], v[168:171]
    buffer_load_dwordx4 v24, s[24:27], s83 offen lds
    v_mfma_f32_16x16x32_bf16 v[172:175], v[32:35], a[24:27], v[172:175]
    s_add_u32 s83, s83, 27648
    ds_read_b64_tr_b16 v[32:33], v10 offset:0
    v_mul_u32_u24 v9, 1792, v9
    v_mfma_f32_16x16x32_bf16 v[172:175], v[36:39], a[52:55], v[172:175]
    ds_read_b64_tr_b16 v[34:35], v10 offset:512
    v_add_u32 v9, v9, v8
    v_mfma_f32_16x16x32_bf16 v[148:151], v[40:43], a[56:59], v[148:151]
    s_add_u32 s41, s41, s80
    ds_read_b64_tr_b16 v[36:37], v10 offset:1024
    v_accvgpr_write_b32 a226, v9
    v_mfma_f32_16x16x32_bf16 v[148:151], v[44:47], a[84:87], v[148:151]
    s_lshl_b32 s45, s75, 9
    ds_read_b64_tr_b16 v[38:39], v10 offset:1536
    v_add_u32 v9, 56, v7
    v_mfma_f32_16x16x32_bf16 v[152:155], v[40:43], a[60:63], v[152:155]
    buffer_load_dwordx4 v24, s[24:27], s83 offen offset:1024 lds
    v_mfma_f32_16x16x32_bf16 v[152:155], v[44:47], a[88:91], v[152:155]
    s_add_u32 s83, s83, 27648
    v_lshrrev_b32 v9, 7, v9
    v_mul_u32_u24 v9, s47, v9
    v_mfma_f32_16x16x32_bf16 v[156:159], v[40:43], a[64:67], v[156:159]
    s_add_u32 s45, s45, s95
    v_add3_u32 v9, v9, v7, s49
    v_add_u32 v9, 24, v9
    v_mfma_f32_16x16x32_bf16 v[156:159], v[44:47], a[92:95], v[156:159]
    buffer_store_dwordx4 v[136:139], v26, s[28:31], s40 offen offset:2048 sc1
    v_mfma_f32_16x16x32_bf16 v[160:163], v[40:43], a[68:71], v[160:163]
    s_add_u32 s75, s75, 1
    v_mul_u32_u24 v9, 1792, v9
    v_add_u32 v9, v9, v8
    v_mfma_f32_16x16x32_bf16 v[160:163], v[44:47], a[96:99], v[160:163]
    buffer_load_dwordx4 v24, s[24:27], s83 offen offset:2048 lds
    v_mfma_f32_16x16x32_bf16 v[164:167], v[40:43], a[72:75], v[164:167]
    s_add_u32 s83, s83, 27648
    v_lshrrev_b32_e64 v1, 5, v1
    v_lshl_or_b32 v9, v1, 31, v9
    v_mfma_f32_16x16x32_bf16 v[164:167], v[44:47], a[100:103], v[164:167]
    s_cmp_ge_u32 s75, 7
    s_cselect_b32 s75, 0, s75
    v_accvgpr_write_b32 a227, v9
    v_mfma_f32_16x16x32_bf16 v[168:171], v[40:43], a[76:79], v[168:171]
    v_mfma_f32_16x16x32_bf16 v[168:171], v[44:47], a[104:107], v[168:171]
    v_mfma_f32_16x16x32_bf16 v[172:175], v[40:43], a[80:83], v[172:175]
    buffer_load_dwordx4 v24, s[24:27], s83 offen offset:3072 lds
    v_mfma_f32_16x16x32_bf16 v[172:175], v[44:47], a[108:111], v[172:175]
    ds_read_b64_tr_b16 v[40:41], v10 offset:2048
    s_add_u32 s83, s83, 31744
    v_mfma_f32_16x16x32_bf16 v[148:151], v[48:51], a[112:115], v[148:151]
    s_add_u32 m0, s74, 49536
    ds_read_b64_tr_b16 v[42:43], v10 offset:2560
    v_mfma_f32_16x16x32_bf16 v[148:151], v[52:55], a[140:143], v[148:151]
    buffer_store_dwordx2 v[144:145], v27, s[28:31], s40 offen offset:3072 sc1
    v_mfma_f32_16x16x32_bf16 v[152:155], v[48:51], a[116:119], v[152:155]
    ds_read_b64_tr_b16 v[44:45], v10 offset:3072
    v_mfma_f32_16x16x32_bf16 v[152:155], v[52:55], a[144:147], v[152:155]
    buffer_load_dwordx4 v24, s[24:27], s83 offen lds
    v_mfma_f32_16x16x32_bf16 v[156:159], v[48:51], a[120:123], v[156:159]
    s_add_u32 s83, s83, 27648
    ds_read_b64_tr_b16 v[46:47], v10 offset:3584
    v_mfma_f32_16x16x32_bf16 v[156:159], v[52:55], a[148:151], v[156:159]
    v_mfma_f32_16x16x32_bf16 v[160:163], v[48:51], a[124:127], v[160:163]
    v_mfma_f32_16x16x32_bf16 v[160:163], v[52:55], a[152:155], v[160:163]
    v_mfma_f32_16x16x32_bf16 v[164:167], v[48:51], a[128:131], v[164:167]
    buffer_load_dwordx4 v24, s[24:27], s83 offen offset:1024 lds
    v_mfma_f32_16x16x32_bf16 v[164:167], v[52:55], a[156:159], v[164:167]
    s_add_u32 s83, s83, 27648
    s_waitcnt vmcnt(16)
    v_mfma_f32_16x16x32_bf16 v[168:171], v[48:51], a[132:135], v[168:171]
    buffer_store_dword v5, v11, s[28:31], s43 offen sc1
    v_mfma_f32_16x16x32_bf16 v[168:171], v[52:55], a[160:163], v[168:171]
    v_mfma_f32_16x16x32_bf16 v[172:175], v[48:51], a[136:139], v[172:175]
    ds_read_b64_tr_b16 v[48:49], v10 offset:16512
    v_mfma_f32_16x16x32_bf16 v[172:175], v[52:55], a[164:167], v[172:175]
    ds_read_b64_tr_b16 v[50:51], v10 offset:17024
    v_mfma_f32_16x16x32_bf16 v[148:151], v[56:59], a[168:171], v[148:151]
    buffer_load_dwordx4 v24, s[24:27], s83 offen offset:2048 lds
    v_mfma_f32_16x16x32_bf16 v[148:151], v[60:63], a[196:199], v[148:151]
    s_add_u32 s83, s83, 27648
    ds_read_b64_tr_b16 v[52:53], v10 offset:17536
    v_mfma_f32_16x16x32_bf16 v[152:155], v[56:59], a[172:175], v[152:155]
    ds_read_b64_tr_b16 v[54:55], v10 offset:18048
    v_mfma_f32_16x16x32_bf16 v[152:155], v[60:63], a[200:203], v[152:155]
    v_mfma_f32_16x16x32_bf16 v[156:159], v[56:59], a[176:179], v[156:159]
    buffer_load_dwordx4 v24, s[24:27], s83 offen offset:3072 lds
    v_mfma_f32_16x16x32_bf16 v[156:159], v[60:63], a[204:207], v[156:159]
    v_cvt_pk_bf16_f32 v148, v148, v149
    v_cvt_pk_bf16_f32 v149, v150, v151
    v_mfma_f32_16x16x32_bf16 v[160:163], v[56:59], a[180:183], v[160:163]
    v_mfma_f32_16x16x32_bf16 v[160:163], v[60:63], a[208:211], v[160:163]
    v_mfma_f32_16x16x32_bf16 v[164:167], v[56:59], a[184:187], v[164:167]
    v_cvt_pk_bf16_f32 v150, v152, v153
    v_cvt_pk_bf16_f32 v151, v154, v155
    v_mfma_f32_16x16x32_bf16 v[164:167], v[60:63], a[212:215], v[164:167]
    v_cvt_pk_bf16_f32 v156, v156, v157
    v_cvt_pk_bf16_f32 v157, v158, v159
    v_mfma_f32_16x16x32_bf16 v[168:171], v[56:59], a[188:191], v[168:171]
    v_mfma_f32_16x16x32_bf16 v[168:171], v[60:63], a[216:219], v[168:171]
    v_cvt_pk_bf16_f32 v158, v160, v161
    v_cvt_pk_bf16_f32 v159, v162, v163
    v_mfma_f32_16x16x32_bf16 v[172:175], v[56:59], a[192:195], v[172:175]
    ds_read_b64_tr_b16 v[56:57], v10 offset:18560
    v_cvt_pk_bf16_f32 v164, v164, v165
    v_mfma_f32_16x16x32_bf16 v[172:175], v[60:63], a[220:223], v[172:175]
    s_waitcnt lgkmcnt(9)
    ds_read_b64_tr_b16 v[58:59], v10 offset:19072
    v_cvt_pk_bf16_f32 v165, v166, v167
    v_mfma_f32_16x16x32_bf16 v[176:179], v[32:35], a[0:3], v[176:179]
    s_mul_i32 s86, s89, 172032
    ds_read_b64_tr_b16 v[60:61], v10 offset:19584
    v_cvt_pk_bf16_f32 v166, v168, v169
    v_mfma_f32_16x16x32_bf16 v[176:179], v[36:39], a[28:31], v[176:179]
    s_add_u32 s87, s89, 12
    ds_read_b64_tr_b16 v[62:63], v10 offset:20096
    v_cvt_pk_bf16_f32 v167, v170, v171
    v_mfma_f32_16x16x32_bf16 v[180:183], v[32:35], a[4:7], v[180:183]
    s_mul_i32 s87, s87, 28672
    v_cvt_pk_bf16_f32 v172, v172, v173
    v_cvt_pk_bf16_f32 v173, v174, v175
    v_mfma_f32_16x16x32_bf16 v[180:183], v[36:39], a[32:35], v[180:183]
    buffer_store_dwordx4 v[148:151], v26, s[28:31], s41 offen sc1
    v_mfma_f32_16x16x32_bf16 v[184:187], v[32:35], a[8:11], v[184:187]
    s_mov_b32 s52, 400000
    s_mov_b32 s46, 0
    s_mov_b32 s48, 0
    v_mfma_f32_16x16x32_bf16 v[184:187], v[36:39], a[36:39], v[184:187]
    s_waitcnt vmcnt(14)
    v_cmp_ne_u32 vcc, 0, v2
    v_mfma_f32_16x16x32_bf16 v[188:191], v[32:35], a[12:15], v[188:191]
    s_andn2_b32 s67, vcc_lo, s68
    s_waitcnt vmcnt(15) lgkmcnt(0)
    s_barrier
    v_mfma_f32_16x16x32_bf16 v[188:191], v[36:39], a[40:43], v[188:191]
    s_ff1_i32_b32 s69, s67
    s_cmp_lg_u32 s67, 0
    s_cselect_b32 s10, 2756608, 0
    s_bitset0_b32 s67, s69
    v_mfma_f32_16x16x32_bf16 v[192:195], v[32:35], a[16:19], v[192:195]
    s_bitset1_b32 s68, s69
    s_and_b32 s69, s69, 7
    s_mul_i32 s70, s69, 3584
    v_mfma_f32_16x16x32_bf16 v[192:195], v[36:39], a[44:47], v[192:195]
    s_add_u32 s70, s70, s71
    s_mul_i32 s40, s75, 229376
    s_add_u32 s40, s40, s80
    v_mfma_f32_16x16x32_bf16 v[196:199], v[32:35], a[20:23], v[196:199]
    buffer_store_dwordx4 v[156:159], v26, s[28:31], s41 offen offset:1024 sc1
    v_mfma_f32_16x16x32_bf16 v[196:199], v[36:39], a[48:51], v[196:199]
    buffer_load_dwordx4 v[64:67], v26, s[8:11], s70 offen sc1
    v_mfma_f32_16x16x32_bf16 v[200:203], v[32:35], a[24:27], v[200:203]
    s_lshl_b32 s42, s75, 9
    ds_read_b64_tr_b16 v[32:33], v0 offset:0
    s_add_u32 s42, s42, s95
    v_mfma_f32_16x16x32_bf16 v[200:203], v[36:39], a[52:55], v[200:203]
    ds_read_b64_tr_b16 v[34:35], v0 offset:512
    s_add_u32 s75, s75, 1
    v_mfma_f32_16x16x32_bf16 v[176:179], v[40:43], a[56:59], v[176:179]
    s_cmp_ge_u32 s75, 7
    s_cselect_b32 s75, 0, s75
    ds_read_b64_tr_b16 v[36:37], v0 offset:1024
    v_mfma_f32_16x16x32_bf16 v[176:179], v[44:47], a[84:87], v[176:179]
    buffer_load_dwordx4 v[68:71], v26, s[8:11], s70 offen offset:1024 sc1
    v_mfma_f32_16x16x32_bf16 v[180:183], v[40:43], a[60:63], v[180:183]
    ds_read_b64_tr_b16 v[38:39], v0 offset:1536
    v_mfma_f32_16x16x32_bf16 v[180:183], v[44:47], a[88:91], v[180:183]
    v_mfma_f32_16x16x32_bf16 v[184:187], v[40:43], a[64:67], v[184:187]
    v_mfma_f32_16x16x32_bf16 v[184:187], v[44:47], a[92:95], v[184:187]
    buffer_load_dwordx4 v[72:75], v26, s[8:11], s70 offen offset:2048 sc1
    v_mfma_f32_16x16x32_bf16 v[188:191], v[40:43], a[68:71], v[188:191]
    buffer_store_dwordx4 v[164:167], v26, s[28:31], s41 offen offset:2048 sc1
    v_mfma_f32_16x16x32_bf16 v[188:191], v[44:47], a[96:99], v[188:191]
    v_mfma_f32_16x16x32_bf16 v[192:195], v[40:43], a[72:75], v[192:195]
    v_mfma_f32_16x16x32_bf16 v[192:195], v[44:47], a[100:103], v[192:195]
    buffer_load_dwordx2 v[88:89], v27, s[8:11], s70 offen offset:3072 sc1
    v_mfma_f32_16x16x32_bf16 v[196:199], v[40:43], a[76:79], v[196:199]
    s_ff1_i32_b32 s69, s67
    s_cmp_lg_u32 s67, 0
    s_cselect_b32 s10, 2756608, 0
    s_bitset0_b32 s67, s69
    v_mfma_f32_16x16x32_bf16 v[196:199], v[44:47], a[104:107], v[196:199]
    s_bitset1_b32 s68, s69
    s_and_b32 s69, s69, 7
    s_mul_i32 s70, s69, 3584
    v_mfma_f32_16x16x32_bf16 v[200:203], v[40:43], a[80:83], v[200:203]
    s_add_u32 s70, s70, s71
    ds_read_b64_tr_b16 v[40:41], v0 offset:2048
    v_mfma_f32_16x16x32_bf16 v[200:203], v[44:47], a[108:111], v[200:203]
    ds_read_b64_tr_b16 v[42:43], v0 offset:2560
    v_mfma_f32_16x16x32_bf16 v[176:179], v[48:51], a[112:115], v[176:179]
    buffer_load_dwordx4 v[76:79], v26, s[8:11], s70 offen sc1
    v_mfma_f32_16x16x32_bf16 v[176:179], v[52:55], a[140:143], v[176:179]
    buffer_store_dwordx2 v[172:173], v27, s[28:31], s41 offen offset:3072 sc1
    v_mfma_f32_16x16x32_bf16 v[180:183], v[48:51], a[116:119], v[180:183]
    ds_read_b64_tr_b16 v[44:45], v0 offset:3072
    v_mfma_f32_16x16x32_bf16 v[180:183], v[52:55], a[144:147], v[180:183]
    buffer_load_dwordx4 v[80:83], v26, s[8:11], s70 offen offset:1024 sc1
    v_mfma_f32_16x16x32_bf16 v[184:187], v[48:51], a[120:123], v[184:187]
    ds_read_b64_tr_b16 v[46:47], v0 offset:3584
    v_mfma_f32_16x16x32_bf16 v[184:187], v[52:55], a[148:151], v[184:187]
    v_mfma_f32_16x16x32_bf16 v[188:191], v[48:51], a[124:127], v[188:191]
    v_mfma_f32_16x16x32_bf16 v[188:191], v[52:55], a[152:155], v[188:191]
    buffer_load_dwordx4 v[84:87], v26, s[8:11], s70 offen offset:2048 sc1
    v_mfma_f32_16x16x32_bf16 v[192:195], v[48:51], a[128:131], v[192:195]
    v_mfma_f32_16x16x32_bf16 v[192:195], v[52:55], a[156:159], v[192:195]
    s_waitcnt vmcnt(16)
    v_mfma_f32_16x16x32_bf16 v[196:199], v[48:51], a[132:135], v[196:199]
    buffer_store_dword v5, v11, s[28:31], s44 offen sc1
    v_mfma_f32_16x16x32_bf16 v[196:199], v[52:55], a[160:163], v[196:199]
    buffer_load_dwordx2 v[90:91], v27, s[8:11], s70 offen offset:3072 sc1
    v_mfma_f32_16x16x32_bf16 v[200:203], v[48:51], a[136:139], v[200:203]
    s_ff1_i32_b32 s69, s67
    ds_read_b64_tr_b16 v[48:49], v0 offset:16512
    s_cmp_lg_u32 s67, 0
    s_cselect_b32 s10, 2756608, 0
    v_mfma_f32_16x16x32_bf16 v[200:203], v[52:55], a[164:167], v[200:203]
    ds_read_b64_tr_b16 v[50:51], v0 offset:17024
    s_bitset0_b32 s67, s69
    v_mfma_f32_16x16x32_bf16 v[176:179], v[56:59], a[168:171], v[176:179]
    s_bitset1_b32 s68, s69
    ds_read_b64_tr_b16 v[52:53], v0 offset:17536
    s_and_b32 s69, s69, 7
    v_mfma_f32_16x16x32_bf16 v[176:179], v[60:63], a[196:199], v[176:179]
    s_mul_i32 s70, s69, 3584
    ds_read_b64_tr_b16 v[54:55], v0 offset:18048
    s_add_u32 s70, s70, s71
    v_mfma_f32_16x16x32_bf16 v[180:183], v[56:59], a[172:175], v[180:183]
    buffer_load_dwordx4 v[92:95], v26, s[8:11], s70 offen sc1
    v_mfma_f32_16x16x32_bf16 v[180:183], v[60:63], a[200:203], v[180:183]
    v_mfma_f32_16x16x32_bf16 v[184:187], v[56:59], a[176:179], v[184:187]
    v_mfma_f32_16x16x32_bf16 v[184:187], v[60:63], a[204:207], v[184:187]
    buffer_load_dwordx4 v[96:99], v26, s[8:11], s70 offen offset:1024 sc1
    v_mfma_f32_16x16x32_bf16 v[188:191], v[56:59], a[180:183], v[188:191]
    v_cvt_pk_bf16_f32 v176, v176, v177
    v_cvt_pk_bf16_f32 v177, v178, v179
    v_mfma_f32_16x16x32_bf16 v[188:191], v[60:63], a[208:211], v[188:191]
    buffer_load_dword v6, v3, s[28:31], s72 offen sc1
    v_mfma_f32_16x16x32_bf16 v[192:195], v[56:59], a[184:187], v[192:195]
    v_cvt_pk_bf16_f32 v178, v180, v181
    v_cvt_pk_bf16_f32 v179, v182, v183
    v_mfma_f32_16x16x32_bf16 v[192:195], v[60:63], a[212:215], v[192:195]
    buffer_load_dwordx4 v[100:103], v26, s[8:11], s70 offen offset:2048 sc1
    v_mfma_f32_16x16x32_bf16 v[196:199], v[56:59], a[188:191], v[196:199]
    v_cvt_pk_bf16_f32 v184, v184, v185
    v_cvt_pk_bf16_f32 v185, v186, v187
    v_mfma_f32_16x16x32_bf16 v[196:199], v[60:63], a[216:219], v[196:199]
    v_cvt_pk_bf16_f32 v186, v188, v189
    v_cvt_pk_bf16_f32 v187, v190, v191
    v_mfma_f32_16x16x32_bf16 v[200:203], v[56:59], a[192:195], v[200:203]
    ds_read_b64_tr_b16 v[56:57], v0 offset:18560
    v_cvt_pk_bf16_f32 v192, v192, v193
    v_mfma_f32_16x16x32_bf16 v[200:203], v[60:63], a[220:223], v[200:203]
    s_waitcnt lgkmcnt(9)
    ds_read_b64_tr_b16 v[58:59], v0 offset:19072
    v_cvt_pk_bf16_f32 v193, v194, v195
    v_mfma_f32_16x16x32_bf16 v[204:207], v[32:35], a[0:3], v[204:207]
    buffer_load_dwordx2 v[116:117], v27, s[8:11], s70 offen offset:3072 sc1
    v_mfma_f32_16x16x32_bf16 v[204:207], v[36:39], a[28:31], v[204:207]
    s_ff1_i32_b32 s69, s67
    ds_read_b64_tr_b16 v[60:61], v0 offset:19584
    v_cvt_pk_bf16_f32 v194, v196, v197
    v_mfma_f32_16x16x32_bf16 v[208:211], v[32:35], a[4:7], v[208:211]
    s_cmp_lg_u32 s67, 0
    s_cselect_b32 s10, 2756608, 0
    ds_read_b64_tr_b16 v[62:63], v0 offset:20096
    v_cvt_pk_bf16_f32 v195, v198, v199
    v_mfma_f32_16x16x32_bf16 v[208:211], v[36:39], a[32:35], v[208:211]
    s_bitset0_b32 s67, s69
    v_cvt_pk_bf16_f32 v200, v200, v201
    v_cvt_pk_bf16_f32 v201, v202, v203
    v_mfma_f32_16x16x32_bf16 v[212:215], v[32:35], a[8:11], v[212:215]
    buffer_store_dwordx4 v[176:179], v26, s[28:31], s40 offen sc1
    v_mfma_f32_16x16x32_bf16 v[212:215], v[36:39], a[36:39], v[212:215]
    s_bitset1_b32 s68, s69
    s_and_b32 s69, s69, 7
    s_mul_i32 s70, s69, 3584
    v_mfma_f32_16x16x32_bf16 v[216:219], v[32:35], a[12:15], v[216:219]
    s_add_u32 s70, s70, s71
    v_mfma_f32_16x16x32_bf16 v[216:219], v[36:39], a[40:43], v[216:219]
    buffer_load_dwordx4 v[104:107], v26, s[8:11], s70 offen sc1
    v_mfma_f32_16x16x32_bf16 v[220:223], v[32:35], a[16:19], v[220:223]
    buffer_load_dwordx4 v[108:111], v26, s[8:11], s70 offen offset:1024 sc1
    v_mfma_f32_16x16x32_bf16 v[220:223], v[36:39], a[44:47], v[220:223]
    buffer_store_dwordx4 v[184:187], v26, s[28:31], s40 offen offset:1024 sc1
    v_mfma_f32_16x16x32_bf16 v[224:227], v[32:35], a[20:23], v[224:227]
    s_waitcnt vmcnt(22) lgkmcnt(0)
    s_barrier
    v_mfma_f32_16x16x32_bf16 v[224:227], v[36:39], a[48:51], v[224:227]
    buffer_load_dwordx4 v[112:115], v26, s[8:11], s70 offen offset:2048 sc1
    v_mfma_f32_16x16x32_bf16 v[228:231], v[32:35], a[24:27], v[228:231]
    s_mul_i32 s41, s75, 229376
    ds_read_b64_tr_b16 v[32:33], v0 offset:33024
    s_add_u32 s41, s41, s80
    v_mfma_f32_16x16x32_bf16 v[228:231], v[36:39], a[52:55], v[228:231]
    ds_read_b64_tr_b16 v[34:35], v0 offset:33536
    s_lshl_b32 s43, s75, 9
    v_mfma_f32_16x16x32_bf16 v[204:207], v[40:43], a[56:59], v[204:207]
    s_add_u32 s43, s43, s95
    ds_read_b64_tr_b16 v[36:37], v0 offset:34048
    s_add_u32 s75, s75, 1
    v_mfma_f32_16x16x32_bf16 v[204:207], v[44:47], a[84:87], v[204:207]
    buffer_load_dwordx2 v[118:119], v27, s[8:11], s70 offen offset:3072 sc1
    v_mfma_f32_16x16x32_bf16 v[208:211], v[40:43], a[60:63], v[208:211]
    s_cmp_ge_u32 s75, 7
    s_cselect_b32 s75, 0, s75
    ds_read_b64_tr_b16 v[38:39], v0 offset:34560
    v_mfma_f32_16x16x32_bf16 v[208:211], v[44:47], a[88:91], v[208:211]
    v_mfma_f32_16x16x32_bf16 v[212:215], v[40:43], a[64:67], v[212:215]
    v_mfma_f32_16x16x32_bf16 v[212:215], v[44:47], a[92:95], v[212:215]
    buffer_store_dwordx4 v[192:195], v26, s[28:31], s40 offen offset:2048 sc1
    v_mfma_f32_16x16x32_bf16 v[216:219], v[40:43], a[68:71], v[216:219]
    v_mfma_f32_16x16x32_bf16 v[216:219], v[44:47], a[96:99], v[216:219]
    v_mfma_f32_16x16x32_bf16 v[220:223], v[40:43], a[72:75], v[220:223]
    v_mfma_f32_16x16x32_bf16 v[220:223], v[44:47], a[100:103], v[220:223]
    v_mfma_f32_16x16x32_bf16 v[224:227], v[40:43], a[76:79], v[224:227]
    v_mfma_f32_16x16x32_bf16 v[224:227], v[44:47], a[104:107], v[224:227]
    v_mfma_f32_16x16x32_bf16 v[228:231], v[40:43], a[80:83], v[228:231]
    ds_read_b64_tr_b16 v[40:41], v0 offset:35072
    v_mfma_f32_16x16x32_bf16 v[228:231], v[44:47], a[108:111], v[228:231]
    ds_read_b64_tr_b16 v[42:43], v0 offset:35584
    v_mfma_f32_16x16x32_bf16 v[204:207], v[48:51], a[112:115], v[204:207]
    ds_read_b64_tr_b16 v[44:45], v0 offset:36096
    v_mfma_f32_16x16x32_bf16 v[204:207], v[52:55], a[140:143], v[204:207]
    buffer_store_dwordx2 v[200:201], v27, s[28:31], s40 offen offset:3072 sc1
    v_mfma_f32_16x16x32_bf16 v[208:211], v[48:51], a[116:119], v[208:211]
    ds_read_b64_tr_b16 v[46:47], v0 offset:36608
    v_mov_b32 v200, 0
    v_mfma_f32_16x16x32_bf16 v[208:211], v[52:55], a[144:147], v[208:211]
    v_mov_b32 v201, 0
    v_mov_b32_e64 v202, 0
    v_mfma_f32_16x16x32_bf16 v[212:215], v[48:51], a[120:123], v[212:215]
    v_mov_b32 v203, 0
    v_mfma_f32_16x16x32_bf16 v[212:215], v[52:55], a[148:151], v[212:215]
    v_mfma_f32_16x16x32_bf16 v[216:219], v[48:51], a[124:127], v[216:219]
    v_mfma_f32_16x16x32_bf16 v[216:219], v[52:55], a[152:155], v[216:219]
    v_mfma_f32_16x16x32_bf16 v[220:223], v[48:51], a[128:131], v[220:223]
    v_mfma_f32_16x16x32_bf16 v[220:223], v[52:55], a[156:159], v[220:223]
    s_waitcnt vmcnt(17)
    v_mfma_f32_16x16x32_bf16 v[224:227], v[48:51], a[132:135], v[224:227]
    buffer_store_dword v5, v11, s[28:31], s45 offen sc1
    v_mfma_f32_16x16x32_bf16 v[224:227], v[52:55], a[160:163], v[224:227]
    v_mfma_f32_16x16x32_bf16 v[228:231], v[48:51], a[136:139], v[228:231]
    ds_read_b64_tr_b16 v[48:49], v0 offset:49536
    v_mfma_f32_16x16x32_bf16 v[228:231], v[52:55], a[164:167], v[228:231]
    ds_read_b64_tr_b16 v[50:51], v0 offset:50048
    v_mfma_f32_16x16x32_bf16 v[204:207], v[56:59], a[168:171], v[204:207]
    ds_read_b64_tr_b16 v[52:53], v0 offset:50560
    v_mfma_f32_16x16x32_bf16 v[204:207], v[60:63], a[196:199], v[204:207]
    ds_read_b64_tr_b16 v[54:55], v0 offset:51072
    v_mfma_f32_16x16x32_bf16 v[208:211], v[56:59], a[172:175], v[208:211]
    v_mfma_f32_16x16x32_bf16 v[208:211], v[60:63], a[200:203], v[208:211]
    v_mfma_f32_16x16x32_bf16 v[212:215], v[56:59], a[176:179], v[212:215]
    v_mfma_f32_16x16x32_bf16 v[212:215], v[60:63], a[204:207], v[212:215]
    v_mfma_f32_16x16x32_bf16 v[216:219], v[56:59], a[180:183], v[216:219]
    v_mfma_f32_16x16x32_bf16 v[216:219], v[60:63], a[208:211], v[216:219]
    v_mfma_f32_16x16x32_bf16 v[220:223], v[56:59], a[184:187], v[220:223]
    v_cvt_pk_bf16_f32 v204, v204, v205
    v_cvt_pk_bf16_f32 v205, v206, v207
    v_mfma_f32_16x16x32_bf16 v[220:223], v[60:63], a[212:215], v[220:223]
    v_cvt_pk_bf16_f32 v206, v208, v209
    v_cvt_pk_bf16_f32 v207, v210, v211
    v_mfma_f32_16x16x32_bf16 v[224:227], v[56:59], a[188:191], v[224:227]
    buffer_store_dwordx4 v[204:207], v26, s[28:31], s41 offen sc1
    v_mfma_f32_16x16x32_bf16 v[224:227], v[60:63], a[216:219], v[224:227]
    v_cvt_pk_bf16_f32 v212, v212, v213
    v_cvt_pk_bf16_f32 v213, v214, v215
    v_mfma_f32_16x16x32_bf16 v[228:231], v[56:59], a[192:195], v[228:231]
    ds_read_b64_tr_b16 v[56:57], v0 offset:51584
    v_cvt_pk_bf16_f32 v214, v216, v217
    v_mfma_f32_16x16x32_bf16 v[228:231], v[60:63], a[220:223], v[228:231]
    s_waitcnt lgkmcnt(9)
    ds_read_b64_tr_b16 v[58:59], v0 offset:52096
    v_cvt_pk_bf16_f32 v215, v218, v219
    v_mfma_f32_16x16x32_bf16 v[232:235], v[32:35], a[0:3], v[232:235]
    buffer_store_dwordx4 v[212:215], v26, s[28:31], s41 offen offset:1024 sc1
    v_mfma_f32_16x16x32_bf16 v[232:235], v[36:39], a[28:31], v[232:235]
    s_waitcnt vmcnt(13)
    ds_read_b64_tr_b16 v[60:61], v0 offset:52608
    v_cvt_pk_bf16_f32 v220, v220, v221
    v_mfma_f32_16x16x32_bf16 v[236:239], v[32:35], a[4:7], v[236:239]
    ds_read_b64_tr_b16 v[62:63], v0 offset:53120
    v_cvt_pk_bf16_f32 v221, v222, v223
    v_mfma_f32_16x16x32_bf16 v[236:239], v[36:39], a[32:35], v[236:239]
    v_cvt_pk_bf16_f32 v222, v224, v225
    v_cvt_pk_bf16_f32 v223, v226, v227
    v_mfma_f32_16x16x32_bf16 v[240:243], v[32:35], a[8:11], v[240:243]
    buffer_store_dwordx4 v[220:223], v26, s[28:31], s41 offen offset:2048 sc1
    v_mfma_f32_16x16x32_bf16 v[240:243], v[36:39], a[36:39], v[240:243]
    v_cvt_pk_bf16_f32 v228, v228, v229
    v_cvt_pk_bf16_f32 v229, v230, v231
    v_mfma_f32_16x16x32_bf16 v[244:247], v[32:35], a[12:15], v[244:247]
    buffer_store_dwordx2 v[228:229], v27, s[28:31], s41 offen offset:3072 sc1
    v_mfma_f32_16x16x32_bf16 v[244:247], v[36:39], a[40:43], v[244:247]
    v_cmp_ne_u32 vcc, 0, v6
    v_mov_b32_e64 v228, 0
    v_mfma_f32_16x16x32_bf16 v[248:251], v[32:35], a[16:19], v[248:251]
    s_andn2_b32 s67, vcc_lo, s68
    v_mov_b32_e64 v229, 0
    v_mov_b32 v230, 0
    v_mfma_f32_16x16x32_bf16 v[248:251], v[36:39], a[44:47], v[248:251]
    s_ff1_i32_b32 s69, s67
    s_cmp_lg_u32 s67, 0
    s_cselect_b32 s10, 2756608, 0
    s_bitset0_b32 s67, s69
    v_mfma_f32_16x16x32_bf16 v[252:255], v[32:35], a[20:23], v[252:255]
    s_bitset1_b32 s68, s69
    s_and_b32 s69, s69, 7
    s_mul_i32 s70, s69, 3584
    v_mfma_f32_16x16x32_bf16 v[252:255], v[36:39], a[48:51], v[252:255]
    s_add_u32 s70, s70, s71
    v_mov_b32_e64 v231, 0
    s_mul_i32 s40, s75, 229376
    v_mfma_f32_16x16x32_bf16 v[28:31], v[32:35], a[24:27], v[28:31]
    buffer_load_dwordx4 v[120:123], v26, s[8:11], s70 offen sc1
    v_mfma_f32_16x16x32_bf16 v[28:31], v[36:39], a[52:55], v[28:31]
    s_waitcnt lgkmcnt(8)
    s_add_u32 s40, s40, s80
    s_lshl_b32 s44, s75, 9
    v_mfma_f32_16x16x32_bf16 v[232:235], v[40:43], a[56:59], v[232:235]
    buffer_load_dwordx4 v[124:127], v26, s[8:11], s70 offen offset:1024 sc1
    v_mfma_f32_16x16x32_bf16 v[232:235], v[44:47], a[84:87], v[232:235]
    buffer_load_dwordx4 v[128:131], v26, s[8:11], s70 offen offset:2048 sc1
    v_mfma_f32_16x16x32_bf16 v[236:239], v[40:43], a[60:63], v[236:239]
    buffer_load_dwordx2 v[144:145], v27, s[8:11], s70 offen offset:3072 sc1
    v_mfma_f32_16x16x32_bf16 v[236:239], v[44:47], a[88:91], v[236:239]
    s_ff1_i32_b32 s69, s67
    s_cmp_lg_u32 s67, 0
    s_cselect_b32 s10, 2756608, 0
    s_bitset0_b32 s67, s69
    v_mfma_f32_16x16x32_bf16 v[240:243], v[40:43], a[64:67], v[240:243]
    s_bitset1_b32 s68, s69
    s_and_b32 s69, s69, 7
    s_mul_i32 s70, s69, 3584
    v_mfma_f32_16x16x32_bf16 v[240:243], v[44:47], a[92:95], v[240:243]
    s_add_u32 s70, s70, s71
    s_add_u32 s44, s44, s95
    s_add_u32 s75, s75, 1
    v_mfma_f32_16x16x32_bf16 v[244:247], v[40:43], a[68:71], v[244:247]
    buffer_load_dwordx4 v[132:135], v26, s[8:11], s70 offen sc1
    v_mfma_f32_16x16x32_bf16 v[244:247], v[44:47], a[96:99], v[244:247]
    buffer_load_dwordx4 v[136:139], v26, s[8:11], s70 offen offset:1024 sc1
    v_mfma_f32_16x16x32_bf16 v[248:251], v[40:43], a[72:75], v[248:251]
    buffer_load_dwordx4 v[140:143], v26, s[8:11], s70 offen offset:2048 sc1
    v_mfma_f32_16x16x32_bf16 v[248:251], v[44:47], a[100:103], v[248:251]
    buffer_load_dwordx2 v[146:147], v27, s[8:11], s70 offen offset:3072 sc1
    v_mfma_f32_16x16x32_bf16 v[252:255], v[40:43], a[76:79], v[252:255]
    s_ff1_i32_b32 s69, s67
    s_cmp_lg_u32 s67, 0
    s_cselect_b32 s10, 2756608, 0
    s_bitset0_b32 s67, s69
    v_mfma_f32_16x16x32_bf16 v[252:255], v[44:47], a[104:107], v[252:255]
    s_bitset1_b32 s68, s69
    s_and_b32 s69, s69, 7
    s_mul_i32 s70, s69, 3584
    v_mfma_f32_16x16x32_bf16 v[28:31], v[40:43], a[80:83], v[28:31]
    s_add_u32 s70, s70, s71
    s_cmp_ge_u32 s75, 7
    s_cselect_b32 s75, 0, s75
    v_mfma_f32_16x16x32_bf16 v[28:31], v[44:47], a[108:111], v[28:31]
    s_waitcnt lgkmcnt(4)
    v_mfma_f32_16x16x32_bf16 v[232:235], v[48:51], a[112:115], v[232:235]
    buffer_load_dwordx4 v[148:151], v26, s[8:11], s70 offen sc1
    v_mfma_f32_16x16x32_bf16 v[232:235], v[52:55], a[140:143], v[232:235]
    buffer_load_dwordx4 v[152:155], v26, s[8:11], s70 offen offset:1024 sc1
    v_mfma_f32_16x16x32_bf16 v[236:239], v[48:51], a[116:119], v[236:239]
    buffer_load_dwordx4 v[156:159], v26, s[8:11], s70 offen offset:2048 sc1
    v_mfma_f32_16x16x32_bf16 v[236:239], v[52:55], a[144:147], v[236:239]
    buffer_load_dwordx2 v[172:173], v27, s[8:11], s70 offen offset:3072 sc1
    v_mfma_f32_16x16x32_bf16 v[240:243], v[48:51], a[120:123], v[240:243]
    s_ff1_i32_b32 s69, s67
    s_cmp_lg_u32 s67, 0
    s_cselect_b32 s10, 2756608, 0
    s_bitset0_b32 s67, s69
    v_mfma_f32_16x16x32_bf16 v[240:243], v[52:55], a[148:151], v[240:243]
    s_bitset1_b32 s68, s69
    s_and_b32 s69, s69, 7
    s_mul_i32 s70, s69, 3584
    v_mfma_f32_16x16x32_bf16 v[244:247], v[48:51], a[124:127], v[244:247]
    s_add_u32 s70, s70, s71
    v_mfma_f32_16x16x32_bf16 v[244:247], v[52:55], a[152:155], v[244:247]
    buffer_load_dwordx4 v[160:163], v26, s[8:11], s70 offen sc1
    v_mfma_f32_16x16x32_bf16 v[248:251], v[48:51], a[128:131], v[248:251]
    buffer_load_dwordx4 v[164:167], v26, s[8:11], s70 offen offset:1024 sc1
    v_mfma_f32_16x16x32_bf16 v[248:251], v[52:55], a[156:159], v[248:251]
    s_waitcnt vmcnt(19)
    v_mfma_f32_16x16x32_bf16 v[252:255], v[48:51], a[132:135], v[252:255]
    buffer_store_dword v5, v11, s[28:31], s42 offen sc1
    v_mfma_f32_16x16x32_bf16 v[252:255], v[52:55], a[160:163], v[252:255]
    buffer_load_dwordx4 v[168:171], v26, s[8:11], s70 offen offset:2048 sc1
    v_mfma_f32_16x16x32_bf16 v[28:31], v[48:51], a[136:139], v[28:31]
    buffer_load_dwordx2 v[174:175], v27, s[8:11], s70 offen offset:3072 sc1
    v_mfma_f32_16x16x32_bf16 v[28:31], v[52:55], a[164:167], v[28:31]
    s_waitcnt lgkmcnt(2)
    v_mfma_f32_16x16x32_bf16 v[232:235], v[56:59], a[168:171], v[232:235]
    s_waitcnt vmcnt(17) lgkmcnt(0)
    v_mfma_f32_16x16x32_bf16 v[232:235], v[60:63], a[196:199], v[232:235]
    buffer_store_dword v5, v11, s[28:31], s43 offen sc1
    v_mfma_f32_16x16x32_bf16 v[236:239], v[56:59], a[172:175], v[236:239]
    v_mfma_f32_16x16x32_bf16 v[236:239], v[60:63], a[200:203], v[236:239]
    v_mfma_f32_16x16x32_bf16 v[240:243], v[56:59], a[176:179], v[240:243]
    v_mfma_f32_16x16x32_bf16 v[240:243], v[60:63], a[204:207], v[240:243]
    v_mfma_f32_16x16x32_bf16 v[244:247], v[56:59], a[180:183], v[244:247]
    v_mfma_f32_16x16x32_bf16 v[244:247], v[60:63], a[208:211], v[244:247]
    v_mfma_f32_16x16x32_bf16 v[248:251], v[56:59], a[184:187], v[248:251]
    v_mfma_f32_16x16x32_bf16 v[248:251], v[60:63], a[212:215], v[248:251]
    v_mfma_f32_16x16x32_bf16 v[252:255], v[56:59], a[188:191], v[252:255]
    v_mfma_f32_16x16x32_bf16 v[252:255], v[60:63], a[216:219], v[252:255]
    v_mfma_f32_16x16x32_bf16 v[28:31], v[56:59], a[192:195], v[28:31]
    v_mfma_f32_16x16x32_bf16 v[28:31], v[60:63], a[220:223], v[28:31]
    s_cmp_ge_u32 s37, 14
    s_cbranch_scc1 L_noown
    s_mov_b32 s73, 0
    s_cmp_lg_u32 s68, -1
    s_cbranch_scc1 L_c
    L_gw:
    s_call_b64 s[12:13], L_acc
    v_mfma_f32_16x16x32_bf16 v[56:59], v[20:23], v[200:203], v[56:59]
    v_mfma_f32_16x16x32_bf16 v[56:59], v[20:23], v[228:231], v[56:59]
L_gx:
    s_nop 7
    v_add_f32 v232, v232, v32
    v_add_f32 v233, v233, v33
    v_add_f32 v234, v234, v34
    v_add_f32 v235, v235, v35
    v_cvt_pk_bf16_f32 v232, v232, v233
    v_cvt_pk_bf16_f32 v233, v234, v235
    ds_write_b64 v25, v[232:233] offset:0
    v_add_f32 v236, v236, v36
    v_add_f32 v237, v237, v37
    v_add_f32 v238, v238, v38
    v_add_f32_e64 v239, v239, v39
    v_cvt_pk_bf16_f32 v236, v236, v237
    v_cvt_pk_bf16_f32 v237, v238, v239
    ds_write_b64 v25, v[236:237] offset:2304
    v_add_f32 v240, v240, v40
    v_add_f32 v241, v241, v41
    v_add_f32 v242, v242, v42
    v_add_f32 v243, v243, v43
    v_cvt_pk_bf16_f32 v240, v240, v241
    v_cvt_pk_bf16_f32 v241, v242, v243
    ds_write_b64 v25, v[240:241] offset:4608
    v_add_f32 v244, v244, v44
    v_add_f32 v245, v245, v45
    v_add_f32 v246, v246, v46
    v_add_f32 v247, v247, v47
    v_cvt_pk_bf16_f32 v244, v244, v245
    v_cvt_pk_bf16_f32 v245, v246, v247
    ds_write_b64 v25, v[244:245] offset:6912
    v_add_f32 v248, v248, v48
    v_add_f32 v249, v249, v49
    v_add_f32 v250, v250, v50
    v_add_f32 v251, v251, v51
    v_cvt_pk_bf16_f32 v248, v248, v249
    v_cvt_pk_bf16_f32 v249, v250, v251
    ds_write_b64 v25, v[248:249] offset:9216
    v_add_f32 v252, v252, v52
    v_add_f32 v253, v253, v53
    v_add_f32 v254, v254, v54
    v_add_f32 v255, v255, v55
    v_cvt_pk_bf16_f32 v252, v252, v253
    v_cvt_pk_bf16_f32 v253, v254, v255
    ds_write_b64 v25, v[252:253] offset:11520
    v_add_f32_e64 v28, v28, v56
    v_add_f32_e64 v29, v29, v57
    v_add_f32_e64 v30, v30, v58
    v_add_f32_e64 v31, v31, v59
    v_cvt_pk_bf16_f32 v28, v28, v29
    v_cvt_pk_bf16_f32 v29, v30, v31
    ds_write_b64 v25, v[28:29] offset:13824
    v_accvgpr_read_b32 v1, a224
    v_accvgpr_read_b32 v7, a225
    v_accvgpr_read_b32 v8, a226
    v_accvgpr_read_b32 v9, a227
    s_waitcnt lgkmcnt(0)
    s_barrier
    ds_read_b128 v[64:67], v4 offset:0
    ds_read_b128 v[68:71], v4 offset:1152
    ds_read_b128 v[72:75], v4 offset:2304
    ds_read_b128 v[76:79], v4 offset:3456
    s_waitcnt lgkmcnt(3)
    buffer_store_dwordx4 v[64:67], v1, s[16:19], 0 offen sc1
    s_waitcnt lgkmcnt(2)
    buffer_store_dwordx4 v[68:71], v7, s[16:19], 0 offen sc1
    s_waitcnt lgkmcnt(1)
    buffer_store_dwordx4 v[72:75], v8, s[16:19], 0 offen sc1
    s_waitcnt lgkmcnt(0)
    buffer_store_dwordx4 v[76:79], v9, s[16:19], 0 offen sc1
    s_endpgm
L_c:
    s_mov_b32 s73, 0
    s_cmp_eq_u32 s68, -1
    s_cbranch_scc1 L_gw
    s_cmp_eq_u32 s67, 0
    s_cbranch_scc1 L_g0p
    L_g0f:
    s_ff1_i32_b32 s69, s67
    s_cmp_lg_u32 s67, 0
    s_cselect_b32 s10, 2756608, 0
    s_bitset0_b32 s67, s69
    s_bitset1_b32 s68, s69
    s_and_b32 s69, s69, 7
    s_mul_i32 s70, s69, 3584
    s_add_u32 s70, s70, s71
    buffer_load_dwordx4 v[176:179], v26, s[8:11], s70 offen sc1
    buffer_load_dwordx4 v[180:183], v26, s[8:11], s70 offen offset:1024 sc1
    buffer_load_dwordx4 v[184:187], v26, s[8:11], s70 offen offset:2048 sc1
    buffer_load_dwordx2 v[200:201], v27, s[8:11], s70 offen offset:3072 sc1
    s_mov_b32 s73, 1
    s_cmp_eq_u32 s68, -1
    s_cbranch_scc1 L_gw
    s_cmp_eq_u32 s67, 0
    s_cbranch_scc1 L_g1p
    L_g1f:
    s_ff1_i32_b32 s69, s67
    s_cmp_lg_u32 s67, 0
    s_cselect_b32 s10, 2756608, 0
    s_bitset0_b32 s67, s69
    s_bitset1_b32 s68, s69
    s_and_b32 s69, s69, 7
    s_mul_i32 s70, s69, 3584
    s_add_u32 s70, s70, s71
    buffer_load_dwordx4 v[188:191], v26, s[8:11], s70 offen sc1
    buffer_load_dwordx4 v[192:195], v26, s[8:11], s70 offen offset:1024 sc1
    buffer_load_dwordx4 v[196:199], v26, s[8:11], s70 offen offset:2048 sc1
    buffer_load_dwordx2 v[202:203], v27, s[8:11], s70 offen offset:3072 sc1
    s_mov_b32 s73, 2
    s_cmp_eq_u32 s68, -1
    s_cbranch_scc1 L_gw
    s_cmp_eq_u32 s67, 0
    s_cbranch_scc1 L_g2p
    L_g2f:
    s_ff1_i32_b32 s69, s67
    s_cmp_lg_u32 s67, 0
    s_cselect_b32 s10, 2756608, 0
    s_bitset0_b32 s67, s69
    s_bitset1_b32 s68, s69
    s_and_b32 s69, s69, 7
    s_mul_i32 s70, s69, 3584
    s_add_u32 s70, s70, s71
    buffer_load_dwordx4 v[204:207], v26, s[8:11], s70 offen sc1
    buffer_load_dwordx4 v[208:211], v26, s[8:11], s70 offen offset:1024 sc1
    buffer_load_dwordx4 v[212:215], v26, s[8:11], s70 offen offset:2048 sc1
    buffer_load_dwordx2 v[228:229], v27, s[8:11], s70 offen offset:3072 sc1
    s_mov_b32 s73, 3
    s_cmp_eq_u32 s68, -1
    s_cbranch_scc1 L_gw
    s_cmp_eq_u32 s67, 0
    s_cbranch_scc1 L_g3p
    L_g3f:
    s_ff1_i32_b32 s69, s67
    s_cmp_lg_u32 s67, 0
    s_cselect_b32 s10, 2756608, 0
    s_bitset0_b32 s67, s69
    s_bitset1_b32 s68, s69
    s_and_b32 s69, s69, 7
    s_mul_i32 s70, s69, 3584
    s_add_u32 s70, s70, s71
    buffer_load_dwordx4 v[216:219], v26, s[8:11], s70 offen sc1
    buffer_load_dwordx4 v[220:223], v26, s[8:11], s70 offen offset:1024 sc1
    buffer_load_dwordx4 v[224:227], v26, s[8:11], s70 offen offset:2048 sc1
    buffer_load_dwordx2 v[230:231], v27, s[8:11], s70 offen offset:3072 sc1
    s_mov_b32 s73, 4
    s_call_b64 s[12:13], L_acc
    v_mfma_f32_16x16x32_bf16 v[56:59], v[20:23], v[200:203], v[56:59]
    v_mfma_f32_16x16x32_bf16 v[56:59], v[20:23], v[228:231], v[56:59]
    s_mov_b32 s46, 0
    v_mov_b32 v200, 0
    v_mov_b32 v201, 0
    v_mov_b32 v202, 0
    v_mov_b32 v203, 0
    v_mov_b32 v228, 0
    v_mov_b32 v229, 0
    v_mov_b32 v230, 0
    v_mov_b32_e64 v231, 0
    s_branch L_c
L_g0s:
L_g0p:
    s_sub_u32 s52, s52, 1
    s_cbranch_scc1 L_gw
    buffer_load_dword v2, v3, s[28:31], s72 offen sc1
    s_mov_b32 s73, 0
    s_call_b64 s[12:13], L_acc
    v_cmp_ne_u32 vcc, 0, v2
    s_nop 1
    s_andn2_b32 s67, vcc_lo, s68
    s_cbranch_scc0 L_g0s
    s_branch L_g0f
L_g1s:
L_g1p:
    s_sub_u32 s52, s52, 1
    s_cbranch_scc1 L_gw
    buffer_load_dword v2, v3, s[28:31], s72 offen sc1
    s_mov_b32 s73, 1
    s_call_b64 s[12:13], L_acc
    v_cmp_ne_u32 vcc, 0, v2
    s_nop 1
    s_andn2_b32 s67, vcc_lo, s68
    s_cbranch_scc0 L_g1s
    s_branch L_g1f
L_g2s:
L_g2p:
    s_sub_u32 s52, s52, 1
    s_cbranch_scc1 L_gw
    buffer_load_dword v2, v3, s[28:31], s72 offen sc1
    s_mov_b32 s73, 2
    s_call_b64 s[12:13], L_acc
    v_cmp_ne_u32 vcc, 0, v2
    s_nop 1
    s_andn2_b32 s67, vcc_lo, s68
    s_cbranch_scc0 L_g2s
    s_branch L_g2f
L_g3s:
L_g3p:
    s_sub_u32 s52, s52, 1
    s_cbranch_scc1 L_gw
    buffer_load_dword v2, v3, s[28:31], s72 offen sc1
    s_mov_b32 s73, 3
    s_call_b64 s[12:13], L_acc
    v_cmp_ne_u32 vcc, 0, v2
    s_nop 1
    s_andn2_b32 s67, vcc_lo, s68
    s_cbranch_scc0 L_g3s
    s_branch L_g3f
L_acc:
    s_cmp_lg_u32 s48, 0
    s_cbranch_scc1 L_acc1
    s_mov_b32 s48, 1
    v_mfma_f32_16x16x32_bf16 v[32:35], v[12:15], v[64:67], 0
    v_mfma_f32_16x16x32_bf16 v[36:39], v[16:19], v[64:67], 0
    v_mfma_f32_16x16x32_bf16 v[40:43], v[12:15], v[68:71], 0
    v_mfma_f32_16x16x32_bf16 v[44:47], v[16:19], v[68:71], 0
    v_mfma_f32_16x16x32_bf16 v[48:51], v[12:15], v[72:75], 0
    v_mfma_f32_16x16x32_bf16 v[52:55], v[16:19], v[72:75], 0
    v_mfma_f32_16x16x32_bf16 v[56:59], v[20:23], v[88:91], 0
    v_mfma_f32_16x16x32_bf16 v[32:35], v[12:15], v[76:79], v[32:35]
    v_mfma_f32_16x16x32_bf16 v[36:39], v[16:19], v[76:79], v[36:39]
    v_mfma_f32_16x16x32_bf16 v[40:43], v[12:15], v[80:83], v[40:43]
    v_mfma_f32_16x16x32_bf16 v[44:47], v[16:19], v[80:83], v[44:47]
    v_mfma_f32_16x16x32_bf16 v[48:51], v[12:15], v[84:87], v[48:51]
    v_mfma_f32_16x16x32_bf16 v[52:55], v[16:19], v[84:87], v[52:55]
    v_mfma_f32_16x16x32_bf16 v[32:35], v[12:15], v[92:95], v[32:35]
    v_mfma_f32_16x16x32_bf16 v[36:39], v[16:19], v[92:95], v[36:39]
    v_mfma_f32_16x16x32_bf16 v[40:43], v[12:15], v[96:99], v[40:43]
    v_mfma_f32_16x16x32_bf16 v[44:47], v[16:19], v[96:99], v[44:47]
    v_mfma_f32_16x16x32_bf16 v[48:51], v[12:15], v[100:103], v[48:51]
    v_mfma_f32_16x16x32_bf16 v[52:55], v[16:19], v[100:103], v[52:55]
    v_mfma_f32_16x16x32_bf16 v[56:59], v[20:23], v[116:119], v[56:59]
    v_mfma_f32_16x16x32_bf16 v[32:35], v[12:15], v[104:107], v[32:35]
    v_mfma_f32_16x16x32_bf16 v[36:39], v[16:19], v[104:107], v[36:39]
    v_mfma_f32_16x16x32_bf16 v[40:43], v[12:15], v[108:111], v[40:43]
    v_mfma_f32_16x16x32_bf16 v[44:47], v[16:19], v[108:111], v[44:47]
    v_mfma_f32_16x16x32_bf16 v[48:51], v[12:15], v[112:115], v[48:51]
    v_mfma_f32_16x16x32_bf16 v[52:55], v[16:19], v[112:115], v[52:55]
    s_waitcnt vmcnt(0)
    v_mfma_f32_16x16x32_bf16 v[32:35], v[12:15], v[120:123], v[32:35]
    v_mfma_f32_16x16x32_bf16 v[36:39], v[16:19], v[120:123], v[36:39]
    v_mfma_f32_16x16x32_bf16 v[40:43], v[12:15], v[124:127], v[40:43]
    v_mfma_f32_16x16x32_bf16 v[44:47], v[16:19], v[124:127], v[44:47]
    v_mfma_f32_16x16x32_bf16 v[48:51], v[12:15], v[128:131], v[48:51]
    v_mfma_f32_16x16x32_bf16 v[52:55], v[16:19], v[128:131], v[52:55]
    v_mfma_f32_16x16x32_bf16 v[56:59], v[20:23], v[144:147], v[56:59]
    v_mfma_f32_16x16x32_bf16 v[32:35], v[12:15], v[132:135], v[32:35]
    v_mfma_f32_16x16x32_bf16 v[36:39], v[16:19], v[132:135], v[36:39]
    v_mfma_f32_16x16x32_bf16 v[40:43], v[12:15], v[136:139], v[40:43]
    v_mfma_f32_16x16x32_bf16 v[44:47], v[16:19], v[136:139], v[44:47]
    v_mfma_f32_16x16x32_bf16 v[48:51], v[12:15], v[140:143], v[48:51]
    v_mfma_f32_16x16x32_bf16 v[52:55], v[16:19], v[140:143], v[52:55]
    v_mfma_f32_16x16x32_bf16 v[32:35], v[12:15], v[148:151], v[32:35]
    v_mfma_f32_16x16x32_bf16 v[36:39], v[16:19], v[148:151], v[36:39]
    v_mfma_f32_16x16x32_bf16 v[40:43], v[12:15], v[152:155], v[40:43]
    v_mfma_f32_16x16x32_bf16 v[44:47], v[16:19], v[152:155], v[44:47]
    v_mfma_f32_16x16x32_bf16 v[48:51], v[12:15], v[156:159], v[48:51]
    v_mfma_f32_16x16x32_bf16 v[52:55], v[16:19], v[156:159], v[52:55]
    v_mfma_f32_16x16x32_bf16 v[56:59], v[20:23], v[172:175], v[56:59]
    v_mfma_f32_16x16x32_bf16 v[32:35], v[12:15], v[160:163], v[32:35]
    v_mfma_f32_16x16x32_bf16 v[36:39], v[16:19], v[160:163], v[36:39]
    v_mfma_f32_16x16x32_bf16 v[40:43], v[12:15], v[164:167], v[40:43]
    v_mfma_f32_16x16x32_bf16 v[44:47], v[16:19], v[164:167], v[44:47]
    v_mfma_f32_16x16x32_bf16 v[48:51], v[12:15], v[168:171], v[48:51]
    v_mfma_f32_16x16x32_bf16 v[52:55], v[16:19], v[168:171], v[52:55]
L_acc1:
    s_waitcnt vmcnt(0)
    s_cmp_le_u32 s73, 0
    s_cbranch_scc1 L_accx
    s_cmp_gt_u32 s46, 0
    s_cbranch_scc1 L_accn0
    v_mfma_f32_16x16x32_bf16 v[32:35], v[12:15], v[176:179], v[32:35]
    v_mfma_f32_16x16x32_bf16 v[36:39], v[16:19], v[176:179], v[36:39]
    v_mfma_f32_16x16x32_bf16 v[40:43], v[12:15], v[180:183], v[40:43]
    v_mfma_f32_16x16x32_bf16 v[44:47], v[16:19], v[180:183], v[44:47]
    v_mfma_f32_16x16x32_bf16 v[48:51], v[12:15], v[184:187], v[48:51]
    v_mfma_f32_16x16x32_bf16 v[52:55], v[16:19], v[184:187], v[52:55]
L_accn0:
    s_cmp_le_u32 s73, 1
    s_cbranch_scc1 L_accx
    s_cmp_gt_u32 s46, 1
    s_cbranch_scc1 L_accn1
    v_mfma_f32_16x16x32_bf16 v[32:35], v[12:15], v[188:191], v[32:35]
    v_mfma_f32_16x16x32_bf16 v[36:39], v[16:19], v[188:191], v[36:39]
    v_mfma_f32_16x16x32_bf16 v[40:43], v[12:15], v[192:195], v[40:43]
    v_mfma_f32_16x16x32_bf16 v[44:47], v[16:19], v[192:195], v[44:47]
    v_mfma_f32_16x16x32_bf16 v[48:51], v[12:15], v[196:199], v[48:51]
    v_mfma_f32_16x16x32_bf16 v[52:55], v[16:19], v[196:199], v[52:55]
L_accn1:
    s_cmp_le_u32 s73, 2
    s_cbranch_scc1 L_accx
    s_cmp_gt_u32 s46, 2
    s_cbranch_scc1 L_accn2
    v_mfma_f32_16x16x32_bf16 v[32:35], v[12:15], v[204:207], v[32:35]
    v_mfma_f32_16x16x32_bf16 v[36:39], v[16:19], v[204:207], v[36:39]
    v_mfma_f32_16x16x32_bf16 v[40:43], v[12:15], v[208:211], v[40:43]
    v_mfma_f32_16x16x32_bf16 v[44:47], v[16:19], v[208:211], v[44:47]
    v_mfma_f32_16x16x32_bf16 v[48:51], v[12:15], v[212:215], v[48:51]
    v_mfma_f32_16x16x32_bf16 v[52:55], v[16:19], v[212:215], v[52:55]
L_accn2:
    s_cmp_le_u32 s73, 3
    s_cbranch_scc1 L_accx
    s_cmp_gt_u32 s46, 3
    s_cbranch_scc1 L_accn3
    v_mfma_f32_16x16x32_bf16 v[32:35], v[12:15], v[216:219], v[32:35]
    v_mfma_f32_16x16x32_bf16 v[36:39], v[16:19], v[216:219], v[36:39]
    v_mfma_f32_16x16x32_bf16 v[40:43], v[12:15], v[220:223], v[40:43]
    v_mfma_f32_16x16x32_bf16 v[44:47], v[16:19], v[220:223], v[44:47]
    v_mfma_f32_16x16x32_bf16 v[48:51], v[12:15], v[224:227], v[48:51]
    v_mfma_f32_16x16x32_bf16 v[52:55], v[16:19], v[224:227], v[52:55]
L_accn3:
L_accx:
    s_mov_b32 s46, s73
    s_setpc_b64 s[12:13]
L_noown:
    s_nop 7
    v_cvt_pk_bf16_f32 v232, v232, v233
    v_cvt_pk_bf16_f32 v233, v234, v235
    v_cvt_pk_bf16_f32 v234, v236, v237
    v_cvt_pk_bf16_f32 v235, v238, v239
    buffer_store_dwordx4 v[232:235], v26, s[28:31], s40 offen sc1
    v_cvt_pk_bf16_f32 v240, v240, v241
    v_cvt_pk_bf16_f32 v241, v242, v243
    v_cvt_pk_bf16_f32 v242, v244, v245
    v_cvt_pk_bf16_f32 v243, v246, v247
    buffer_store_dwordx4 v[240:243], v26, s[28:31], s40 offen offset:1024 sc1
    v_cvt_pk_bf16_f32 v248, v248, v249
    v_cvt_pk_bf16_f32 v249, v250, v251
    v_cvt_pk_bf16_f32 v250, v252, v253
    v_cvt_pk_bf16_f32 v251, v254, v255
    buffer_store_dwordx4 v[248:251], v26, s[28:31], s40 offen offset:2048 sc1
    v_cvt_pk_bf16_f32 v28, v28, v29
    v_cvt_pk_bf16_f32 v29, v30, v31
    buffer_store_dwordx2 v[28:29], v27, s[28:31], s40 offen offset:3072 sc1
    s_waitcnt vmcnt(0)
    buffer_store_dword v5, v11, s[28:31], s44 offen sc1
    s_endpgm
L_rdy:
    s_sub_u32 s52, s52, 1
    s_cbranch_scc1 L_rdyok
    buffer_load_dword v1, v11, s[32:35], 0 offen sc1
    s_waitcnt vmcnt(0)
    v_readfirstlane_b32 s86, v1
    s_nop 3
    s_cmp_lt_u32 s86, 16
    s_cbranch_scc1 L_rdy
    s_branch L_rdyok
L_ow:
    s_sub_u32 s52, s52, 1
    s_cbranch_scc1 L_owok
    buffer_load_dword v2, v3, s[28:31], s72 offen sc1
    s_waitcnt vmcnt(0)
    v_cmp_ne_u32 vcc, 0, v2
    s_nop 3
    s_and_b32 s85, vcc_lo, 0x300
    s_cmp_lg_u32 s85, 0x300
    s_cbranch_scc1 L_ow
    s_branch L_owok
L_redo:
    s_mov_b32 s90, -1
L_again:
    s_waitcnt vmcnt(0) lgkmcnt(0)
    s_barrier
    v_lshrrev_b32_e64 v0, 4, v26
    s_lshl_b32 s85, s3, 6
    s_nop 7
    v_add_u32_e64 v0, s85, v0
    s_branch L_restart
L_max0:
    s_waitcnt vmcnt(0) lgkmcnt(0)
    s_mov_b32 s92, m0
    s_nop 7
    s_mov_b64 s[8:9], s[58:59]
    s_mov_b32 s10, 262144
    s_mov_b32 s11, 0x20000
    v_add_u32 v6, 66560, v1
    s_mov_b32 s93, s81
    v_mov_b32 v16, 0xff800000
    v_mov_b32 v17, 0xff800000
    v_mov_b32 v18, 0xff800000
    v_mov_b32 v19, 0xff800000
L_maxl0:
    s_barrier
    s_add_u32 m0, s71, 133120
    s_nop 0
    buffer_load_dwordx4 v26, s[8:11], s93 offen lds
    buffer_load_dwordx4 v26, s[8:11], s93 offen offset:1024 lds
    s_add_u32 s93, s93, 8192
    s_add_u32 m0, s71, 141440
    s_nop 0
    buffer_load_dwordx4 v26, s[8:11], s93 offen lds
    buffer_load_dwordx4 v26, s[8:11], s93 offen offset:1024 lds
    s_add_u32 s93, s93, 8192
    s_waitcnt vmcnt(0)
    s_barrier
    ds_read_b128 v[236:239], v6 offset:0
    s_waitcnt lgkmcnt(0)
    v_mfma_f32_16x16x32_bf16 v[240:243], v[236:239], v[120:123], 0
    v_mfma_f32_16x16x32_bf16 v[244:247], v[236:239], v[152:155], 0
    v_mfma_f32_16x16x32_bf16 v[248:251], v[236:239], v[184:187], 0
    v_mfma_f32_16x16x32_bf16 v[252:255], v[236:239], v[216:219], 0
    ds_read_b128 v[236:239], v6 offset:64
    s_waitcnt lgkmcnt(0)
    v_mfma_f32_16x16x32_bf16 v[240:243], v[236:239], v[124:127], v[240:243]
    v_mfma_f32_16x16x32_bf16 v[244:247], v[236:239], v[156:159], v[244:247]
    v_mfma_f32_16x16x32_bf16 v[248:251], v[236:239], v[188:191], v[248:251]
    v_mfma_f32_16x16x32_bf16 v[252:255], v[236:239], a[224:227], v[252:255]
    ds_read_b128 v[236:239], v6 offset:128
    s_waitcnt lgkmcnt(0)
    v_mfma_f32_16x16x32_bf16 v[240:243], v[236:239], v[128:131], v[240:243]
    v_mfma_f32_16x16x32_bf16 v[244:247], v[236:239], v[160:163], v[244:247]
    v_mfma_f32_16x16x32_bf16 v[248:251], v[236:239], v[192:195], v[248:251]
    v_mfma_f32_16x16x32_bf16 v[252:255], v[236:239], v[220:223], v[252:255]
    ds_read_b128 v[236:239], v6 offset:192
    s_waitcnt lgkmcnt(0)
    v_mfma_f32_16x16x32_bf16 v[240:243], v[236:239], v[132:135], v[240:243]
    v_mfma_f32_16x16x32_bf16 v[244:247], v[236:239], v[164:167], v[244:247]
    v_mfma_f32_16x16x32_bf16 v[248:251], v[236:239], v[196:199], v[248:251]
    v_mfma_f32_16x16x32_bf16 v[252:255], v[236:239], a[228:231], v[252:255]
    ds_read_b128 v[236:239], v6 offset:256
    s_waitcnt lgkmcnt(0)
    v_mfma_f32_16x16x32_bf16 v[240:243], v[236:239], v[136:139], v[240:243]
    v_mfma_f32_16x16x32_bf16 v[244:247], v[236:239], v[168:171], v[244:247]
    v_mfma_f32_16x16x32_bf16 v[248:251], v[236:239], v[200:203], v[248:251]
    v_mfma_f32_16x16x32_bf16 v[252:255], v[236:239], v[224:227], v[252:255]
    ds_read_b128 v[236:239], v6 offset:320
    s_waitcnt lgkmcnt(0)
    v_mfma_f32_16x16x32_bf16 v[240:243], v[236:239], v[140:143], v[240:243]
    v_mfma_f32_16x16x32_bf16 v[244:247], v[236:239], v[172:175], v[244:247]
    v_mfma_f32_16x16x32_bf16 v[248:251], v[236:239], v[204:207], v[248:251]
    v_mfma_f32_16x16x32_bf16 v[252:255], v[236:239], a[232:235], v[252:255]
    ds_read_b128 v[236:239], v6 offset:384
    s_waitcnt lgkmcnt(0)
    v_mfma_f32_16x16x32_bf16 v[240:243], v[236:239], v[144:147], v[240:243]
    v_mfma_f32_16x16x32_bf16 v[244:247], v[236:239], v[176:179], v[244:247]
    v_mfma_f32_16x16x32_bf16 v[248:251], v[236:239], v[208:211], v[248:251]
    v_mfma_f32_16x16x32_bf16 v[252:255], v[236:239], v[228:231], v[252:255]
    ds_read_b128 v[236:239], v6 offset:448
    s_waitcnt lgkmcnt(0)
    v_mfma_f32_16x16x32_bf16 v[240:243], v[236:239], v[148:151], v[240:243]
    v_mfma_f32_16x16x32_bf16 v[244:247], v[236:239], v[180:183], v[244:247]
    v_mfma_f32_16x16x32_bf16 v[248:251], v[236:239], v[212:215], v[248:251]
    v_mfma_f32_16x16x32_bf16 v[252:255], v[236:239], a[236:239], v[252:255]
    s_nop 7
    v_max3_f32 v16, v16, v240, v241
    v_max3_f32 v16, v16, v242, v243
    v_max3_f32 v17, v17, v244, v245
    v_max3_f32 v17, v17, v246, v247
    v_max3_f32 v18, v18, v248, v249
    v_max3_f32 v18, v18, v250, v251
    v_max3_f32 v19, v19, v252, v253
    v_max3_f32 v19, v19, v254, v255
    ds_read_b128 v[236:239], v6 offset:1024
    s_waitcnt lgkmcnt(0)
    v_mfma_f32_16x16x32_bf16 v[240:243], v[236:239], v[120:123], 0
    v_mfma_f32_16x16x32_bf16 v[244:247], v[236:239], v[152:155], 0
    v_mfma_f32_16x16x32_bf16 v[248:251], v[236:239], v[184:187], 0
    v_mfma_f32_16x16x32_bf16 v[252:255], v[236:239], v[216:219], 0
    ds_read_b128 v[236:239], v6 offset:1088
    s_waitcnt lgkmcnt(0)
    v_mfma_f32_16x16x32_bf16 v[240:243], v[236:239], v[124:127], v[240:243]
    v_mfma_f32_16x16x32_bf16 v[244:247], v[236:239], v[156:159], v[244:247]
    v_mfma_f32_16x16x32_bf16 v[248:251], v[236:239], v[188:191], v[248:251]
    v_mfma_f32_16x16x32_bf16 v[252:255], v[236:239], a[224:227], v[252:255]
    ds_read_b128 v[236:239], v6 offset:1152
    s_waitcnt lgkmcnt(0)
    v_mfma_f32_16x16x32_bf16 v[240:243], v[236:239], v[128:131], v[240:243]
    v_mfma_f32_16x16x32_bf16 v[244:247], v[236:239], v[160:163], v[244:247]
    v_mfma_f32_16x16x32_bf16 v[248:251], v[236:239], v[192:195], v[248:251]
    v_mfma_f32_16x16x32_bf16 v[252:255], v[236:239], v[220:223], v[252:255]
    ds_read_b128 v[236:239], v6 offset:1216
    s_waitcnt lgkmcnt(0)
    v_mfma_f32_16x16x32_bf16 v[240:243], v[236:239], v[132:135], v[240:243]
    v_mfma_f32_16x16x32_bf16 v[244:247], v[236:239], v[164:167], v[244:247]
    v_mfma_f32_16x16x32_bf16 v[248:251], v[236:239], v[196:199], v[248:251]
    v_mfma_f32_16x16x32_bf16 v[252:255], v[236:239], a[228:231], v[252:255]
    ds_read_b128 v[236:239], v6 offset:1280
    s_waitcnt lgkmcnt(0)
    v_mfma_f32_16x16x32_bf16 v[240:243], v[236:239], v[136:139], v[240:243]
    v_mfma_f32_16x16x32_bf16 v[244:247], v[236:239], v[168:171], v[244:247]
    v_mfma_f32_16x16x32_bf16 v[248:251], v[236:239], v[200:203], v[248:251]
    v_mfma_f32_16x16x32_bf16 v[252:255], v[236:239], v[224:227], v[252:255]
    ds_read_b128 v[236:239], v6 offset:1344
    s_waitcnt lgkmcnt(0)
    v_mfma_f32_16x16x32_bf16 v[240:243], v[236:239], v[140:143], v[240:243]
    v_mfma_f32_16x16x32_bf16 v[244:247], v[236:239], v[172:175], v[244:247]
    v_mfma_f32_16x16x32_bf16 v[248:251], v[236:239], v[204:207], v[248:251]
    v_mfma_f32_16x16x32_bf16 v[252:255], v[236:239], a[232:235], v[252:255]
    ds_read_b128 v[236:239], v6 offset:1408
    s_waitcnt lgkmcnt(0)
    v_mfma_f32_16x16x32_bf16 v[240:243], v[236:239], v[144:147], v[240:243]
    v_mfma_f32_16x16x32_bf16 v[244:247], v[236:239], v[176:179], v[244:247]
    v_mfma_f32_16x16x32_bf16 v[248:251], v[236:239], v[208:211], v[248:251]
    v_mfma_f32_16x16x32_bf16 v[252:255], v[236:239], v[228:231], v[252:255]
    ds_read_b128 v[236:239], v6 offset:1472
    s_waitcnt lgkmcnt(0)
    v_mfma_f32_16x16x32_bf16 v[240:243], v[236:239], v[148:151], v[240:243]
    v_mfma_f32_16x16x32_bf16 v[244:247], v[236:239], v[180:183], v[244:247]
    v_mfma_f32_16x16x32_bf16 v[248:251], v[236:239], v[212:215], v[248:251]
    v_mfma_f32_16x16x32_bf16 v[252:255], v[236:239], a[236:239], v[252:255]
    s_nop 7
    v_max3_f32 v16, v16, v240, v241
    v_max3_f32 v16, v16, v242, v243
    v_max3_f32 v17, v17, v244, v245
    v_max3_f32 v17, v17, v246, v247
    v_max3_f32 v18, v18, v248, v249
    v_max3_f32 v18, v18, v250, v251
    v_max3_f32 v19, v19, v252, v253
    v_max3_f32 v19, v19, v254, v255
    s_cmp_lt_u32 s93, 262144
    s_cbranch_scc1 L_maxl0
    v_mov_b32 v20, v16
    v_mov_b32 v21, v17
    v_mov_b32 v22, v18
    v_mov_b32 v23, v19
    s_nop 1
    v_permlane16_swap_b32 v16, v20
    v_permlane16_swap_b32 v17, v21
    v_permlane16_swap_b32 v18, v22
    v_permlane16_swap_b32 v19, v23
    v_max_f32 v16, v16, v20
    v_max_f32 v17, v17, v21
    v_max_f32 v18, v18, v22
    v_max_f32 v19, v19, v23
    v_mov_b32 v20, v16
    v_mov_b32_e64 v21, v17
    v_mov_b32_e64 v22, v18
    v_mov_b32 v23, v19
    s_nop 1
    v_permlane32_swap_b32 v16, v20
    v_permlane32_swap_b32 v17, v21
    v_permlane32_swap_b32 v18, v22
    v_permlane32_swap_b32 v19, v23
    v_max_f32_e64 v16, v16, v20
    v_max_f32_e64 v17, v17, v21
    v_max_f32_e64 v18, v18, v22
    v_max_f32_e64 v19, v19, v23
    v_mul_f32 v16, -v16, s84
    v_mul_f32 v17, -v17, s84
    v_mul_f32 v18, -v18, s84
    v_mul_f32 v19, -v19, s84
    s_mov_b32 m0, s92
    s_barrier
    s_branch L_maxok0
L_max1:
    s_waitcnt vmcnt(0) lgkmcnt(0)
    s_mov_b32 s92, m0
    s_nop 7
    s_mov_b64 s[8:9], s[58:59]
    s_mov_b32 s10, 262144
    s_mov_b32 s11, 0x20000
    v_add_u32 v6, 66560, v1
    s_mov_b32 s93, s81
    v_mov_b32 v16, 0xff800000
    v_mov_b32 v17, 0xff800000
    v_mov_b32 v18, 0xff800000
    v_mov_b32 v19, 0xff800000
L_maxl1:
    s_barrier
    s_add_u32 m0, s71, 133120
    s_nop 0
    buffer_load_dwordx4 v26, s[8:11], s93 offen lds
    buffer_load_dwordx4 v26, s[8:11], s93 offen offset:1024 lds
    s_add_u32 s93, s93, 8192
    s_add_u32 m0, s71, 141440
    s_nop 0
    buffer_load_dwordx4 v26, s[8:11], s93 offen lds
    buffer_load_dwordx4 v26, s[8:11], s93 offen offset:1024 lds
    s_add_u32 s93, s93, 8192
    s_waitcnt vmcnt(0)
    s_barrier
    ds_read_b128 v[236:239], v6 offset:0
    s_waitcnt lgkmcnt(0)
    v_mfma_f32_16x16x32_bf16 v[240:243], v[236:239], v[120:123], 0
    v_mfma_f32_16x16x32_bf16 v[244:247], v[236:239], v[152:155], 0
    v_mfma_f32_16x16x32_bf16 v[248:251], v[236:239], v[184:187], 0
    v_mfma_f32_16x16x32_bf16 v[252:255], v[236:239], a[224:227], 0
    ds_read_b128 v[236:239], v6 offset:64
    s_waitcnt lgkmcnt(0)
    v_mfma_f32_16x16x32_bf16 v[240:243], v[236:239], v[124:127], v[240:243]
    v_mfma_f32_16x16x32_bf16 v[244:247], v[236:239], v[156:159], v[244:247]
    v_mfma_f32_16x16x32_bf16 v[248:251], v[236:239], v[188:191], v[248:251]
    v_mfma_f32_16x16x32_bf16 v[252:255], v[236:239], v[216:219], v[252:255]
    ds_read_b128 v[236:239], v6 offset:128
    s_waitcnt lgkmcnt(0)
    v_mfma_f32_16x16x32_bf16 v[240:243], v[236:239], v[128:131], v[240:243]
    v_mfma_f32_16x16x32_bf16 v[244:247], v[236:239], v[160:163], v[244:247]
    v_mfma_f32_16x16x32_bf16 v[248:251], v[236:239], v[192:195], v[248:251]
    v_mfma_f32_16x16x32_bf16 v[252:255], v[236:239], a[228:231], v[252:255]
    ds_read_b128 v[236:239], v6 offset:192
    s_waitcnt lgkmcnt(0)
    v_mfma_f32_16x16x32_bf16 v[240:243], v[236:239], v[132:135], v[240:243]
    v_mfma_f32_16x16x32_bf16 v[244:247], v[236:239], v[164:167], v[244:247]
    v_mfma_f32_16x16x32_bf16 v[248:251], v[236:239], v[196:199], v[248:251]
    v_mfma_f32_16x16x32_bf16 v[252:255], v[236:239], v[220:223], v[252:255]
    ds_read_b128 v[236:239], v6 offset:256
    s_waitcnt lgkmcnt(0)
    v_mfma_f32_16x16x32_bf16 v[240:243], v[236:239], v[136:139], v[240:243]
    v_mfma_f32_16x16x32_bf16 v[244:247], v[236:239], v[168:171], v[244:247]
    v_mfma_f32_16x16x32_bf16 v[248:251], v[236:239], v[200:203], v[248:251]
    v_mfma_f32_16x16x32_bf16 v[252:255], v[236:239], a[232:235], v[252:255]
    ds_read_b128 v[236:239], v6 offset:320
    s_waitcnt lgkmcnt(0)
    v_mfma_f32_16x16x32_bf16 v[240:243], v[236:239], v[140:143], v[240:243]
    v_mfma_f32_16x16x32_bf16 v[244:247], v[236:239], v[172:175], v[244:247]
    v_mfma_f32_16x16x32_bf16 v[248:251], v[236:239], v[204:207], v[248:251]
    v_mfma_f32_16x16x32_bf16 v[252:255], v[236:239], v[224:227], v[252:255]
    ds_read_b128 v[236:239], v6 offset:384
    s_waitcnt lgkmcnt(0)
    v_mfma_f32_16x16x32_bf16 v[240:243], v[236:239], v[144:147], v[240:243]
    v_mfma_f32_16x16x32_bf16 v[244:247], v[236:239], v[176:179], v[244:247]
    v_mfma_f32_16x16x32_bf16 v[248:251], v[236:239], v[208:211], v[248:251]
    v_mfma_f32_16x16x32_bf16 v[252:255], v[236:239], a[236:239], v[252:255]
    ds_read_b128 v[236:239], v6 offset:448
    s_waitcnt lgkmcnt(0)
    v_mfma_f32_16x16x32_bf16 v[240:243], v[236:239], v[148:151], v[240:243]
    v_mfma_f32_16x16x32_bf16 v[244:247], v[236:239], v[180:183], v[244:247]
    v_mfma_f32_16x16x32_bf16 v[248:251], v[236:239], v[212:215], v[248:251]
    v_mfma_f32_16x16x32_bf16 v[252:255], v[236:239], v[228:231], v[252:255]
    s_nop 7
    v_max3_f32 v16, v16, v240, v241
    v_max3_f32 v16, v16, v242, v243
    v_max3_f32 v17, v17, v244, v245
    v_max3_f32 v17, v17, v246, v247
    v_max3_f32 v18, v18, v248, v249
    v_max3_f32 v18, v18, v250, v251
    v_max3_f32 v19, v19, v252, v253
    v_max3_f32 v19, v19, v254, v255
    ds_read_b128 v[236:239], v6 offset:1024
    s_waitcnt lgkmcnt(0)
    v_mfma_f32_16x16x32_bf16 v[240:243], v[236:239], v[120:123], 0
    v_mfma_f32_16x16x32_bf16 v[244:247], v[236:239], v[152:155], 0
    v_mfma_f32_16x16x32_bf16 v[248:251], v[236:239], v[184:187], 0
    v_mfma_f32_16x16x32_bf16 v[252:255], v[236:239], a[224:227], 0
    ds_read_b128 v[236:239], v6 offset:1088
    s_waitcnt lgkmcnt(0)
    v_mfma_f32_16x16x32_bf16 v[240:243], v[236:239], v[124:127], v[240:243]
    v_mfma_f32_16x16x32_bf16 v[244:247], v[236:239], v[156:159], v[244:247]
    v_mfma_f32_16x16x32_bf16 v[248:251], v[236:239], v[188:191], v[248:251]
    v_mfma_f32_16x16x32_bf16 v[252:255], v[236:239], v[216:219], v[252:255]
    ds_read_b128 v[236:239], v6 offset:1152
    s_waitcnt lgkmcnt(0)
    v_mfma_f32_16x16x32_bf16 v[240:243], v[236:239], v[128:131], v[240:243]
    v_mfma_f32_16x16x32_bf16 v[244:247], v[236:239], v[160:163], v[244:247]
    v_mfma_f32_16x16x32_bf16 v[248:251], v[236:239], v[192:195], v[248:251]
    v_mfma_f32_16x16x32_bf16 v[252:255], v[236:239], a[228:231], v[252:255]
    ds_read_b128 v[236:239], v6 offset:1216
    s_waitcnt lgkmcnt(0)
    v_mfma_f32_16x16x32_bf16 v[240:243], v[236:239], v[132:135], v[240:243]
    v_mfma_f32_16x16x32_bf16 v[244:247], v[236:239], v[164:167], v[244:247]
    v_mfma_f32_16x16x32_bf16 v[248:251], v[236:239], v[196:199], v[248:251]
    v_mfma_f32_16x16x32_bf16 v[252:255], v[236:239], v[220:223], v[252:255]
    ds_read_b128 v[236:239], v6 offset:1280
    s_waitcnt lgkmcnt(0)
    v_mfma_f32_16x16x32_bf16 v[240:243], v[236:239], v[136:139], v[240:243]
    v_mfma_f32_16x16x32_bf16 v[244:247], v[236:239], v[168:171], v[244:247]
    v_mfma_f32_16x16x32_bf16 v[248:251], v[236:239], v[200:203], v[248:251]
    v_mfma_f32_16x16x32_bf16 v[252:255], v[236:239], a[232:235], v[252:255]
    ds_read_b128 v[236:239], v6 offset:1344
    s_waitcnt lgkmcnt(0)
    v_mfma_f32_16x16x32_bf16 v[240:243], v[236:239], v[140:143], v[240:243]
    v_mfma_f32_16x16x32_bf16 v[244:247], v[236:239], v[172:175], v[244:247]
    v_mfma_f32_16x16x32_bf16 v[248:251], v[236:239], v[204:207], v[248:251]
    v_mfma_f32_16x16x32_bf16 v[252:255], v[236:239], v[224:227], v[252:255]
    ds_read_b128 v[236:239], v6 offset:1408
    s_waitcnt lgkmcnt(0)
    v_mfma_f32_16x16x32_bf16 v[240:243], v[236:239], v[144:147], v[240:243]
    v_mfma_f32_16x16x32_bf16 v[244:247], v[236:239], v[176:179], v[244:247]
    v_mfma_f32_16x16x32_bf16 v[248:251], v[236:239], v[208:211], v[248:251]
    v_mfma_f32_16x16x32_bf16 v[252:255], v[236:239], a[236:239], v[252:255]
    ds_read_b128 v[236:239], v6 offset:1472
    s_waitcnt lgkmcnt(0)
    v_mfma_f32_16x16x32_bf16 v[240:243], v[236:239], v[148:151], v[240:243]
    v_mfma_f32_16x16x32_bf16 v[244:247], v[236:239], v[180:183], v[244:247]
    v_mfma_f32_16x16x32_bf16 v[248:251], v[236:239], v[212:215], v[248:251]
    v_mfma_f32_16x16x32_bf16 v[252:255], v[236:239], v[228:231], v[252:255]
    s_nop 7
    v_max3_f32 v16, v16, v240, v241
    v_max3_f32 v16, v16, v242, v243
    v_max3_f32 v17, v17, v244, v245
    v_max3_f32 v17, v17, v246, v247
    v_max3_f32 v18, v18, v248, v249
    v_max3_f32 v18, v18, v250, v251
    v_max3_f32 v19, v19, v252, v253
    v_max3_f32 v19, v19, v254, v255
    s_cmp_lt_u32 s93, 262144
    s_cbranch_scc1 L_maxl1
    v_mov_b32 v20, v16
    v_mov_b32 v21, v17
    v_mov_b32 v22, v18
    v_mov_b32 v23, v19
    s_nop 1
    v_permlane16_swap_b32 v16, v20
    v_permlane16_swap_b32 v17, v21
    v_permlane16_swap_b32 v18, v22
    v_permlane16_swap_b32 v19, v23
    v_max_f32 v16, v16, v20
    v_max_f32 v17, v17, v21
    v_max_f32 v18, v18, v22
    v_max_f32 v19, v19, v23
    v_mov_b32 v20, v16
    v_mov_b32 v21, v17
    v_mov_b32 v22, v18
    v_mov_b32 v23, v19
    s_nop 1
    v_permlane32_swap_b32 v16, v20
    v_permlane32_swap_b32 v17, v21
    v_permlane32_swap_b32 v18, v22
    v_permlane32_swap_b32 v19, v23
    v_max_f32 v16, v16, v20
    v_max_f32 v17, v17, v21
    v_max_f32 v18, v18, v22
    v_max_f32 v19, v19, v23
    v_mul_f32 v16, -v16, s84
    v_mul_f32 v17, -v17, s84
    v_mul_f32 v18, -v18, s84
    v_mul_f32 v19, -v19, s84
    s_mov_b32 m0, s92
    s_barrier
    s_branch L_maxok1
L_end:
    s_endpgm
.section .rodata,"a"
.p2align 6
.amdhsa_kernel concat_heads__mha_block_cached__gqa_block_cached__near_ridge_kernel
  .amdhsa_next_free_vgpr 512
  .amdhsa_next_free_sgpr 102
  .amdhsa_accum_offset 256
  .amdhsa_group_segment_fixed_size 0
  .amdhsa_kernarg_size 104
  .amdhsa_user_sgpr_count 2
  .amdhsa_user_sgpr_kernarg_segment_ptr 1
  .amdhsa_system_sgpr_workgroup_id_x 1
.end_amdhsa_kernel
```
